```python
import torch

def _softmax(x, axis=-1):
    return torch.softmax(x, dim=axis)
def _gelu(x):
    return torch.nn.functional.gelu(x, approximate="tanh")
def _silu(x):
    return torch.nn.functional.silu(x)
def _sigmoid(x):
    return torch.sigmoid(x)
def _layernorm(x, axis=-1, eps=1e-5):
    m = x.mean(dim=axis, keepdim=True)
    v = x.var(dim=axis, keepdim=True, unbiased=False)
    return (x - m) / torch.sqrt(v + eps)
def _scatter_add(tgt, idx, src, axis=0):
    return tgt.clone().index_add_(axis, idx, src)
def _segment_sum(src, seg, n):
    out = torch.zeros((n,) + src.shape[1:], dtype=src.dtype)
    return out.index_add_(0, seg, src)
def _pad(x, pw):
    flat = tuple(v for pair in reversed(pw) for v in pair)
    return torch.nn.functional.pad(x, flat)

kernel_name = 'standalone__gqa_softmax__near_ridge'

def setup_inputs():

    _w = (lambda a: (lambda t: t.to(torch.bfloat16) if t.is_floating_point() else t)(torch.as_tensor(a)))
    B, Hq, Hkv, Sq, Sk, D = 16, 32, 16, 496, 512, 128
    return {
        "q": _w((lambda *s: torch.randn(*s, dtype=torch.bfloat16) * 0.8)(B, Hq, Sq, D)),
        "k": _w((lambda *s: torch.randn(*s, dtype=torch.bfloat16) * 0.8)(B, Hkv, Sk, D)),
        "v": _w((lambda *s: torch.randn(*s, dtype=torch.bfloat16) * 0.05)(B, Hkv, Sk, D)),
    }

def reference(q, k, v):
    B, Hq, Sq, D = q.shape
    Hkv = k.shape[1]
    rep = Hq // Hkv
    k = (lambda x, n, axis: torch.repeat_interleave(x, n, dim=axis))(k, rep, axis=1)
    v = (lambda x, n, axis: torch.repeat_interleave(x, n, dim=axis))(v, rep, axis=1)
    scale = D ** -0.5
    scores = torch.einsum("bhqd,bhkd->bhqk", q, k) * scale
    p = _softmax(scores, axis=-1)
    return torch.einsum("bhqk,bhkd->bhqd", p, v)
```

```asm
; @launch grid=(256,1,1) block=(256,1,1) lds=135232
.amdgcn_target "amdgcn-amd-amdhsa--gfx950"
.text
.globl standalone__gqa_softmax__near_ridge_kernel
.p2align 8
.type standalone__gqa_softmax__near_ridge_kernel,@function
standalone__gqa_softmax__near_ridge_kernel:
  s_cmp_lt_u32 s2, 256
  s_cbranch_scc1 L_go
  s_endpgm
L_go:
  s_load_dwordx4 s[32:35], s[0:1], 0
  s_load_dwordx4 s[36:39], s[0:1], 16
  s_getpc_b64 s[52:53]
  s_lshr_b32 s54, s2, 3
  s_lshl_b32 s54, s54, 12
  v_lshlrev_b32 v1, 4, v0
  v_add_u32 v1, s54, v1
  v_min_u32 v1, L_fallback-L_go, v1
  v_mov_b32 v3, s53
  v_add_co_u32 v2, vcc, s52, v1
  s_nop 1
  v_addc_co_u32 v3, vcc, 0, v3, vcc
  global_load_dwordx4 v[80:83], v[2:3], off
  v_lshrrev_b32 v10, 6, v0
  v_and_b32 v12, 63, v0
  v_readfirstlane_b32 s41, v10
  s_and_b32 s42, s2, 7
  s_lshr_b32 s43, s2, 5
  s_lshl_b32 s42, s42, 5
  s_lshl_b32 s43, s43, 2
  s_or_b32 s40, s42, s43
  s_bfe_u32 s44, s2, 0x20003
  v_and_b32 v13, 15, v12
  v_lshrrev_b32 v14, 4, v12
  v_lshlrev_b32 v9, 11, v14
  v_lshl_add_u32 v9, v13, 4, v9
  v_lshlrev_b32 v4, 4, v12
  v_lshl_add_u32 v4, v10, 11, v4
  s_lshl_b32 s44, s44, 16
  v_lshl_add_u32 v9, v10, 14, v9
  v_add_u32 v5, s44, v9
  s_mul_i32 s48, s41, 16896
  s_add_u32 s48, s48, 67584
  s_mul_i32 s22, s41, 2112
  s_add_u32 s23, s22, 33792
  s_lshl_b32 s20, s40, 17
  s_mov_b32 s21, s20
  s_mul_i32 s45, s40, 253952
  s_mov_b32 s6, 33554432
  s_mov_b32 s7, 0x20000
  s_mov_b32 s10, 33554432
  s_mov_b32 s11, 0x20000
  s_mov_b32 s14, 253952
  s_mov_b32 s15, 0x20000
  s_mov_b32 s18, 253952
  s_mov_b32 s19, 0x20000
  s_mov_b32 s49, 253952
  s_mov_b32 s24, 0
  s_mov_b32 s25, 8192
  s_waitcnt lgkmcnt(0)
  s_mov_b32 s4, s34
  s_mov_b32 s5, s35
  s_mov_b32 s8, s36
  s_mov_b32 s9, s37
  s_add_u32 s12, s32, s45
  s_addc_u32 s13, s33, 0
  s_add_u32 s16, s38, s45
  s_addc_u32 s17, s39, 0
 s_add_u32 m0, s48, 0
 s_nop 0
 buffer_load_dwordx4 v5, s[12:15], 0 offen nt lds
 s_add_u32 m0, s48, 800
 s_nop 0
 buffer_load_dwordx4 v5, s[12:15], 0 offen offset:256 nt lds
 s_add_u32 m0, s48, 1600
 s_nop 0
 buffer_load_dwordx4 v5, s[12:15], 0 offen offset:512 nt lds
 s_add_u32 m0, s48, 2400
 s_nop 0
 buffer_load_dwordx4 v5, s[12:15], 0 offen offset:768 nt lds
 s_add_u32 m0, s48, 3200
 s_nop 0
 buffer_load_dwordx4 v5, s[12:15], 0 offen offset:1024 nt lds
 s_add_u32 m0, s48, 4000
 s_nop 0
 buffer_load_dwordx4 v5, s[12:15], 0 offen offset:1280 nt lds
 s_add_u32 m0, s48, 4800
 s_nop 0
 buffer_load_dwordx4 v5, s[12:15], 0 offen offset:1536 nt lds
 s_add_u32 m0, s48, 5600
 s_nop 0
 buffer_load_dwordx4 v5, s[12:15], 0 offen offset:1792 nt lds
 s_add_u32 m0, s22, 0
 s_nop 0
 buffer_load_dwordx4 v4, s[4:7], s20 offen nt lds
 s_add_u32 m0, s22, 32
 s_nop 0
 buffer_load_dwordx4 v4, s[4:7], s20 offen offset:1024 nt lds
 s_add_u32 s20, s20, 8192
 s_add_u32 m0, s22, 8448
 s_nop 0
 buffer_load_dwordx4 v4, s[4:7], s20 offen nt lds
 s_add_u32 m0, s22, 8480
 s_nop 0
 buffer_load_dwordx4 v4, s[4:7], s20 offen offset:1024 nt lds
 s_add_u32 s20, s20, 8192
  v_and_b32 v9, 7, v12
  v_mul_u32_u24 v9, 1056, v9
  v_bfe_u32 v11, v12, 3, 1
  v_lshl_add_u32 v9, v11, 8, v9
  v_lshl_add_u32 v1, v14, 4, v9
  v_add_u32 v3, s48, v1
  v_bfe_u32 v11, v12, 2, 1
  v_lshl_add_u32 v9, v11, 4, v9
  v_lshl_add_u32 v9, v14, 4, v9
  v_add_u32 v6, s48, v9
  v_lshlrev_b32 v9, 4, v12
  v_add_u32 v7, s48, v9
  v_bfe_u32 v9, v12, 3, 2
  v_mul_u32_u24 v9, 2112, v9
  v_bfe_u32 v11, v12, 2, 1
  v_mul_u32_u24 v11, 1032, v11
  v_add_u32 v9, v9, v11
  v_lshrrev_b32 v11, 5, v12
  v_lshl_add_u32 v9, v11, 8, v9
  v_and_b32 v11, 3, v12
  v_lshl_add_u32 v9, v11, 4, v9
  v_add_u32 v2, 33792, v9
  v_lshrrev_b32 v11, 5, v12
  v_mul_u32_u24 v9, 1056, v11
  v_and_b32 v15, 31, v12
  v_lshl_add_u32 v9, v15, 4, v9
  v_add_u32 v240, s48, v9
  v_lshlrev_b32 v9, 12, v11
  v_sub_u32 v9, v5, v9
  v_lshl_add_u32 v241, v11, 8, v9
  s_mov_b32 s55, 12288
  v_and_b32 v11, 1, v12
  v_mul_u32_u24 v11, 0xaaaa, v11
  v_add_u32 v11, 0x4444, v11
  v_lshl_add_u32 v242, v11, 16, v11
  v_bfe_u32 v9, v12, 1, 1
  v_add_u32 v9, -1, v9
  v_and_b32 v9, 0x3f803f80, v9
  v_accvgpr_write_b32 a132, 0
  v_accvgpr_write_b32 a133, 0
  v_accvgpr_write_b32 a134, 0
  v_accvgpr_write_b32 a135, 0
  v_accvgpr_write_b32 a136, 0
  v_accvgpr_write_b32 a137, 0
  v_accvgpr_write_b32 a138, 0
  v_accvgpr_write_b32 a139, 0
  v_accvgpr_write_b32 a140, 0
  v_accvgpr_write_b32 a141, 0
  v_accvgpr_write_b32 a142, 0
  v_accvgpr_write_b32 a143, 0
  v_accvgpr_write_b32 a144, 0
  v_accvgpr_write_b32 a145, 0
  v_accvgpr_write_b32 a146, 0
  v_accvgpr_write_b32 a147, 0
  v_accvgpr_write_b32 a128, v9
  v_accvgpr_write_b32 a129, v9
  v_accvgpr_write_b32 a130, v9
  v_accvgpr_write_b32 a131, v9
  s_mov_b32 s46, 0x3e0293ee
  s_mov_b32 s47, 0x3e0293ee
  s_mov_b32 s27, 0xffff0000
  s_mov_b64 s[28:29], 0
  s_mov_b32 s30, 0x27800000
  s_mov_b32 s31, 0x30000000
  s_cmp_eq_u32 s41, 0
  s_cbranch_scc1 L_pad0
  s_cmp_eq_u32 s41, 1
  s_cbranch_scc1 L_pad1
  s_cmp_eq_u32 s41, 2
  s_cbranch_scc1 L_pad2
  s_cmp_eq_u32 s2, s2
  s_branch L_pad3
.p2align 12
L_p1:
  s_nop 0
 s_add_u32 m0, s23, 0
 s_nop 0
 buffer_load_dwordx4 v4, s[8:11], s21 offen nt lds
 s_add_u32 m0, s23, 8
 s_nop 0
 buffer_load_dwordx4 v4, s[8:11], s21 offen offset:1024 nt lds
 s_add_u32 s21, s21, 8192
 s_add_u32 m0, s23, 8448
 s_nop 0
 buffer_load_dwordx4 v4, s[8:11], s21 offen nt lds
 s_add_u32 m0, s23, 8456
 s_nop 0
 buffer_load_dwordx4 v4, s[8:11], s21 offen offset:1024 nt lds
 s_add_u32 s21, s21, 8192
 s_add_u32 m0, s48, 8448
 s_nop 0
 buffer_load_dwordx4 v5, s[12:15], s25 offen nt lds
 s_add_u32 m0, s48, 9248
 s_nop 0
 buffer_load_dwordx4 v5, s[12:15], s25 offen offset:256 nt lds
 s_add_u32 m0, s48, 10048
 s_nop 0
 buffer_load_dwordx4 v5, s[12:15], s25 offen offset:512 nt lds
 s_add_u32 m0, s48, 10848
 s_nop 0
 buffer_load_dwordx4 v5, s[12:15], s25 offen offset:768 nt lds
 s_waitcnt vmcnt(10)
 ds_read_b128 v[208:211], v3 offset:0
 ds_read_b128 v[212:215], v3 offset:64
 ds_read_b128 v[216:219], v3 offset:128
 ds_read_b128 v[220:223], v3 offset:192
 ds_read_b128 a[164:167], v3 offset:512
 ds_read_b128 a[168:171], v3 offset:576
 ds_read_b128 a[172:175], v3 offset:640
 ds_read_b128 a[176:179], v3 offset:704
 s_waitcnt lgkmcnt(7)
 v_lshlrev_b32 v12, 16, v208
 v_and_b32 v13, s27, v208
 v_lshlrev_b32 v14, 16, v209
 v_and_b32_e64 v15, s27, v209
 v_pk_mul_f32 v[12:13], v[12:13], s[46:47]
 v_pk_mul_f32 v[14:15], v[14:15], s[46:47]
 v_cvt_pk_bf16_f32 v208, v12, v13
 v_cvt_pk_bf16_f32 v209, v14, v15
 v_lshlrev_b32 v12, 16, v210
 v_and_b32 v13, s27, v210
 v_lshlrev_b32 v14, 16, v211
 v_and_b32 v15, s27, v211
 v_pk_mul_f32 v[12:13], v[12:13], s[46:47]
 v_pk_mul_f32 v[14:15], v[14:15], s[46:47]
 v_cvt_pk_bf16_f32 v210, v12, v13
 v_cvt_pk_bf16_f32 v211, v14, v15
 s_waitcnt vmcnt(8)
 s_barrier
 ds_read_b128 a[0:3], v1 offset:0
 ds_read_b128 a[4:7], v1 offset:64
 ds_read_b128 a[8:11], v1 offset:128
 ds_read_b128 a[12:15], v1 offset:192
 ds_read_b128 a[16:19], v1 offset:512
 ds_read_b128 a[20:23], v1 offset:576
 ds_read_b128 a[24:27], v1 offset:640
 ds_read_b128 a[28:31], v1 offset:704
 s_waitcnt lgkmcnt(14)
 v_lshlrev_b32 v12, 16, v212
 v_and_b32 v13, s27, v212
 v_lshlrev_b32 v14, 16, v213
 v_and_b32_e64 v15, s27, v213
 v_pk_mul_f32 v[12:13], v[12:13], s[46:47]
 v_pk_mul_f32 v[14:15], v[14:15], s[46:47]
 v_cvt_pk_bf16_f32 v212, v12, v13
 v_cvt_pk_bf16_f32 v213, v14, v15
 v_lshlrev_b32 v12, 16, v214
 v_and_b32 v13, s27, v214
 v_lshlrev_b32 v14, 16, v215
 v_and_b32 v15, s27, v215
 v_pk_mul_f32 v[12:13], v[12:13], s[46:47]
 v_pk_mul_f32 v[14:15], v[14:15], s[46:47]
 v_cvt_pk_bf16_f32 v214, v12, v13
 v_cvt_pk_bf16_f32 v215, v14, v15
 s_waitcnt lgkmcnt(13)
 v_lshlrev_b32 v12, 16, v216
 v_and_b32 v13, s27, v216
 v_lshlrev_b32 v14, 16, v217
 v_and_b32_e64 v15, s27, v217
 v_pk_mul_f32 v[12:13], v[12:13], s[46:47]
 v_pk_mul_f32 v[14:15], v[14:15], s[46:47]
 v_cvt_pk_bf16_f32 v216, v12, v13
 v_cvt_pk_bf16_f32 v217, v14, v15
 v_lshlrev_b32 v12, 16, v218
 v_and_b32 v13, s27, v218
 v_lshlrev_b32 v14, 16, v219
 v_and_b32 v15, s27, v219
 v_pk_mul_f32 v[12:13], v[12:13], s[46:47]
 v_pk_mul_f32 v[14:15], v[14:15], s[46:47]
 v_cvt_pk_bf16_f32 v218, v12, v13
 v_cvt_pk_bf16_f32 v219, v14, v15
 s_waitcnt lgkmcnt(12)
 v_lshlrev_b32 v12, 16, v220
 v_and_b32 v13, s27, v220
 v_lshlrev_b32 v14, 16, v221
 v_and_b32_e64 v15, s27, v221
 v_pk_mul_f32 v[12:13], v[12:13], s[46:47]
 v_pk_mul_f32 v[14:15], v[14:15], s[46:47]
 v_cvt_pk_bf16_f32 v220, v12, v13
 v_cvt_pk_bf16_f32 v221, v14, v15
 v_lshlrev_b32 v12, 16, v222
 v_and_b32 v13, s27, v222
 v_lshlrev_b32 v14, 16, v223
 v_and_b32 v15, s27, v223
 v_pk_mul_f32 v[12:13], v[12:13], s[46:47]
 v_pk_mul_f32 v[14:15], v[14:15], s[46:47]
 v_cvt_pk_bf16_f32 v222, v12, v13
 v_cvt_pk_bf16_f32 v223, v14, v15
 s_waitcnt lgkmcnt(0)
 v_mfma_f32_16x16x32_bf16 v[16:19], a[0:3], v[208:211], 0
 ds_read_b128 a[32:35], v1 offset:8448
 ds_read_b128 a[36:39], v1 offset:8512
 v_mfma_f32_16x16x32_bf16 v[16:19], a[4:7], v[212:215], v[16:19]
 ds_read_b128 a[40:43], v1 offset:8576
 ds_read_b128 a[44:47], v1 offset:8640
 v_mfma_f32_16x16x32_bf16 v[16:19], a[8:11], v[216:219], v[16:19]
 ds_read_b128 a[48:51], v1 offset:8960
 ds_read_b128 a[52:55], v1 offset:9024
 v_mfma_f32_16x16x32_bf16 v[16:19], a[12:15], v[220:223], v[16:19]
 ds_read_b128 a[56:59], v1 offset:9088
 ds_read_b128 a[60:63], v1 offset:9152
 v_mfma_f32_16x16x32_bf16 v[20:23], a[16:19], v[208:211], 0
 s_add_u32 m0, s48, 11648
 v_mfma_f32_16x16x32_bf16 v[20:23], a[20:23], v[212:215], v[20:23]
 buffer_load_dwordx4 v5, s[12:15], s25 offen offset:1024 nt lds
 v_mfma_f32_16x16x32_bf16 v[20:23], a[24:27], v[216:219], v[20:23]
 v_mfma_f32_16x16x32_bf16 v[20:23], a[28:31], v[220:223], v[20:23]
 s_add_u32 m0, s48, 12448
 v_exp_f32 v16, v16
 v_mfma_f32_16x16x32_bf16 v[24:27], a[0:3], a[164:167], 0
 buffer_load_dwordx4 v5, s[12:15], s25 offen offset:1280 nt lds
 v_mfma_f32_16x16x32_bf16 v[24:27], a[4:7], a[168:171], v[24:27]
 v_exp_f32 v17, v17
 v_mfma_f32_16x16x32_bf16 v[24:27], a[8:11], a[172:175], v[24:27]
 s_add_u32 m0, s48, 13248
 v_exp_f32 v18, v18
 v_mfma_f32_16x16x32_bf16 v[24:27], a[12:15], a[176:179], v[24:27]
 buffer_load_dwordx4 v5, s[12:15], s25 offen offset:1536 nt lds
 v_mfma_f32_16x16x32_bf16 v[28:31], a[16:19], a[164:167], 0
 v_exp_f32 v19, v19
 v_mfma_f32_16x16x32_bf16 v[28:31], a[20:23], a[168:171], v[28:31]
 s_add_u32 m0, s48, 14048
 v_exp_f32 v20, v20
 v_mfma_f32_16x16x32_bf16 v[28:31], a[24:27], a[172:175], v[28:31]
 s_waitcnt lgkmcnt(0)
 buffer_load_dwordx4 v5, s[12:15], s25 offen offset:1792 nt lds
 v_mfma_f32_16x16x32_bf16 v[28:31], a[28:31], a[176:179], v[28:31]
 s_add_u32 s12, s12, 253952
 s_addc_u32 s13, s13, 0
 v_mul_f32 v24, s46, v24
 v_mfma_f32_16x16x32_bf16 v[32:35], a[32:35], v[208:211], 0
 s_add_u32 m0, s22, 16896
 v_exp_f32 v21, v21
 v_mfma_f32_16x16x32_bf16 v[32:35], a[36:39], v[212:215], v[32:35]
 buffer_load_dwordx4 v4, s[4:7], s20 offen nt lds
 v_mfma_f32_16x16x32_bf16 v[32:35], a[40:43], v[216:219], v[32:35]
 v_exp_f32 v22, v22
 v_mfma_f32_16x16x32_bf16 v[32:35], a[44:47], v[220:223], v[32:35]
 s_add_u32 m0, s22, 16928
 v_exp_f32 v23, v23
 v_mfma_f32_16x16x32_bf16 v[36:39], a[48:51], v[208:211], 0
 buffer_load_dwordx4 v4, s[4:7], s20 offen offset:1024 nt lds
 v_mfma_f32_16x16x32_bf16 v[36:39], a[52:55], v[212:215], v[36:39]
 s_add_u32 s20, s20, 8192
 v_exp_f32 v24, v24
 v_mfma_f32_16x16x32_bf16 v[36:39], a[56:59], v[216:219], v[36:39]
 s_add_u32 m0, s22, 25344
 v_mul_f32 v25, s46, v25
 v_mul_f32 v26, s46, v26
 v_mfma_f32_16x16x32_bf16 v[36:39], a[60:63], v[220:223], v[36:39]
 buffer_load_dwordx4 v4, s[4:7], s20 offen nt lds
 v_mfma_f32_16x16x32_bf16 v[40:43], a[32:35], a[164:167], 0
 v_exp_f32 v25, v25
 v_mfma_f32_16x16x32_bf16 v[40:43], a[36:39], a[168:171], v[40:43]
 s_add_u32 m0, s22, 25376
 v_exp_f32 v26, v26
 v_mfma_f32_16x16x32_bf16 v[40:43], a[40:43], a[172:175], v[40:43]
 buffer_load_dwordx4 v4, s[4:7], s20 offen offset:1024 nt lds
 v_mfma_f32_16x16x32_bf16 v[40:43], a[44:47], a[176:179], v[40:43]
 s_add_u32 s20, s20, 8192
 v_mul_f32 v27, s46, v27
 v_mul_f32 v28, s46, v28
 v_mfma_f32_16x16x32_bf16 v[44:47], a[48:51], a[164:167], 0
 s_add_u32 m0, s23, 16896
 v_exp_f32 v27, v27
 v_mfma_f32_16x16x32_bf16 v[44:47], a[52:55], a[168:171], v[44:47]
 buffer_load_dwordx4 v4, s[8:11], s21 offen nt lds
 v_mfma_f32_16x16x32_bf16 v[44:47], a[56:59], a[172:175], v[44:47]
 v_exp_f32 v28, v28
 v_mfma_f32_16x16x32_bf16 v[44:47], a[60:63], a[176:179], v[44:47]
 v_mul_f32 v29, s46, v29
 v_mul_f32 v30, s46, v30
 s_waitcnt vmcnt(13) lgkmcnt(0)
 s_barrier
 v_mul_f32 v31, s46, v31
 v_mul_f32 v40, s46, v40
 v_mul_f32 v41, s46, v41
 v_mul_f32 v42, s46, v42
 v_mul_f32 v43, s46, v43
 v_mul_f32 v44, s46, v44
 v_mul_f32 v45, s46, v45
 v_mul_f32 v46, s46, v46
 v_mul_f32 v47, s46, v47
 v_exp_f32 v29, v29
 v_exp_f32 v30, v30
 v_exp_f32 v31, v31
 v_exp_f32 v32, v32
 v_exp_f32 v33, v33
 v_exp_f32 v34, v34
 v_exp_f32 v35, v35
 v_exp_f32 v36, v36
 v_exp_f32 v37, v37
 v_exp_f32 v38, v38
 v_exp_f32 v39, v39
 v_exp_f32 v40, v40
 v_exp_f32 v41, v41
 v_exp_f32 v42, v42
 v_exp_f32 v43, v43
 v_exp_f32 v44, v44
 v_exp_f32 v45, v45
 v_exp_f32 v46, v46
 v_exp_f32 v47, v47
 v_cvt_pk_bf16_f32 v48, v16, v17
 v_cvt_pk_bf16_f32 v49, v18, v19
 v_cvt_pk_bf16_f32 v50, v20, v21
 v_cvt_pk_bf16_f32 v51, v22, v23
 v_cvt_pk_bf16_f32 v56, v24, v25
 v_cvt_pk_bf16_f32 v57, v26, v27
 v_cvt_pk_bf16_f32 v58, v28, v29
 v_cvt_pk_bf16_f32 v59, v30, v31
 v_cvt_pk_bf16_f32 v52, v32, v33
 v_cvt_pk_bf16_f32 v53, v34, v35
 v_cvt_pk_bf16_f32 v54, v36, v37
 v_cvt_pk_bf16_f32 v55, v38, v39
 v_cvt_pk_bf16_f32 v60, v40, v41
 v_cvt_pk_bf16_f32 v61, v42, v43
 v_cvt_pk_bf16_f32 v62, v44, v45
 v_cvt_pk_bf16_f32 v63, v46, v47
 ds_read_b64_tr_b16 a[64:65], v2 offset:0
 ds_read_b64_tr_b16 a[66:67], v2 offset:512
 ds_read_b64_tr_b16 a[96:97], v2 offset:8448
 ds_read_b64_tr_b16 a[98:99], v2 offset:8960
 ds_read_b64_tr_b16 a[68:69], v2 offset:8
 ds_read_b64_tr_b16 a[70:71], v2 offset:520
 ds_read_b64_tr_b16 a[100:101], v2 offset:8456
 ds_read_b64_tr_b16 a[102:103], v2 offset:8968
 ds_read_b64_tr_b16 a[72:73], v2 offset:64
 ds_read_b64_tr_b16 a[74:75], v2 offset:576
 ds_read_b64_tr_b16 a[104:105], v2 offset:8512
 ds_read_b64_tr_b16 a[106:107], v2 offset:9024
 ds_read_b64_tr_b16 a[76:77], v2 offset:72
 ds_read_b64_tr_b16 a[78:79], v2 offset:584
 ds_read_b64_tr_b16 a[108:109], v2 offset:8520
 ds_read_b64_tr_b16 a[110:111], v2 offset:9032
 ds_read_b64_tr_b16 a[80:81], v2 offset:128
 ds_read_b64_tr_b16 a[82:83], v2 offset:640
 ds_read_b64_tr_b16 a[112:113], v2 offset:8576
 ds_read_b64_tr_b16 a[114:115], v2 offset:9088
 ds_read_b64_tr_b16 a[84:85], v2 offset:136
 ds_read_b64_tr_b16 a[86:87], v2 offset:648
 ds_read_b64_tr_b16 a[116:117], v2 offset:8584
 ds_read_b64_tr_b16 a[118:119], v2 offset:9096
 ds_read_b64_tr_b16 a[88:89], v2 offset:192
 ds_read_b64_tr_b16 a[90:91], v2 offset:704
 ds_read_b64_tr_b16 a[120:121], v2 offset:8640
 ds_read_b64_tr_b16 a[122:123], v2 offset:9152
 ds_read_b64_tr_b16 a[92:93], v2 offset:200
 ds_read_b64_tr_b16 a[94:95], v2 offset:712
 ds_read_b64_tr_b16 a[124:125], v2 offset:8648
 ds_read_b64_tr_b16 a[126:127], v2 offset:9160
 v_smfmac_f32_16x16x64_bf16 a[132:135], a[128:131], v[48:55], v242
 s_add_u32 m0, s23, 16904
 v_smfmac_f32_16x16x64_bf16 a[136:139], a[128:131], v[56:63], v242
 s_waitcnt lgkmcnt(14)
 buffer_load_dwordx4 v4, s[8:11], s21 offen offset:1024 nt lds
 v_mfma_f32_16x16x32_bf16 v[80:83], a[64:67], v[48:51], 0
 s_add_u32 s21, s21, 8192
 v_mfma_f32_16x16x32_bf16 v[80:83], a[96:99], v[52:55], v[80:83]
 s_add_u32 m0, s23, 25344
 v_mfma_f32_16x16x32_bf16 v[112:115], a[64:67], v[56:59], 0
 buffer_load_dwordx4 v4, s[8:11], s21 offen nt lds
 v_mfma_f32_16x16x32_bf16 v[112:115], a[96:99], v[60:63], v[112:115]
 v_mfma_f32_16x16x32_bf16 v[84:87], a[68:71], v[48:51], 0
 s_add_u32 m0, s23, 25352
 v_mfma_f32_16x16x32_bf16 v[84:87], a[100:103], v[52:55], v[84:87]
 buffer_load_dwordx4 v4, s[8:11], s21 offen offset:1024 nt lds
 v_mfma_f32_16x16x32_bf16 v[116:119], a[68:71], v[56:59], 0
 s_add_u32 s21, s21, 8192
 v_mfma_f32_16x16x32_bf16 v[116:119], a[100:103], v[60:63], v[116:119]
 v_mfma_f32_16x16x32_bf16 v[88:91], a[72:75], v[48:51], 0
 v_mfma_f32_16x16x32_bf16 v[88:91], a[104:107], v[52:55], v[88:91]
 v_mfma_f32_16x16x32_bf16 v[120:123], a[72:75], v[56:59], 0
 v_mfma_f32_16x16x32_bf16 v[120:123], a[104:107], v[60:63], v[120:123]
 v_mfma_f32_16x16x32_bf16 v[92:95], a[76:79], v[48:51], 0
 v_mfma_f32_16x16x32_bf16 v[92:95], a[108:111], v[52:55], v[92:95]
 v_mfma_f32_16x16x32_bf16 v[124:127], a[76:79], v[56:59], 0
 v_mfma_f32_16x16x32_bf16 v[124:127], a[108:111], v[60:63], v[124:127]
 s_waitcnt lgkmcnt(8)
 v_mfma_f32_16x16x32_bf16 v[96:99], a[80:83], v[48:51], 0
 v_mfma_f32_16x16x32_bf16 v[96:99], a[112:115], v[52:55], v[96:99]
 v_mfma_f32_16x16x32_bf16 v[128:131], a[80:83], v[56:59], 0
 v_mfma_f32_16x16x32_bf16 v[128:131], a[112:115], v[60:63], v[128:131]
 v_mfma_f32_16x16x32_bf16 v[100:103], a[84:87], v[48:51], 0
 v_mfma_f32_16x16x32_bf16 v[100:103], a[116:119], v[52:55], v[100:103]
 v_mfma_f32_16x16x32_bf16 v[132:135], a[84:87], v[56:59], 0
 v_mfma_f32_16x16x32_bf16 v[132:135], a[116:119], v[60:63], v[132:135]
 s_waitcnt lgkmcnt(0)
 v_mfma_f32_16x16x32_bf16 v[104:107], a[88:91], v[48:51], 0
 v_mfma_f32_16x16x32_bf16 v[104:107], a[120:123], v[52:55], v[104:107]
 v_mfma_f32_16x16x32_bf16 v[136:139], a[88:91], v[56:59], 0
 v_mfma_f32_16x16x32_bf16 v[136:139], a[120:123], v[60:63], v[136:139]
 v_mfma_f32_16x16x32_bf16 v[108:111], a[92:95], v[48:51], 0
 v_mfma_f32_16x16x32_bf16 v[108:111], a[124:127], v[52:55], v[108:111]
 v_mfma_f32_16x16x32_bf16 v[140:143], a[92:95], v[56:59], 0
 v_mfma_f32_16x16x32_bf16 v[140:143], a[124:127], v[60:63], v[140:143]
 s_waitcnt vmcnt(8)
 ds_read_b128 v[224:227], v3 offset:8448
 ds_read_b128 v[228:231], v3 offset:8512
 ds_read_b128 v[232:235], v3 offset:8576
 ds_read_b128 v[236:239], v3 offset:8640
 ds_read_b128 a[180:183], v3 offset:8960
 ds_read_b128 a[184:187], v3 offset:9024
 ds_read_b128 a[188:191], v3 offset:9088
 ds_read_b128 a[192:195], v3 offset:9152
 s_waitcnt lgkmcnt(7)
 v_lshlrev_b32 v12, 16, v224
 v_and_b32 v13, s27, v224
 v_lshlrev_b32 v14, 16, v225
 v_and_b32 v15, s27, v225
 v_pk_mul_f32 v[12:13], v[12:13], s[46:47]
 v_pk_mul_f32 v[14:15], v[14:15], s[46:47]
 v_cvt_pk_bf16_f32 v224, v12, v13
 v_cvt_pk_bf16_f32 v225, v14, v15
 v_lshlrev_b32 v12, 16, v226
 v_and_b32 v13, s27, v226
 v_lshlrev_b32 v14, 16, v227
 v_and_b32 v15, s27, v227
 v_pk_mul_f32 v[12:13], v[12:13], s[46:47]
 v_pk_mul_f32 v[14:15], v[14:15], s[46:47]
 v_cvt_pk_bf16_f32 v226, v12, v13
 v_cvt_pk_bf16_f32 v227, v14, v15
 s_waitcnt lgkmcnt(6)
 v_lshlrev_b32 v12, 16, v228
 v_and_b32 v13, s27, v228
 v_lshlrev_b32 v14, 16, v229
 v_and_b32_e64 v15, s27, v229
 v_pk_mul_f32 v[12:13], v[12:13], s[46:47]
 v_pk_mul_f32 v[14:15], v[14:15], s[46:47]
 v_cvt_pk_bf16_f32 v228, v12, v13
 v_cvt_pk_bf16_f32 v229, v14, v15
 v_lshlrev_b32 v12, 16, v230
 v_and_b32 v13, s27, v230
 v_lshlrev_b32 v14, 16, v231
 v_and_b32 v15, s27, v231
 v_pk_mul_f32 v[12:13], v[12:13], s[46:47]
 v_pk_mul_f32 v[14:15], v[14:15], s[46:47]
 v_cvt_pk_bf16_f32 v230, v12, v13
 v_cvt_pk_bf16_f32 v231, v14, v15
 v_mfma_f32_16x16x32_bf16 v[16:19], a[0:3], v[224:227], 0
 s_waitcnt lgkmcnt(5)
 v_lshlrev_b32 v12, 16, v232
 v_and_b32 v13, s27, v232
 v_lshlrev_b32 v14, 16, v233
 v_and_b32_e64 v15, s27, v233
 v_pk_mul_f32 v[12:13], v[12:13], s[46:47]
 v_pk_mul_f32 v[14:15], v[14:15], s[46:47]
 v_cvt_pk_bf16_f32 v232, v12, v13
 v_cvt_pk_bf16_f32 v233, v14, v15
 v_lshlrev_b32 v12, 16, v234
 v_and_b32 v13, s27, v234
 v_lshlrev_b32 v14, 16, v235
 v_and_b32 v15, s27, v235
 v_pk_mul_f32 v[12:13], v[12:13], s[46:47]
 v_pk_mul_f32 v[14:15], v[14:15], s[46:47]
 v_cvt_pk_bf16_f32 v234, v12, v13
 v_cvt_pk_bf16_f32 v235, v14, v15
 v_mfma_f32_16x16x32_bf16 v[16:19], a[4:7], v[228:231], v[16:19]
 s_waitcnt lgkmcnt(4)
 v_lshlrev_b32 v12, 16, v236
 v_and_b32 v13, s27, v236
 v_lshlrev_b32 v14, 16, v237
 v_and_b32_e64 v15, s27, v237
 v_pk_mul_f32 v[12:13], v[12:13], s[46:47]
 v_pk_mul_f32 v[14:15], v[14:15], s[46:47]
 v_cvt_pk_bf16_f32 v236, v12, v13
 v_cvt_pk_bf16_f32 v237, v14, v15
 v_lshlrev_b32 v12, 16, v238
 v_and_b32 v13, s27, v238
 v_lshlrev_b32 v14, 16, v239
 v_and_b32 v15, s27, v239
 v_pk_mul_f32 v[12:13], v[12:13], s[46:47]
 v_pk_mul_f32 v[14:15], v[14:15], s[46:47]
 v_cvt_pk_bf16_f32 v238, v12, v13
 v_cvt_pk_bf16_f32 v239, v14, v15
 v_mfma_f32_16x16x32_bf16 v[16:19], a[8:11], v[232:235], v[16:19]
 s_add_u32 m0, s22, 0
 v_mfma_f32_16x16x32_bf16 v[16:19], a[12:15], v[236:239], v[16:19]
 buffer_load_dwordx4 v4, s[4:7], s20 offen nt lds
 v_mfma_f32_16x16x32_bf16 v[20:23], a[16:19], v[224:227], 0
 v_mfma_f32_16x16x32_bf16 v[20:23], a[20:23], v[228:231], v[20:23]
 s_waitcnt lgkmcnt(0)
 s_waitcnt vmcnt(5) lgkmcnt(8)
 s_barrier
 v_mfma_f32_16x16x32_bf16 v[20:23], a[24:27], v[232:235], v[20:23]
 v_mfma_f32_16x16x32_bf16 v[20:23], a[28:31], v[236:239], v[20:23]
 s_add_u32 m0, s22, 32
 v_exp_f32 v16, v16
 v_mfma_f32_16x16x32_bf16 v[24:27], a[0:3], a[180:183], 0
 buffer_load_dwordx4 v4, s[4:7], s20 offen offset:1024 nt lds
 v_mfma_f32_16x16x32_bf16 v[24:27], a[4:7], a[184:187], v[24:27]
 s_add_u32 s20, s20, 8192
 v_exp_f32 v17, v17
 v_mfma_f32_16x16x32_bf16 v[24:27], a[8:11], a[188:191], v[24:27]
 s_add_u32 m0, s22, 8448
 ds_read_b128 a[0:3], v1 offset:16896
 v_cvt_pk_bf16_f32 v64, v16, v17
 v_mfma_f32_16x16x32_bf16 v[24:27], a[12:15], a[192:195], v[24:27]
 buffer_load_dwordx4 v4, s[4:7], s20 offen nt lds
 v_mfma_f32_16x16x32_bf16 v[28:31], a[16:19], a[180:183], 0
 ds_read_b128 a[4:7], v1 offset:16960
 v_mfma_f32_16x16x32_bf16 v[28:31], a[20:23], a[184:187], v[28:31]
 s_add_u32 m0, s22, 8480
 v_exp_f32 v18, v18
 v_mfma_f32_16x16x32_bf16 v[28:31], a[24:27], a[188:191], v[28:31]
 buffer_load_dwordx4 v4, s[4:7], s20 offen offset:1024 nt lds
 ds_read_b128 a[8:11], v1 offset:17024
 v_mfma_f32_16x16x32_bf16 v[28:31], a[28:31], a[192:195], v[28:31]
 s_add_u32 s20, s20, 8192
 v_exp_f32 v19, v19
 v_mfma_f32_16x16x32_bf16 v[32:35], a[32:35], v[224:227], 0
 s_add_u32 m0, s23, 0
 ds_read_b128 a[12:15], v1 offset:17088
 v_cvt_pk_bf16_f32 v65, v18, v19
 v_mfma_f32_16x16x32_bf16 v[32:35], a[36:39], v[228:231], v[32:35]
 buffer_load_dwordx4 v4, s[8:11], s21 offen nt lds
 v_mfma_f32_16x16x32_bf16 v[32:35], a[40:43], v[232:235], v[32:35]
 ds_read_b128 a[16:19], v1 offset:17408
 v_mul_f32 v24, s46, v24
 v_mfma_f32_16x16x32_bf16 v[32:35], a[44:47], v[236:239], v[32:35]
 s_add_u32 m0, s23, 8
 v_exp_f32 v20, v20
 v_mfma_f32_16x16x32_bf16 v[36:39], a[48:51], v[224:227], 0
 buffer_load_dwordx4 v4, s[8:11], s21 offen offset:1024 nt lds
 ds_read_b128 a[20:23], v1 offset:17472
 v_mfma_f32_16x16x32_bf16 v[36:39], a[52:55], v[228:231], v[36:39]
 s_add_u32 s21, s21, 8192
 v_exp_f32 v21, v21
 v_mfma_f32_16x16x32_bf16 v[36:39], a[56:59], v[232:235], v[36:39]
 s_add_u32 m0, s23, 8448
 ds_read_b128 a[24:27], v1 offset:17536
 v_cvt_pk_bf16_f32 v66, v20, v21
 v_mfma_f32_16x16x32_bf16 v[36:39], a[60:63], v[236:239], v[36:39]
 buffer_load_dwordx4 v4, s[8:11], s21 offen nt lds
 v_mfma_f32_16x16x32_bf16 v[40:43], a[32:35], a[180:183], 0
 ds_read_b128 a[28:31], v1 offset:17600
 v_mul_f32 v25, s46, v25
 v_mfma_f32_16x16x32_bf16 v[40:43], a[36:39], a[184:187], v[40:43]
 s_add_u32 m0, s23, 8456
 v_exp_f32 v22, v22
 v_mfma_f32_16x16x32_bf16 v[40:43], a[40:43], a[188:191], v[40:43]
 buffer_load_dwordx4 v4, s[8:11], s21 offen offset:1024 nt lds
 ds_read_b128 a[32:35], v1 offset:25344
 v_mfma_f32_16x16x32_bf16 v[40:43], a[44:47], a[192:195], v[40:43]
 s_add_u32 s21, s21, 8192
 v_exp_f32 v23, v23
 v_mfma_f32_16x16x32_bf16 v[44:47], a[48:51], a[180:183], 0
 ds_read_b128 a[36:39], v1 offset:25408
 v_cvt_pk_bf16_f32 v67, v22, v23
 v_mfma_f32_16x16x32_bf16 v[44:47], a[52:55], a[184:187], v[44:47]
 v_exp_f32 v24, v24
 v_mfma_f32_16x16x32_bf16 v[44:47], a[56:59], a[188:191], v[44:47]
 s_waitcnt lgkmcnt(6)
 ds_read_b128 a[40:43], v1 offset:25472
 v_mul_f32 v26, s46, v26
 v_mfma_f32_16x16x32_bf16 v[44:47], a[60:63], a[192:195], v[44:47]
 v_exp_f32 v25, v25
 v_mfma_f32_16x16x32_bf16 v[16:19], a[0:3], v[208:211], 0
 ds_read_b128 a[44:47], v1 offset:25536
 v_mul_f32 v27, s46, v27
 v_mfma_f32_16x16x32_bf16 v[16:19], a[4:7], v[212:215], v[16:19]
 v_exp_f32 v26, v26
 v_mfma_f32_16x16x32_bf16 v[16:19], a[8:11], v[216:219], v[16:19]
 s_waitcnt lgkmcnt(4)
 ds_read_b128 a[48:51], v1 offset:25856
 v_cvt_pk_bf16_f32 v72, v24, v25
 v_mfma_f32_16x16x32_bf16 v[16:19], a[12:15], v[220:223], v[16:19]
 v_exp_f32 v27, v27
 v_mfma_f32_16x16x32_bf16 v[20:23], a[16:19], v[208:211], 0
 ds_read_b128 a[52:55], v1 offset:25920
 v_cvt_pk_bf16_f32 v73, v26, v27
 v_mfma_f32_16x16x32_bf16 v[20:23], a[20:23], v[212:215], v[20:23]
 v_mul_f32 v28, s46, v28
 v_mul_f32 v29, s46, v29
 v_mfma_f32_16x16x32_bf16 v[20:23], a[24:27], v[216:219], v[20:23]
 ds_read_b128 a[56:59], v1 offset:25984
 v_mul_f32 v30, s46, v30
 v_mfma_f32_16x16x32_bf16 v[20:23], a[28:31], v[220:223], v[20:23]
 v_exp_f32 v28, v28
 v_mfma_f32_16x16x32_bf16 v[24:27], a[0:3], a[164:167], 0
 ds_read_b128 a[60:63], v1 offset:26048
 v_mul_f32 v31, s46, v31
 v_mfma_f32_16x16x32_bf16 v[24:27], a[4:7], a[168:171], v[24:27]
 v_exp_f32 v29, v29
 v_mfma_f32_16x16x32_bf16 v[24:27], a[8:11], a[172:175], v[24:27]
 v_exp_f32 v30, v30
 v_exp_f32 v31, v31
 v_mfma_f32_16x16x32_bf16 v[24:27], a[12:15], a[176:179], v[24:27]
 v_cvt_pk_bf16_f32 v74, v28, v29
 v_cvt_pk_bf16_f32 v75, v30, v31
 v_mfma_f32_16x16x32_bf16 v[28:31], a[16:19], a[164:167], 0
 v_exp_f32 v32, v32
 v_mfma_f32_16x16x32_bf16 v[28:31], a[20:23], a[168:171], v[28:31]
 v_exp_f32 v33, v33
 v_mfma_f32_16x16x32_bf16 v[28:31], a[24:27], a[172:175], v[28:31]
 s_waitcnt lgkmcnt(4)
 v_exp_f32 v34, v34
 v_exp_f32 v35, v35
 v_mfma_f32_16x16x32_bf16 v[28:31], a[28:31], a[176:179], v[28:31]
 v_cvt_pk_bf16_f32 v68, v32, v33
 v_cvt_pk_bf16_f32 v69, v34, v35
 v_mfma_f32_16x16x32_bf16 v[32:35], a[32:35], v[208:211], 0
 v_exp_f32 v36, v36
 v_mfma_f32_16x16x32_bf16 v[32:35], a[36:39], v[212:215], v[32:35]
 v_exp_f32 v37, v37
 v_mfma_f32_16x16x32_bf16 v[32:35], a[40:43], v[216:219], v[32:35]
 s_waitcnt lgkmcnt(0)
 v_exp_f32 v38, v38
 v_exp_f32 v39, v39
 v_mfma_f32_16x16x32_bf16 v[32:35], a[44:47], v[220:223], v[32:35]
 v_cvt_pk_bf16_f32 v70, v36, v37
 v_cvt_pk_bf16_f32 v71, v38, v39
 v_mfma_f32_16x16x32_bf16 v[36:39], a[48:51], v[208:211], 0
 v_exp_f32 v16, v16
 v_mfma_f32_16x16x32_bf16 v[36:39], a[52:55], v[212:215], v[36:39]
 v_mul_f32 v40, s46, v40
 v_mul_f32 v41, s46, v41
 v_mul_f32 v42, s46, v42
 v_mul_f32 v43, s46, v43
 v_mfma_f32_16x16x32_bf16 v[36:39], a[56:59], v[216:219], v[36:39]
 v_exp_f32 v40, v40
 v_exp_f32 v41, v41
 v_exp_f32 v42, v42
 v_exp_f32 v43, v43
 v_mfma_f32_16x16x32_bf16 v[36:39], a[60:63], v[220:223], v[36:39]
 v_cvt_pk_bf16_f32 v76, v40, v41
 v_cvt_pk_bf16_f32 v77, v42, v43
 v_mfma_f32_16x16x32_bf16 v[40:43], a[32:35], a[164:167], 0
 v_exp_f32 v17, v17
 v_mfma_f32_16x16x32_bf16 v[40:43], a[36:39], a[168:171], v[40:43]
 v_mul_f32 v44, s46, v44
 v_mul_f32 v45, s46, v45
 v_mul_f32 v46, s46, v46
 v_mul_f32 v47, s46, v47
 v_mfma_f32_16x16x32_bf16 v[40:43], a[40:43], a[172:175], v[40:43]
 v_exp_f32 v44, v44
 v_exp_f32 v45, v45
 v_exp_f32 v46, v46
 v_exp_f32 v47, v47
 v_mfma_f32_16x16x32_bf16 v[40:43], a[44:47], a[176:179], v[40:43]
 v_cvt_pk_bf16_f32 v78, v44, v45
 v_cvt_pk_bf16_f32 v79, v46, v47
 v_mfma_f32_16x16x32_bf16 v[44:47], a[48:51], a[164:167], 0
 v_exp_f32 v18, v18
 v_mfma_f32_16x16x32_bf16 v[44:47], a[52:55], a[168:171], v[44:47]
 v_exp_f32 v19, v19
 v_mfma_f32_16x16x32_bf16 v[44:47], a[56:59], a[172:175], v[44:47]
 v_exp_f32 v20, v20
 v_mfma_f32_16x16x32_bf16 v[44:47], a[60:63], a[176:179], v[44:47]
 v_exp_f32 v21, v21
 v_smfmac_f32_16x16x64_bf16 a[140:143], a[128:131], v[64:71], v242
 s_waitcnt vmcnt(8) lgkmcnt(0)
 s_barrier
 v_smfmac_f32_16x16x64_bf16 a[144:147], a[128:131], v[72:79], v242
 s_add_u32 m0, s22, 16896
 v_cvt_pk_bf16_f32 v48, v16, v17
 v_mfma_f32_16x16x32_bf16 v[144:147], a[64:67], v[64:67], 0
 buffer_load_dwordx4 v4, s[4:7], s20 offen nt lds
 v_mfma_f32_16x16x32_bf16 v[144:147], a[96:99], v[68:71], v[144:147]
 v_exp_f32 v22, v22
 v_mfma_f32_16x16x32_bf16 v[176:179], a[64:67], v[72:75], 0
 s_add_u32 m0, s22, 16928
 v_exp_f32 v23, v23
 v_mfma_f32_16x16x32_bf16 v[176:179], a[96:99], v[76:79], v[176:179]
 buffer_load_dwordx4 v4, s[4:7], s20 offen offset:1024 nt lds
 v_mfma_f32_16x16x32_bf16 v[148:151], a[68:71], v[64:67], 0
 s_add_u32 s20, s20, 8192
 ds_read_b64_tr_b16 a[64:65], v2 offset:16896
 v_cvt_pk_bf16_f32 v49, v18, v19
 v_mfma_f32_16x16x32_bf16 v[148:151], a[100:103], v[68:71], v[148:151]
 s_add_u32 m0, s22, 25344
 ds_read_b64_tr_b16 a[66:67], v2 offset:17408
 v_cvt_pk_bf16_f32 v50, v20, v21
 v_mfma_f32_16x16x32_bf16 v[180:183], a[68:71], v[72:75], 0
 buffer_load_dwordx4 v4, s[4:7], s20 offen nt lds
 v_mfma_f32_16x16x32_bf16 v[180:183], a[100:103], v[76:79], v[180:183]
 ds_read_b64_tr_b16 a[96:97], v2 offset:25344
 v_cvt_pk_bf16_f32 v51, v22, v23
 v_mfma_f32_16x16x32_bf16 v[152:155], a[72:75], v[64:67], 0
 s_add_u32 m0, s22, 25376
 ds_read_b64_tr_b16 a[98:99], v2 offset:25856
 v_mul_f32 v24, s46, v24
 v_mfma_f32_16x16x32_bf16 v[152:155], a[104:107], v[68:71], v[152:155]
 buffer_load_dwordx4 v4, s[4:7], s20 offen offset:1024 nt lds
 v_mfma_f32_16x16x32_bf16 v[184:187], a[72:75], v[72:75], 0
 s_add_u32 s20, s20, 8192
 ds_read_b64_tr_b16 a[68:69], v2 offset:16904
 v_mul_f32 v25, s46, v25
 v_mfma_f32_16x16x32_bf16 v[184:187], a[104:107], v[76:79], v[184:187]
 ds_read_b64_tr_b16 a[70:71], v2 offset:17416
 v_mul_f32 v26, s46, v26
 v_mfma_f32_16x16x32_bf16 v[156:159], a[76:79], v[64:67], 0
L_pad0:
 s_cbranch_scc1 L_pad4
 ds_read_b64_tr_b16 a[100:101], v2 offset:25352
 v_mul_f32 v27, s46, v27
 v_mfma_f32_16x16x32_bf16 v[156:159], a[108:111], v[68:71], v[156:159]
 ds_read_b64_tr_b16 a[102:103], v2 offset:25864
 v_mul_f32 v28, s46, v28
 v_mfma_f32_16x16x32_bf16 v[188:191], a[76:79], v[72:75], 0
 ds_read_b64_tr_b16 a[72:73], v2 offset:16960
 v_mul_f32 v29, s46, v29
 v_mfma_f32_16x16x32_bf16 v[188:191], a[108:111], v[76:79], v[188:191]
 ds_read_b64_tr_b16 a[74:75], v2 offset:17472
 v_mul_f32 v30, s46, v30
 v_mfma_f32_16x16x32_bf16 v[160:163], a[80:83], v[64:67], 0
 ds_read_b64_tr_b16 a[104:105], v2 offset:25408
 v_mul_f32 v31, s46, v31
 v_mfma_f32_16x16x32_bf16 v[160:163], a[112:115], v[68:71], v[160:163]
 ds_read_b64_tr_b16 a[106:107], v2 offset:25920
 v_mul_f32 v40, s46, v40
 v_mfma_f32_16x16x32_bf16 v[192:195], a[80:83], v[72:75], 0
 ds_read_b64_tr_b16 a[76:77], v2 offset:16968
 v_mul_f32 v41, s46, v41
 v_mfma_f32_16x16x32_bf16 v[192:195], a[112:115], v[76:79], v[192:195]
 ds_read_b64_tr_b16 a[78:79], v2 offset:17480
 v_mul_f32 v42, s46, v42
 v_mfma_f32_16x16x32_bf16 v[164:167], a[84:87], v[64:67], 0
 ds_read_b64_tr_b16 a[108:109], v2 offset:25416
 v_mul_f32 v43, s46, v43
 v_mfma_f32_16x16x32_bf16 v[164:167], a[116:119], v[68:71], v[164:167]
 ds_read_b64_tr_b16 a[110:111], v2 offset:25928
 v_mul_f32 v44, s46, v44
 v_mfma_f32_16x16x32_bf16 v[196:199], a[84:87], v[72:75], 0
 ds_read_b64_tr_b16 a[80:81], v2 offset:17024
 v_mul_f32 v45, s46, v45
 v_mfma_f32_16x16x32_bf16 v[196:199], a[116:119], v[76:79], v[196:199]
 ds_read_b64_tr_b16 a[82:83], v2 offset:17536
 v_mul_f32 v46, s46, v46
 v_mfma_f32_16x16x32_bf16 v[168:171], a[88:91], v[64:67], 0
 ds_read_b64_tr_b16 a[112:113], v2 offset:25472
 v_mul_f32 v47, s46, v47
 v_mfma_f32_16x16x32_bf16 v[168:171], a[120:123], v[68:71], v[168:171]
 v_exp_f32 v24, v24
 v_mfma_f32_16x16x32_bf16 v[200:203], a[88:91], v[72:75], 0
 v_exp_f32 v25, v25
 v_mfma_f32_16x16x32_bf16 v[200:203], a[120:123], v[76:79], v[200:203]
 ds_read_b64_tr_b16 a[114:115], v2 offset:25984
 v_cvt_pk_bf16_f32 v56, v24, v25
 v_mfma_f32_16x16x32_bf16 v[172:175], a[92:95], v[64:67], 0
 v_exp_f32 v26, v26
 v_mfma_f32_16x16x32_bf16 v[172:175], a[124:127], v[68:71], v[172:175]
 v_exp_f32 v27, v27
 v_mfma_f32_16x16x32_bf16 v[204:207], a[92:95], v[72:75], 0
 ds_read_b64_tr_b16 a[84:85], v2 offset:17032
 v_cvt_pk_bf16_f32 v57, v26, v27
 v_mfma_f32_16x16x32_bf16 v[204:207], a[124:127], v[76:79], v[204:207]
 v_exp_f32 v28, v28
 v_mfma_f32_16x16x32_bf16 v[16:19], a[0:3], v[224:227], 0
 v_exp_f32 v29, v29
 v_mfma_f32_16x16x32_bf16 v[16:19], a[4:7], v[228:231], v[16:19]
 ds_read_b64_tr_b16 a[86:87], v2 offset:17544
 v_cvt_pk_bf16_f32 v58, v28, v29
 v_mfma_f32_16x16x32_bf16 v[16:19], a[8:11], v[232:235], v[16:19]
 v_exp_f32 v30, v30
 v_mfma_f32_16x16x32_bf16 v[16:19], a[12:15], v[236:239], v[16:19]
 v_exp_f32 v31, v31
 v_mfma_f32_16x16x32_bf16 v[20:23], a[16:19], v[224:227], 0
 ds_read_b64_tr_b16 a[116:117], v2 offset:25480
 v_cvt_pk_bf16_f32 v59, v30, v31
 v_mfma_f32_16x16x32_bf16 v[20:23], a[20:23], v[228:231], v[20:23]
 v_exp_f32 v32, v32
 v_mfma_f32_16x16x32_bf16 v[20:23], a[24:27], v[232:235], v[20:23]
 v_exp_f32 v33, v33
 v_mfma_f32_16x16x32_bf16 v[20:23], a[28:31], v[236:239], v[20:23]
 ds_read_b64_tr_b16 a[118:119], v2 offset:25992
 v_cvt_pk_bf16_f32 v52, v32, v33
 v_mfma_f32_16x16x32_bf16 v[24:27], a[0:3], a[180:183], 0
 v_exp_f32 v34, v34
 v_mfma_f32_16x16x32_bf16 v[24:27], a[4:7], a[184:187], v[24:27]
 v_exp_f32 v35, v35
 v_mfma_f32_16x16x32_bf16 v[24:27], a[8:11], a[188:191], v[24:27]
 ds_read_b64_tr_b16 a[88:89], v2 offset:17088
 v_cvt_pk_bf16_f32 v53, v34, v35
 v_mfma_f32_16x16x32_bf16 v[24:27], a[12:15], a[192:195], v[24:27]
 v_exp_f32 v36, v36
 v_mfma_f32_16x16x32_bf16 v[28:31], a[16:19], a[180:183], 0
 v_exp_f32 v37, v37
 v_mfma_f32_16x16x32_bf16 v[28:31], a[20:23], a[184:187], v[28:31]
 ds_read_b64_tr_b16 a[90:91], v2 offset:17600
 v_cvt_pk_bf16_f32 v54, v36, v37
 v_mfma_f32_16x16x32_bf16 v[28:31], a[24:27], a[188:191], v[28:31]
 v_exp_f32 v38, v38
 v_mfma_f32_16x16x32_bf16 v[28:31], a[28:31], a[192:195], v[28:31]
 ds_read_b64_tr_b16 a[120:121], v2 offset:25536
 v_mul_f32 v24, s46, v24
 v_mfma_f32_16x16x32_bf16 v[32:35], a[32:35], v[224:227], 0
 ds_read_b64_tr_b16 a[122:123], v2 offset:26048
 v_mul_f32 v25, s46, v25
 v_mfma_f32_16x16x32_bf16 v[32:35], a[36:39], v[228:231], v[32:35]
 ds_read_b64_tr_b16 a[92:93], v2 offset:17096
 v_mul_f32 v26, s46, v26
 v_mfma_f32_16x16x32_bf16 v[32:35], a[40:43], v[232:235], v[32:35]
 v_exp_f32 v39, v39
 v_mfma_f32_16x16x32_bf16 v[32:35], a[44:47], v[236:239], v[32:35]
 ds_read_b64_tr_b16 a[94:95], v2 offset:17608
 v_cvt_pk_bf16_f32 v55, v38, v39
 v_mfma_f32_16x16x32_bf16 v[36:39], a[48:51], v[224:227], 0
 ds_read_b64_tr_b16 a[124:125], v2 offset:25544
 v_mul_f32 v27, s46, v27
 v_mfma_f32_16x16x32_bf16 v[36:39], a[52:55], v[228:231], v[36:39]
 ds_read_b64_tr_b16 a[126:127], v2 offset:26056
 v_mul_f32 v28, s46, v28
 v_mfma_f32_16x16x32_bf16 v[36:39], a[56:59], v[232:235], v[36:39]
 v_exp_f32 v40, v40
 v_exp_f32 v41, v41
 v_exp_f32 v42, v42
 v_exp_f32 v43, v43
 v_mfma_f32_16x16x32_bf16 v[36:39], a[60:63], v[236:239], v[36:39]
 v_cvt_pk_bf16_f32 v60, v40, v41
 v_cvt_pk_bf16_f32 v61, v42, v43
 v_mfma_f32_16x16x32_bf16 v[40:43], a[32:35], a[180:183], 0
 v_exp_f32 v44, v44
 v_mfma_f32_16x16x32_bf16 v[40:43], a[36:39], a[184:187], v[40:43]
 v_exp_f32 v45, v45
 v_mfma_f32_16x16x32_bf16 v[40:43], a[40:43], a[188:191], v[40:43]
 v_exp_f32 v46, v46
 v_exp_f32 v47, v47
 v_mfma_f32_16x16x32_bf16 v[40:43], a[44:47], a[192:195], v[40:43]
 v_cvt_pk_bf16_f32 v62, v44, v45
 v_cvt_pk_bf16_f32 v63, v46, v47
 v_mfma_f32_16x16x32_bf16 v[44:47], a[48:51], a[180:183], 0
 v_exp_f32 v16, v16
 v_mfma_f32_16x16x32_bf16 v[44:47], a[52:55], a[184:187], v[44:47]
 v_exp_f32 v17, v17
 v_mfma_f32_16x16x32_bf16 v[44:47], a[56:59], a[188:191], v[44:47]
 v_exp_f32 v18, v18
 v_mfma_f32_16x16x32_bf16 v[44:47], a[60:63], a[192:195], v[44:47]
 v_exp_f32 v19, v19
 v_smfmac_f32_16x16x64_bf16 a[132:135], a[128:131], v[48:55], v242
 s_waitcnt vmcnt(8) lgkmcnt(0)
 s_barrier
 v_smfmac_f32_16x16x64_bf16 a[136:139], a[128:131], v[56:63], v242
 s_add_u32 m0, s23, 16896
 v_mfma_f32_16x16x32_bf16 v[80:83], a[64:67], v[48:51], v[80:83]
 buffer_load_dwordx4 v4, s[8:11], s21 offen nt lds
 v_mfma_f32_16x16x32_bf16 v[80:83], a[96:99], v[52:55], v[80:83]
 ds_read_b128 a[0:3], v1 offset:0
 v_cvt_pk_bf16_f32 v64, v16, v17
 v_mfma_f32_16x16x32_bf16 v[112:115], a[64:67], v[56:59], v[112:115]
 s_add_u32 m0, s23, 16904
 v_exp_f32 v20, v20
 v_mfma_f32_16x16x32_bf16 v[112:115], a[96:99], v[60:63], v[112:115]
 buffer_load_dwordx4 v4, s[8:11], s21 offen offset:1024 nt lds
 v_mfma_f32_16x16x32_bf16 v[84:87], a[68:71], v[48:51], v[84:87]
 s_add_u32 s21, s21, 8192
 ds_read_b128 a[4:7], v1 offset:64
 v_cvt_pk_bf16_f32 v65, v18, v19
 v_mfma_f32_16x16x32_bf16 v[84:87], a[100:103], v[52:55], v[84:87]
 s_add_u32 m0, s23, 25344
 v_exp_f32 v21, v21
 v_mfma_f32_16x16x32_bf16 v[116:119], a[68:71], v[56:59], v[116:119]
 buffer_load_dwordx4 v4, s[8:11], s21 offen nt lds
 v_mfma_f32_16x16x32_bf16 v[116:119], a[100:103], v[60:63], v[116:119]
 ds_read_b128 a[8:11], v1 offset:128
 v_cvt_pk_bf16_f32 v66, v20, v21
 v_mfma_f32_16x16x32_bf16 v[88:91], a[72:75], v[48:51], v[88:91]
 s_add_u32 m0, s23, 25352
 v_exp_f32 v22, v22
 v_mfma_f32_16x16x32_bf16 v[88:91], a[104:107], v[52:55], v[88:91]
 buffer_load_dwordx4 v4, s[8:11], s21 offen offset:1024 nt lds
 v_mfma_f32_16x16x32_bf16 v[120:123], a[72:75], v[56:59], v[120:123]
 s_add_u32 s21, s21, 8192
 ds_read_b128 a[12:15], v1 offset:192
 v_mul_f32 v29, s46, v29
 v_mfma_f32_16x16x32_bf16 v[120:123], a[104:107], v[60:63], v[120:123]
 v_exp_f32 v23, v23
 v_mfma_f32_16x16x32_bf16 v[92:95], a[76:79], v[48:51], v[92:95]
 ds_read_b128 a[16:19], v1 offset:512
 v_cvt_pk_bf16_f32 v67, v22, v23
 v_mfma_f32_16x16x32_bf16 v[92:95], a[108:111], v[52:55], v[92:95]
 v_exp_f32 v24, v24
 v_mfma_f32_16x16x32_bf16 v[124:127], a[76:79], v[56:59], v[124:127]
 ds_read_b128 a[20:23], v1 offset:576
 v_mul_f32 v30, s46, v30
 v_mfma_f32_16x16x32_bf16 v[124:127], a[108:111], v[60:63], v[124:127]
 v_exp_f32 v25, v25
 v_mfma_f32_16x16x32_bf16 v[96:99], a[80:83], v[48:51], v[96:99]
 ds_read_b128 a[24:27], v1 offset:640
 v_cvt_pk_bf16_f32 v72, v24, v25
 v_mfma_f32_16x16x32_bf16 v[96:99], a[112:115], v[52:55], v[96:99]
 v_exp_f32 v26, v26
 v_mfma_f32_16x16x32_bf16 v[128:131], a[80:83], v[56:59], v[128:131]
 ds_read_b128 a[28:31], v1 offset:704
 v_mul_f32 v31, s46, v31
 v_mfma_f32_16x16x32_bf16 v[128:131], a[112:115], v[60:63], v[128:131]
 v_exp_f32 v27, v27
 v_mfma_f32_16x16x32_bf16 v[100:103], a[84:87], v[48:51], v[100:103]
 ds_read_b128 a[32:35], v1 offset:8448
 v_cvt_pk_bf16_f32 v73, v26, v27
 v_mfma_f32_16x16x32_bf16 v[100:103], a[116:119], v[52:55], v[100:103]
 v_exp_f32 v28, v28
 v_mfma_f32_16x16x32_bf16 v[132:135], a[84:87], v[56:59], v[132:135]
 ds_read_b128 a[36:39], v1 offset:8512
 v_mul_f32 v40, s46, v40
 v_mfma_f32_16x16x32_bf16 v[132:135], a[116:119], v[60:63], v[132:135]
 v_exp_f32 v29, v29
 v_mfma_f32_16x16x32_bf16 v[104:107], a[88:91], v[48:51], v[104:107]
 ds_read_b128 a[40:43], v1 offset:8576
 v_cvt_pk_bf16_f32 v74, v28, v29
 v_mfma_f32_16x16x32_bf16 v[104:107], a[120:123], v[52:55], v[104:107]
 v_exp_f32 v30, v30
 v_mfma_f32_16x16x32_bf16 v[136:139], a[88:91], v[56:59], v[136:139]
 ds_read_b128 a[44:47], v1 offset:8640
 v_mul_f32 v41, s46, v41
 v_mfma_f32_16x16x32_bf16 v[136:139], a[120:123], v[60:63], v[136:139]
 v_exp_f32 v31, v31
 v_mfma_f32_16x16x32_bf16 v[108:111], a[92:95], v[48:51], v[108:111]
 ds_read_b128 a[48:51], v1 offset:8960
 v_cvt_pk_bf16_f32 v75, v30, v31
 v_mfma_f32_16x16x32_bf16 v[108:111], a[124:127], v[52:55], v[108:111]
 v_exp_f32 v32, v32
 v_mfma_f32_16x16x32_bf16 v[140:143], a[92:95], v[56:59], v[140:143]
 s_waitcnt lgkmcnt(9)
 ds_read_b128 a[52:55], v1 offset:9024
 v_mul_f32 v42, s46, v42
 v_mfma_f32_16x16x32_bf16 v[140:143], a[124:127], v[60:63], v[140:143]
 v_exp_f32 v33, v33
 v_mfma_f32_16x16x32_bf16 v[16:19], a[0:3], v[208:211], 0
 ds_read_b128 a[56:59], v1 offset:9088
 v_cvt_pk_bf16_f32 v68, v32, v33
 v_mfma_f32_16x16x32_bf16 v[16:19], a[4:7], v[212:215], v[16:19]
 v_exp_f32 v34, v34
 v_mfma_f32_16x16x32_bf16 v[16:19], a[8:11], v[216:219], v[16:19]
 s_waitcnt lgkmcnt(7)
 ds_read_b128 a[60:63], v1 offset:9152
 v_mul_f32 v43, s46, v43
 v_mfma_f32_16x16x32_bf16 v[16:19], a[12:15], v[220:223], v[16:19]
 v_exp_f32 v35, v35
 v_mfma_f32_16x16x32_bf16 v[20:23], a[16:19], v[208:211], 0
 v_exp_f32 v36, v36
 v_mfma_f32_16x16x32_bf16 v[20:23], a[20:23], v[212:215], v[20:23]
 v_exp_f32 v37, v37
 v_mfma_f32_16x16x32_bf16 v[20:23], a[24:27], v[216:219], v[20:23]
 v_exp_f32 v38, v38
 v_mfma_f32_16x16x32_bf16 v[20:23], a[28:31], v[220:223], v[20:23]
 v_exp_f32 v39, v39
 v_mfma_f32_16x16x32_bf16 v[24:27], a[0:3], a[164:167], 0
 v_exp_f32 v40, v40
 v_mfma_f32_16x16x32_bf16 v[24:27], a[4:7], a[168:171], v[24:27]
 v_exp_f32 v41, v41
 v_mfma_f32_16x16x32_bf16 v[24:27], a[8:11], a[172:175], v[24:27]
 v_exp_f32 v42, v42
 v_mfma_f32_16x16x32_bf16 v[24:27], a[12:15], a[176:179], v[24:27]
 v_exp_f32 v43, v43
 v_mfma_f32_16x16x32_bf16 v[28:31], a[16:19], a[164:167], 0
 v_exp_f32 v16, v16
 v_mfma_f32_16x16x32_bf16 v[28:31], a[20:23], a[168:171], v[28:31]
 v_exp_f32 v17, v17
 v_mfma_f32_16x16x32_bf16 v[28:31], a[24:27], a[172:175], v[28:31]
 s_waitcnt lgkmcnt(4)
 v_exp_f32 v18, v18
 v_mfma_f32_16x16x32_bf16 v[28:31], a[28:31], a[176:179], v[28:31]
 v_cvt_pk_bf16_f32 v69, v34, v35
 v_cvt_pk_bf16_f32 v70, v36, v37
 v_mfma_f32_16x16x32_bf16 v[32:35], a[32:35], v[208:211], 0
 v_exp_f32 v19, v19
 v_mfma_f32_16x16x32_bf16 v[32:35], a[36:39], v[212:215], v[32:35]
 v_exp_f32 v20, v20
 v_mfma_f32_16x16x32_bf16 v[32:35], a[40:43], v[216:219], v[32:35]
 s_waitcnt lgkmcnt(0)
 v_exp_f32 v21, v21
 v_mfma_f32_16x16x32_bf16 v[32:35], a[44:47], v[220:223], v[32:35]
 v_cvt_pk_bf16_f32 v71, v38, v39
 v_cvt_pk_bf16_f32 v76, v40, v41
 v_mfma_f32_16x16x32_bf16 v[36:39], a[48:51], v[208:211], 0
 v_exp_f32 v22, v22
 v_mfma_f32_16x16x32_bf16 v[36:39], a[52:55], v[212:215], v[36:39]
 v_exp_f32 v23, v23
 v_mfma_f32_16x16x32_bf16 v[36:39], a[56:59], v[216:219], v[36:39]
 v_cvt_pk_bf16_f32 v77, v42, v43
 v_mul_f32 v44, s46, v44
 v_mfma_f32_16x16x32_bf16 v[36:39], a[60:63], v[220:223], v[36:39]
 v_exp_f32 v44, v44
 v_mfma_f32_16x16x32_bf16 v[40:43], a[32:35], a[164:167], 0
 v_mul_f32 v45, s46, v45
 v_mul_f32 v46, s46, v46
 v_mfma_f32_16x16x32_bf16 v[40:43], a[36:39], a[168:171], v[40:43]
 v_mul_f32 v47, s46, v47
 v_cvt_pk_bf16_f32 v48, v16, v17
 v_mfma_f32_16x16x32_bf16 v[40:43], a[40:43], a[172:175], v[40:43]
 v_exp_f32 v45, v45
 v_exp_f32 v46, v46
 v_exp_f32 v47, v47
 v_mfma_f32_16x16x32_bf16 v[40:43], a[44:47], a[176:179], v[40:43]
 v_cvt_pk_bf16_f32 v78, v44, v45
 v_cvt_pk_bf16_f32 v79, v46, v47
 v_mfma_f32_16x16x32_bf16 v[44:47], a[48:51], a[164:167], 0
 v_cvt_pk_bf16_f32 v49, v18, v19
 v_cvt_pk_bf16_f32 v50, v20, v21
 v_mfma_f32_16x16x32_bf16 v[44:47], a[52:55], a[168:171], v[44:47]
 v_cvt_pk_bf16_f32 v51, v22, v23
 v_mul_f32 v24, s46, v24
 v_mfma_f32_16x16x32_bf16 v[44:47], a[56:59], a[172:175], v[44:47]
 v_exp_f32 v24, v24
 v_mfma_f32_16x16x32_bf16 v[44:47], a[60:63], a[176:179], v[44:47]
 v_mul_f32 v25, s46, v25
 v_mul_f32 v26, s46, v26
 v_smfmac_f32_16x16x64_bf16 a[140:143], a[128:131], v[64:71], v242
 s_waitcnt vmcnt(8) lgkmcnt(0)
 s_barrier
 v_smfmac_f32_16x16x64_bf16 a[144:147], a[128:131], v[72:79], v242
 s_add_u32 m0, s22, 0
 v_mul_f32 v27, s46, v27
 v_mfma_f32_16x16x32_bf16 v[144:147], a[64:67], v[64:67], v[144:147]
 buffer_load_dwordx4 v4, s[4:7], s20 offen nt lds
 v_mfma_f32_16x16x32_bf16 v[144:147], a[96:99], v[68:71], v[144:147]
 v_exp_f32 v25, v25
 v_mfma_f32_16x16x32_bf16 v[176:179], a[64:67], v[72:75], v[176:179]
 s_add_u32 m0, s22, 32
 v_exp_f32 v26, v26
 v_mfma_f32_16x16x32_bf16 v[176:179], a[96:99], v[76:79], v[176:179]
 buffer_load_dwordx4 v4, s[4:7], s20 offen offset:1024 nt lds
 v_mfma_f32_16x16x32_bf16 v[148:151], a[68:71], v[64:67], v[148:151]
 s_add_u32 s20, s20, 8192
 ds_read_b64_tr_b16 a[64:65], v2 offset:0
 v_cvt_pk_bf16_f32 v56, v24, v25
 v_mfma_f32_16x16x32_bf16 v[148:151], a[100:103], v[68:71], v[148:151]
 s_add_u32 m0, s22, 8448
 ds_read_b64_tr_b16 a[66:67], v2 offset:512
 v_mul_f32 v28, s46, v28
 v_mfma_f32_16x16x32_bf16 v[180:183], a[68:71], v[72:75], v[180:183]
 buffer_load_dwordx4 v4, s[4:7], s20 offen nt lds
 v_mfma_f32_16x16x32_bf16 v[180:183], a[100:103], v[76:79], v[180:183]
 ds_read_b64_tr_b16 a[96:97], v2 offset:8448
 v_mul_f32 v29, s46, v29
 v_mfma_f32_16x16x32_bf16 v[152:155], a[72:75], v[64:67], v[152:155]
 s_add_u32 m0, s22, 8480
 ds_read_b64_tr_b16 a[98:99], v2 offset:8960
 v_mul_f32 v30, s46, v30
 v_mfma_f32_16x16x32_bf16 v[152:155], a[104:107], v[68:71], v[152:155]
 buffer_load_dwordx4 v4, s[4:7], s20 offen offset:1024 nt lds
 v_mfma_f32_16x16x32_bf16 v[184:187], a[72:75], v[72:75], v[184:187]
 s_add_u32 s20, s20, 8192
 ds_read_b64_tr_b16 a[68:69], v2 offset:8
 v_mul_f32 v31, s46, v31
 v_mfma_f32_16x16x32_bf16 v[184:187], a[104:107], v[76:79], v[184:187]
 ds_read_b64_tr_b16 a[70:71], v2 offset:520
 v_mul_f32 v40, s46, v40
 v_mfma_f32_16x16x32_bf16 v[156:159], a[76:79], v[64:67], v[156:159]
 ds_read_b64_tr_b16 a[100:101], v2 offset:8456
 v_mul_f32 v41, s46, v41
 v_mfma_f32_16x16x32_bf16 v[156:159], a[108:111], v[68:71], v[156:159]
 ds_read_b64_tr_b16 a[102:103], v2 offset:8968
 v_mul_f32 v42, s46, v42
 v_mfma_f32_16x16x32_bf16 v[188:191], a[76:79], v[72:75], v[188:191]
 ds_read_b64_tr_b16 a[72:73], v2 offset:64
 v_mul_f32 v43, s46, v43
 v_mfma_f32_16x16x32_bf16 v[188:191], a[108:111], v[76:79], v[188:191]
 ds_read_b64_tr_b16 a[74:75], v2 offset:576
 v_mul_f32 v44, s46, v44
 v_mfma_f32_16x16x32_bf16 v[160:163], a[80:83], v[64:67], v[160:163]
 ds_read_b64_tr_b16 a[104:105], v2 offset:8512
 v_mul_f32 v45, s46, v45
 v_mfma_f32_16x16x32_bf16 v[160:163], a[112:115], v[68:71], v[160:163]
 ds_read_b64_tr_b16 a[106:107], v2 offset:9024
 v_mul_f32 v46, s46, v46
 v_mfma_f32_16x16x32_bf16 v[192:195], a[80:83], v[72:75], v[192:195]
 ds_read_b64_tr_b16 a[76:77], v2 offset:72
 v_mul_f32 v47, s46, v47
 v_mfma_f32_16x16x32_bf16 v[192:195], a[112:115], v[76:79], v[192:195]
 v_exp_f32 v27, v27
 v_mfma_f32_16x16x32_bf16 v[164:167], a[84:87], v[64:67], v[164:167]
 ds_read_b64_tr_b16 a[78:79], v2 offset:584
 v_cvt_pk_bf16_f32 v57, v26, v27
 v_mfma_f32_16x16x32_bf16 v[164:167], a[116:119], v[68:71], v[164:167]
 v_exp_f32 v28, v28
 v_mfma_f32_16x16x32_bf16 v[196:199], a[84:87], v[72:75], v[196:199]
 v_exp_f32 v29, v29
 v_mfma_f32_16x16x32_bf16 v[196:199], a[116:119], v[76:79], v[196:199]
 ds_read_b64_tr_b16 a[108:109], v2 offset:8520
 v_cvt_pk_bf16_f32 v58, v28, v29
 v_mfma_f32_16x16x32_bf16 v[168:171], a[88:91], v[64:67], v[168:171]
 v_exp_f32 v30, v30
 v_mfma_f32_16x16x32_bf16 v[168:171], a[120:123], v[68:71], v[168:171]
 v_exp_f32 v31, v31
 v_mfma_f32_16x16x32_bf16 v[200:203], a[88:91], v[72:75], v[200:203]
 ds_read_b64_tr_b16 a[110:111], v2 offset:9032
 v_cvt_pk_bf16_f32 v59, v30, v31
 v_mfma_f32_16x16x32_bf16 v[200:203], a[120:123], v[76:79], v[200:203]
 v_exp_f32 v32, v32
 v_mfma_f32_16x16x32_bf16 v[172:175], a[92:95], v[64:67], v[172:175]
 v_exp_f32 v33, v33
 v_mfma_f32_16x16x32_bf16 v[172:175], a[124:127], v[68:71], v[172:175]
 ds_read_b64_tr_b16 a[80:81], v2 offset:128
 v_cvt_pk_bf16_f32 v52, v32, v33
 v_mfma_f32_16x16x32_bf16 v[204:207], a[92:95], v[72:75], v[204:207]
 v_exp_f32 v34, v34
 v_mfma_f32_16x16x32_bf16 v[204:207], a[124:127], v[76:79], v[204:207]
 v_exp_f32 v35, v35
 v_mfma_f32_16x16x32_bf16 v[16:19], a[0:3], v[224:227], 0
 ds_read_b64_tr_b16 a[82:83], v2 offset:640
 v_cvt_pk_bf16_f32 v53, v34, v35
 v_mfma_f32_16x16x32_bf16 v[16:19], a[4:7], v[228:231], v[16:19]
 v_exp_f32 v36, v36
 v_mfma_f32_16x16x32_bf16 v[16:19], a[8:11], v[232:235], v[16:19]
 v_exp_f32 v37, v37
 v_mfma_f32_16x16x32_bf16 v[16:19], a[12:15], v[236:239], v[16:19]
 ds_read_b64_tr_b16 a[112:113], v2 offset:8576
 v_cvt_pk_bf16_f32 v54, v36, v37
 v_mfma_f32_16x16x32_bf16 v[20:23], a[16:19], v[224:227], 0
 v_exp_f32 v38, v38
 v_mfma_f32_16x16x32_bf16 v[20:23], a[20:23], v[228:231], v[20:23]
 v_exp_f32 v39, v39
 v_mfma_f32_16x16x32_bf16 v[20:23], a[24:27], v[232:235], v[20:23]
 ds_read_b64_tr_b16 a[114:115], v2 offset:9088
 v_cvt_pk_bf16_f32 v55, v38, v39
 v_mfma_f32_16x16x32_bf16 v[20:23], a[28:31], v[236:239], v[20:23]
 v_exp_f32 v40, v40
 v_mfma_f32_16x16x32_bf16 v[24:27], a[0:3], a[180:183], 0
 v_exp_f32 v41, v41
 v_mfma_f32_16x16x32_bf16 v[24:27], a[4:7], a[184:187], v[24:27]
 ds_read_b64_tr_b16 a[84:85], v2 offset:136
 v_cvt_pk_bf16_f32 v60, v40, v41
 v_mfma_f32_16x16x32_bf16 v[24:27], a[8:11], a[188:191], v[24:27]
 v_exp_f32 v42, v42
 v_mfma_f32_16x16x32_bf16 v[24:27], a[12:15], a[192:195], v[24:27]
 v_exp_f32 v43, v43
 v_mfma_f32_16x16x32_bf16 v[28:31], a[16:19], a[180:183], 0
 ds_read_b64_tr_b16 a[86:87], v2 offset:648
 v_cvt_pk_bf16_f32 v61, v42, v43
 v_mfma_f32_16x16x32_bf16 v[28:31], a[20:23], a[184:187], v[28:31]
 v_exp_f32 v44, v44
 v_mfma_f32_16x16x32_bf16 v[28:31], a[24:27], a[188:191], v[28:31]
 v_exp_f32 v45, v45
 v_mfma_f32_16x16x32_bf16 v[28:31], a[28:31], a[192:195], v[28:31]
 ds_read_b64_tr_b16 a[116:117], v2 offset:8584
 v_cvt_pk_bf16_f32 v62, v44, v45
 v_mfma_f32_16x16x32_bf16 v[32:35], a[32:35], v[224:227], 0
 ds_read_b64_tr_b16 a[118:119], v2 offset:9096
 v_mul_f32 v24, s46, v24
 v_mfma_f32_16x16x32_bf16 v[32:35], a[36:39], v[228:231], v[32:35]
 ds_read_b64_tr_b16 a[88:89], v2 offset:192
 v_mul_f32 v25, s46, v25
 v_mfma_f32_16x16x32_bf16 v[32:35], a[40:43], v[232:235], v[32:35]
 ds_read_b64_tr_b16 a[90:91], v2 offset:704
 v_mul_f32 v26, s46, v26
 v_mfma_f32_16x16x32_bf16 v[32:35], a[44:47], v[236:239], v[32:35]
 ds_read_b64_tr_b16 a[120:121], v2 offset:8640
 v_mul_f32 v27, s46, v27
 v_mfma_f32_16x16x32_bf16 v[36:39], a[48:51], v[224:227], 0
 ds_read_b64_tr_b16 a[122:123], v2 offset:9152
 v_mul_f32 v28, s46, v28
 v_mfma_f32_16x16x32_bf16 v[36:39], a[52:55], v[228:231], v[36:39]
 ds_read_b64_tr_b16 a[92:93], v2 offset:200
 v_mul_f32 v29, s46, v29
 v_mfma_f32_16x16x32_bf16 v[36:39], a[56:59], v[232:235], v[36:39]
 ds_read_b64_tr_b16 a[94:95], v2 offset:712
 v_mul_f32 v30, s46, v30
 v_mfma_f32_16x16x32_bf16 v[36:39], a[60:63], v[236:239], v[36:39]
 ds_read_b64_tr_b16 a[124:125], v2 offset:8648
 v_mul_f32 v31, s46, v31
 v_mfma_f32_16x16x32_bf16 v[40:43], a[32:35], a[180:183], 0
 v_exp_f32 v46, v46
 v_mfma_f32_16x16x32_bf16 v[40:43], a[36:39], a[184:187], v[40:43]
 ds_read_b64_tr_b16 a[126:127], v2 offset:9160
 v_mfma_f32_16x16x32_bf16 v[40:43], a[40:43], a[188:191], v[40:43]
 v_exp_f32 v47, v47
 v_mfma_f32_16x16x32_bf16 v[40:43], a[44:47], a[192:195], v[40:43]
 v_cvt_pk_bf16_f32 v63, v46, v47
 v_mfma_f32_16x16x32_bf16 v[44:47], a[48:51], a[180:183], 0
 v_exp_f32 v16, v16
 v_mfma_f32_16x16x32_bf16 v[44:47], a[52:55], a[184:187], v[44:47]
 v_exp_f32 v17, v17
 v_mfma_f32_16x16x32_bf16 v[44:47], a[56:59], a[188:191], v[44:47]
 v_exp_f32 v18, v18
 v_mfma_f32_16x16x32_bf16 v[44:47], a[60:63], a[192:195], v[44:47]
 v_exp_f32 v19, v19
 v_smfmac_f32_16x16x64_bf16 a[132:135], a[128:131], v[48:55], v242
 s_waitcnt vmcnt(8) lgkmcnt(0)
 s_barrier
 v_smfmac_f32_16x16x64_bf16 a[136:139], a[128:131], v[56:63], v242
 s_add_u32 m0, s23, 0
 v_mfma_f32_16x16x32_bf16 v[80:83], a[64:67], v[48:51], v[80:83]
 buffer_load_dwordx4 v4, s[8:11], s21 offen nt lds
 v_mfma_f32_16x16x32_bf16 v[80:83], a[96:99], v[52:55], v[80:83]
 ds_read_b128 a[0:3], v1 offset:16896
 v_cvt_pk_bf16_f32 v64, v16, v17
 v_mfma_f32_16x16x32_bf16 v[112:115], a[64:67], v[56:59], v[112:115]
 s_add_u32 m0, s23, 8
 v_exp_f32 v20, v20
 v_mfma_f32_16x16x32_bf16 v[112:115], a[96:99], v[60:63], v[112:115]
 buffer_load_dwordx4 v4, s[8:11], s21 offen offset:1024 nt lds
 v_mfma_f32_16x16x32_bf16 v[84:87], a[68:71], v[48:51], v[84:87]
 s_add_u32 s21, s21, 8192
 ds_read_b128 a[4:7], v1 offset:16960
 v_cvt_pk_bf16_f32 v65, v18, v19
 v_mfma_f32_16x16x32_bf16 v[84:87], a[100:103], v[52:55], v[84:87]
 s_add_u32 m0, s23, 8448
 v_exp_f32 v21, v21
 v_mfma_f32_16x16x32_bf16 v[116:119], a[68:71], v[56:59], v[116:119]
 buffer_load_dwordx4 v4, s[8:11], s21 offen nt lds
 v_mfma_f32_16x16x32_bf16 v[116:119], a[100:103], v[60:63], v[116:119]
 ds_read_b128 a[8:11], v1 offset:17024
 v_cvt_pk_bf16_f32 v66, v20, v21
 v_mfma_f32_16x16x32_bf16 v[88:91], a[72:75], v[48:51], v[88:91]
 s_add_u32 m0, s23, 8456
 v_exp_f32 v22, v22
 v_mfma_f32_16x16x32_bf16 v[88:91], a[104:107], v[52:55], v[88:91]
 buffer_load_dwordx4 v4, s[8:11], s21 offen offset:1024 nt lds
 v_mfma_f32_16x16x32_bf16 v[120:123], a[72:75], v[56:59], v[120:123]
 s_add_u32 s21, s21, 8192
 ds_read_b128 a[12:15], v1 offset:17088
 v_mul_f32 v40, s46, v40
 v_mfma_f32_16x16x32_bf16 v[120:123], a[104:107], v[60:63], v[120:123]
 v_exp_f32 v23, v23
 v_mfma_f32_16x16x32_bf16 v[92:95], a[76:79], v[48:51], v[92:95]
 ds_read_b128 a[16:19], v1 offset:17408
 v_cvt_pk_bf16_f32 v67, v22, v23
 v_mfma_f32_16x16x32_bf16 v[92:95], a[108:111], v[52:55], v[92:95]
 v_exp_f32 v24, v24
 v_mfma_f32_16x16x32_bf16 v[124:127], a[76:79], v[56:59], v[124:127]
 ds_read_b128 a[20:23], v1 offset:17472
 v_mul_f32 v41, s46, v41
 v_mfma_f32_16x16x32_bf16 v[124:127], a[108:111], v[60:63], v[124:127]
 v_exp_f32 v25, v25
 v_mfma_f32_16x16x32_bf16 v[96:99], a[80:83], v[48:51], v[96:99]
 ds_read_b128 a[24:27], v1 offset:17536
 v_cvt_pk_bf16_f32 v72, v24, v25
 v_mfma_f32_16x16x32_bf16 v[96:99], a[112:115], v[52:55], v[96:99]
 v_exp_f32 v26, v26
 v_mfma_f32_16x16x32_bf16 v[128:131], a[80:83], v[56:59], v[128:131]
 ds_read_b128 a[28:31], v1 offset:17600
 v_mul_f32 v42, s46, v42
 v_mfma_f32_16x16x32_bf16 v[128:131], a[112:115], v[60:63], v[128:131]
 v_exp_f32 v27, v27
 v_mfma_f32_16x16x32_bf16 v[100:103], a[84:87], v[48:51], v[100:103]
 ds_read_b128 a[32:35], v1 offset:25344
 v_cvt_pk_bf16_f32 v73, v26, v27
 v_mfma_f32_16x16x32_bf16 v[100:103], a[116:119], v[52:55], v[100:103]
 v_exp_f32 v28, v28
 v_mfma_f32_16x16x32_bf16 v[132:135], a[84:87], v[56:59], v[132:135]
 ds_read_b128 a[36:39], v1 offset:25408
 v_mul_f32 v43, s46, v43
 v_mfma_f32_16x16x32_bf16 v[132:135], a[116:119], v[60:63], v[132:135]
 v_exp_f32 v29, v29
 v_mfma_f32_16x16x32_bf16 v[104:107], a[88:91], v[48:51], v[104:107]
 ds_read_b128 a[40:43], v1 offset:25472
 v_cvt_pk_bf16_f32 v74, v28, v29
 v_mfma_f32_16x16x32_bf16 v[104:107], a[120:123], v[52:55], v[104:107]
 v_exp_f32 v30, v30
 v_mfma_f32_16x16x32_bf16 v[136:139], a[88:91], v[56:59], v[136:139]
 ds_read_b128 a[44:47], v1 offset:25536
 v_mul_f32 v44, s46, v44
 v_mfma_f32_16x16x32_bf16 v[136:139], a[120:123], v[60:63], v[136:139]
 v_exp_f32 v31, v31
 v_mfma_f32_16x16x32_bf16 v[108:111], a[92:95], v[48:51], v[108:111]
 ds_read_b128 a[48:51], v1 offset:25856
 v_cvt_pk_bf16_f32 v75, v30, v31
 v_mfma_f32_16x16x32_bf16 v[108:111], a[124:127], v[52:55], v[108:111]
 v_exp_f32 v32, v32
 v_mfma_f32_16x16x32_bf16 v[140:143], a[92:95], v[56:59], v[140:143]
 s_waitcnt lgkmcnt(9)
 ds_read_b128 a[52:55], v1 offset:25920
 v_mul_f32 v45, s46, v45
 v_mfma_f32_16x16x32_bf16 v[140:143], a[124:127], v[60:63], v[140:143]
 v_exp_f32 v33, v33
 v_mfma_f32_16x16x32_bf16 v[16:19], a[0:3], v[208:211], 0
 ds_read_b128 a[56:59], v1 offset:25984
 v_cvt_pk_bf16_f32 v68, v32, v33
 v_mfma_f32_16x16x32_bf16 v[16:19], a[4:7], v[212:215], v[16:19]
 v_exp_f32 v34, v34
 v_mfma_f32_16x16x32_bf16 v[16:19], a[8:11], v[216:219], v[16:19]
 s_waitcnt lgkmcnt(7)
 ds_read_b128 a[60:63], v1 offset:26048
 v_mul_f32 v46, s46, v46
 v_mfma_f32_16x16x32_bf16 v[16:19], a[12:15], v[220:223], v[16:19]
 v_exp_f32 v35, v35
 v_mfma_f32_16x16x32_bf16 v[20:23], a[16:19], v[208:211], 0
 v_exp_f32 v36, v36
 v_mfma_f32_16x16x32_bf16 v[20:23], a[20:23], v[212:215], v[20:23]
 v_exp_f32 v37, v37
 v_mfma_f32_16x16x32_bf16 v[20:23], a[24:27], v[216:219], v[20:23]
 v_exp_f32 v38, v38
 v_mfma_f32_16x16x32_bf16 v[20:23], a[28:31], v[220:223], v[20:23]
 v_exp_f32 v39, v39
 v_mfma_f32_16x16x32_bf16 v[24:27], a[0:3], a[164:167], 0
 v_exp_f32 v40, v40
 v_mfma_f32_16x16x32_bf16 v[24:27], a[4:7], a[168:171], v[24:27]
 v_exp_f32 v41, v41
 v_mfma_f32_16x16x32_bf16 v[24:27], a[8:11], a[172:175], v[24:27]
 v_exp_f32 v42, v42
 v_mfma_f32_16x16x32_bf16 v[24:27], a[12:15], a[176:179], v[24:27]
 v_exp_f32 v43, v43
 v_mfma_f32_16x16x32_bf16 v[28:31], a[16:19], a[164:167], 0
 v_exp_f32 v44, v44
 v_mfma_f32_16x16x32_bf16 v[28:31], a[20:23], a[168:171], v[28:31]
 v_exp_f32 v45, v45
 v_mfma_f32_16x16x32_bf16 v[28:31], a[24:27], a[172:175], v[28:31]
 s_waitcnt lgkmcnt(4)
 v_exp_f32 v46, v46
 v_mfma_f32_16x16x32_bf16 v[28:31], a[28:31], a[176:179], v[28:31]
 v_cvt_pk_bf16_f32 v69, v34, v35
 v_cvt_pk_bf16_f32 v70, v36, v37
 v_mfma_f32_16x16x32_bf16 v[32:35], a[32:35], v[208:211], 0
 v_exp_f32 v16, v16
 v_mfma_f32_16x16x32_bf16 v[32:35], a[36:39], v[212:215], v[32:35]
 v_exp_f32 v17, v17
 v_mfma_f32_16x16x32_bf16 v[32:35], a[40:43], v[216:219], v[32:35]
 s_waitcnt lgkmcnt(0)
 v_exp_f32_e64 v18, v18
 v_mfma_f32_16x16x32_bf16 v[32:35], a[44:47], v[220:223], v[32:35]
 v_cvt_pk_bf16_f32 v71, v38, v39
 v_cvt_pk_bf16_f32 v76, v40, v41
 v_mfma_f32_16x16x32_bf16 v[36:39], a[48:51], v[208:211], 0
L_pad1:
 s_cbranch_scc1 L_pad5
 v_exp_f32 v19, v19
 v_mfma_f32_16x16x32_bf16 v[36:39], a[52:55], v[212:215], v[36:39]
 v_exp_f32 v20, v20
 v_mfma_f32_16x16x32_bf16 v[36:39], a[56:59], v[216:219], v[36:39]
 v_exp_f32 v21, v21
 v_mfma_f32_16x16x32_bf16 v[36:39], a[60:63], v[220:223], v[36:39]
 v_cvt_pk_bf16_f32 v77, v42, v43
 v_mul_f32 v47, s46, v47
 v_mfma_f32_16x16x32_bf16 v[40:43], a[32:35], a[164:167], 0
 v_exp_f32 v47, v47
 v_mfma_f32_16x16x32_bf16 v[40:43], a[36:39], a[168:171], v[40:43]
 v_exp_f32 v22, v22
 v_mfma_f32_16x16x32_bf16 v[40:43], a[40:43], a[172:175], v[40:43]
 v_exp_f32 v23, v23
 v_mfma_f32_16x16x32_bf16 v[40:43], a[44:47], a[176:179], v[40:43]
 v_cvt_pk_bf16_f32 v78, v44, v45
 v_cvt_pk_bf16_f32 v79, v46, v47
 v_mfma_f32_16x16x32_bf16 v[44:47], a[48:51], a[164:167], 0
 v_cvt_pk_bf16_f32 v48, v16, v17
 v_cvt_pk_bf16_f32 v49, v18, v19
 v_mfma_f32_16x16x32_bf16 v[44:47], a[52:55], a[168:171], v[44:47]
 v_cvt_pk_bf16_f32 v50, v20, v21
 v_cvt_pk_bf16_f32 v51, v22, v23
 v_mfma_f32_16x16x32_bf16 v[44:47], a[56:59], a[172:175], v[44:47]
 v_mul_f32 v24, s46, v24
 v_mul_f32 v25, s46, v25
 v_mfma_f32_16x16x32_bf16 v[44:47], a[60:63], a[176:179], v[44:47]
 v_exp_f32 v24, v24
 v_smfmac_f32_16x16x64_bf16 a[140:143], a[128:131], v[64:71], v242
 s_waitcnt vmcnt(8) lgkmcnt(0)
 s_barrier
 v_smfmac_f32_16x16x64_bf16 a[144:147], a[128:131], v[72:79], v242
 s_add_u32 m0, s22, 16896
 v_mul_f32 v26, s46, v26
 v_mfma_f32_16x16x32_bf16 v[144:147], a[64:67], v[64:67], v[144:147]
 buffer_load_dwordx4 v4, s[4:7], s20 offen nt lds
 v_mfma_f32_16x16x32_bf16 v[144:147], a[96:99], v[68:71], v[144:147]
 v_exp_f32 v25, v25
 v_mfma_f32_16x16x32_bf16 v[176:179], a[64:67], v[72:75], v[176:179]
 s_add_u32 m0, s22, 16928
 v_exp_f32 v26, v26
 v_mfma_f32_16x16x32_bf16 v[176:179], a[96:99], v[76:79], v[176:179]
 buffer_load_dwordx4 v4, s[4:7], s20 offen offset:1024 nt lds
 v_mfma_f32_16x16x32_bf16 v[148:151], a[68:71], v[64:67], v[148:151]
 s_add_u32 s20, s20, 8192
 ds_read_b64_tr_b16 a[64:65], v2 offset:16896
 v_mul_f32 v27, s46, v27
 v_mfma_f32_16x16x32_bf16 v[148:151], a[100:103], v[68:71], v[148:151]
 s_add_u32 m0, s22, 25344
 ds_read_b64_tr_b16 a[66:67], v2 offset:17408
 v_cvt_pk_bf16_f32 v56, v24, v25
 v_mfma_f32_16x16x32_bf16 v[180:183], a[68:71], v[72:75], v[180:183]
 buffer_load_dwordx4 v4, s[4:7], s20 offen nt lds
 v_mfma_f32_16x16x32_bf16 v[180:183], a[100:103], v[76:79], v[180:183]
 ds_read_b64_tr_b16 a[96:97], v2 offset:25344
 v_mul_f32 v28, s46, v28
 v_mfma_f32_16x16x32_bf16 v[152:155], a[72:75], v[64:67], v[152:155]
 s_add_u32 m0, s22, 25376
 ds_read_b64_tr_b16 a[98:99], v2 offset:25856
 v_mul_f32 v29, s46, v29
 v_mfma_f32_16x16x32_bf16 v[152:155], a[104:107], v[68:71], v[152:155]
 buffer_load_dwordx4 v4, s[4:7], s20 offen offset:1024 nt lds
 v_mfma_f32_16x16x32_bf16 v[184:187], a[72:75], v[72:75], v[184:187]
 s_add_u32 s20, s20, 8192
 ds_read_b64_tr_b16 a[68:69], v2 offset:16904
 v_mul_f32 v30, s46, v30
 v_mfma_f32_16x16x32_bf16 v[184:187], a[104:107], v[76:79], v[184:187]
 ds_read_b64_tr_b16 a[70:71], v2 offset:17416
 v_mul_f32 v31, s46, v31
 v_mfma_f32_16x16x32_bf16 v[156:159], a[76:79], v[64:67], v[156:159]
 ds_read_b64_tr_b16 a[100:101], v2 offset:25352
 v_mul_f32 v40, s46, v40
 v_mfma_f32_16x16x32_bf16 v[156:159], a[108:111], v[68:71], v[156:159]
 ds_read_b64_tr_b16 a[102:103], v2 offset:25864
 v_mul_f32 v41, s46, v41
 v_mfma_f32_16x16x32_bf16 v[188:191], a[76:79], v[72:75], v[188:191]
 ds_read_b64_tr_b16 a[72:73], v2 offset:16960
 v_mul_f32 v42, s46, v42
 v_mfma_f32_16x16x32_bf16 v[188:191], a[108:111], v[76:79], v[188:191]
 ds_read_b64_tr_b16 a[74:75], v2 offset:17472
 v_mul_f32 v43, s46, v43
 v_mfma_f32_16x16x32_bf16 v[160:163], a[80:83], v[64:67], v[160:163]
 ds_read_b64_tr_b16 a[104:105], v2 offset:25408
 v_mul_f32 v44, s46, v44
 v_mfma_f32_16x16x32_bf16 v[160:163], a[112:115], v[68:71], v[160:163]
 ds_read_b64_tr_b16 a[106:107], v2 offset:25920
 v_mul_f32 v45, s46, v45
 v_mfma_f32_16x16x32_bf16 v[192:195], a[80:83], v[72:75], v[192:195]
 ds_read_b64_tr_b16 a[76:77], v2 offset:16968
 v_mul_f32 v46, s46, v46
 v_mfma_f32_16x16x32_bf16 v[192:195], a[112:115], v[76:79], v[192:195]
 ds_read_b64_tr_b16 a[78:79], v2 offset:17480
 v_mul_f32 v47, s46, v47
 v_mfma_f32_16x16x32_bf16 v[164:167], a[84:87], v[64:67], v[164:167]
 v_exp_f32 v27, v27
 v_mfma_f32_16x16x32_bf16 v[164:167], a[116:119], v[68:71], v[164:167]
 ds_read_b64_tr_b16 a[108:109], v2 offset:25416
 v_cvt_pk_bf16_f32 v57, v26, v27
 v_mfma_f32_16x16x32_bf16 v[196:199], a[84:87], v[72:75], v[196:199]
 v_exp_f32 v28, v28
 v_mfma_f32_16x16x32_bf16 v[196:199], a[116:119], v[76:79], v[196:199]
 v_exp_f32 v29, v29
 v_mfma_f32_16x16x32_bf16 v[168:171], a[88:91], v[64:67], v[168:171]
 ds_read_b64_tr_b16 a[110:111], v2 offset:25928
 v_cvt_pk_bf16_f32 v58, v28, v29
 v_mfma_f32_16x16x32_bf16 v[168:171], a[120:123], v[68:71], v[168:171]
 v_exp_f32 v30, v30
 v_mfma_f32_16x16x32_bf16 v[200:203], a[88:91], v[72:75], v[200:203]
 v_exp_f32 v31, v31
 v_mfma_f32_16x16x32_bf16 v[200:203], a[120:123], v[76:79], v[200:203]
 ds_read_b64_tr_b16 a[80:81], v2 offset:17024
 v_cvt_pk_bf16_f32 v59, v30, v31
 v_mfma_f32_16x16x32_bf16 v[172:175], a[92:95], v[64:67], v[172:175]
 v_exp_f32 v32, v32
 v_mfma_f32_16x16x32_bf16 v[172:175], a[124:127], v[68:71], v[172:175]
 v_exp_f32 v33, v33
 v_mfma_f32_16x16x32_bf16 v[204:207], a[92:95], v[72:75], v[204:207]
 ds_read_b64_tr_b16 a[82:83], v2 offset:17536
 v_cvt_pk_bf16_f32 v52, v32, v33
 v_mfma_f32_16x16x32_bf16 v[204:207], a[124:127], v[76:79], v[204:207]
 v_exp_f32 v34, v34
 v_mfma_f32_16x16x32_bf16 v[16:19], a[0:3], v[224:227], 0
 v_exp_f32 v35, v35
 v_mfma_f32_16x16x32_bf16 v[16:19], a[4:7], v[228:231], v[16:19]
 ds_read_b64_tr_b16 a[112:113], v2 offset:25472
 v_cvt_pk_bf16_f32 v53, v34, v35
 v_mfma_f32_16x16x32_bf16 v[16:19], a[8:11], v[232:235], v[16:19]
 v_exp_f32 v36, v36
 v_mfma_f32_16x16x32_bf16 v[16:19], a[12:15], v[236:239], v[16:19]
 v_exp_f32 v37, v37
 v_mfma_f32_16x16x32_bf16 v[20:23], a[16:19], v[224:227], 0
 ds_read_b64_tr_b16 a[114:115], v2 offset:25984
 v_cvt_pk_bf16_f32 v54, v36, v37
 v_mfma_f32_16x16x32_bf16 v[20:23], a[20:23], v[228:231], v[20:23]
 v_exp_f32 v38, v38
 v_mfma_f32_16x16x32_bf16 v[20:23], a[24:27], v[232:235], v[20:23]
 v_exp_f32 v39, v39
 v_mfma_f32_16x16x32_bf16 v[20:23], a[28:31], v[236:239], v[20:23]
 ds_read_b64_tr_b16 a[84:85], v2 offset:17032
 v_cvt_pk_bf16_f32 v55, v38, v39
 v_mfma_f32_16x16x32_bf16 v[24:27], a[0:3], a[180:183], 0
 v_exp_f32 v40, v40
 v_mfma_f32_16x16x32_bf16 v[24:27], a[4:7], a[184:187], v[24:27]
 v_exp_f32 v41, v41
 v_mfma_f32_16x16x32_bf16 v[24:27], a[8:11], a[188:191], v[24:27]
 ds_read_b64_tr_b16 a[86:87], v2 offset:17544
 v_cvt_pk_bf16_f32 v60, v40, v41
 v_mfma_f32_16x16x32_bf16 v[24:27], a[12:15], a[192:195], v[24:27]
 v_exp_f32 v42, v42
 v_mfma_f32_16x16x32_bf16 v[28:31], a[16:19], a[180:183], 0
 v_exp_f32 v43, v43
 v_mfma_f32_16x16x32_bf16 v[28:31], a[20:23], a[184:187], v[28:31]
 ds_read_b64_tr_b16 a[116:117], v2 offset:25480
 v_cvt_pk_bf16_f32 v61, v42, v43
 v_mfma_f32_16x16x32_bf16 v[28:31], a[24:27], a[188:191], v[28:31]
 v_exp_f32 v44, v44
 v_mfma_f32_16x16x32_bf16 v[28:31], a[28:31], a[192:195], v[28:31]
 ds_read_b64_tr_b16 a[118:119], v2 offset:25992
 v_mul_f32 v24, s46, v24
 v_mfma_f32_16x16x32_bf16 v[32:35], a[32:35], v[224:227], 0
 ds_read_b64_tr_b16 a[88:89], v2 offset:17088
 v_mul_f32 v25, s46, v25
 v_mfma_f32_16x16x32_bf16 v[32:35], a[36:39], v[228:231], v[32:35]
 ds_read_b64_tr_b16 a[90:91], v2 offset:17600
 v_mul_f32 v26, s46, v26
 v_mfma_f32_16x16x32_bf16 v[32:35], a[40:43], v[232:235], v[32:35]
 ds_read_b64_tr_b16 a[120:121], v2 offset:25536
 v_mul_f32 v27, s46, v27
 v_mfma_f32_16x16x32_bf16 v[32:35], a[44:47], v[236:239], v[32:35]
 ds_read_b64_tr_b16 a[122:123], v2 offset:26048
 v_mul_f32 v28, s46, v28
 v_mfma_f32_16x16x32_bf16 v[36:39], a[48:51], v[224:227], 0
 ds_read_b64_tr_b16 a[92:93], v2 offset:17096
 v_mul_f32 v29, s46, v29
 v_mfma_f32_16x16x32_bf16 v[36:39], a[52:55], v[228:231], v[36:39]
 ds_read_b64_tr_b16 a[94:95], v2 offset:17608
 v_mul_f32 v30, s46, v30
 v_mfma_f32_16x16x32_bf16 v[36:39], a[56:59], v[232:235], v[36:39]
 v_exp_f32 v45, v45
 v_mfma_f32_16x16x32_bf16 v[36:39], a[60:63], v[236:239], v[36:39]
 ds_read_b64_tr_b16 a[124:125], v2 offset:25544
 v_cvt_pk_bf16_f32 v62, v44, v45
 v_mfma_f32_16x16x32_bf16 v[40:43], a[32:35], a[180:183], 0
 v_exp_f32 v46, v46
 v_mfma_f32_16x16x32_bf16 v[40:43], a[36:39], a[184:187], v[40:43]
 ds_read_b64_tr_b16 a[126:127], v2 offset:26056
 v_mfma_f32_16x16x32_bf16 v[40:43], a[40:43], a[188:191], v[40:43]
 v_exp_f32 v47, v47
 v_mfma_f32_16x16x32_bf16 v[40:43], a[44:47], a[192:195], v[40:43]
 v_cvt_pk_bf16_f32 v63, v46, v47
 v_mfma_f32_16x16x32_bf16 v[44:47], a[48:51], a[180:183], 0
 v_exp_f32 v16, v16
 v_mfma_f32_16x16x32_bf16 v[44:47], a[52:55], a[184:187], v[44:47]
 v_exp_f32 v17, v17
 v_mfma_f32_16x16x32_bf16 v[44:47], a[56:59], a[188:191], v[44:47]
 v_exp_f32 v18, v18
 v_mfma_f32_16x16x32_bf16 v[44:47], a[60:63], a[192:195], v[44:47]
 v_exp_f32 v19, v19
 v_cvt_pk_bf16_f32 v64, v16, v17
L_loop:
 v_smfmac_f32_16x16x64_bf16 a[132:135], a[128:131], v[48:55], v242
 s_waitcnt vmcnt(8) lgkmcnt(0)
 s_barrier
 v_smfmac_f32_16x16x64_bf16 a[136:139], a[128:131], v[56:63], v242
 s_add_u32 m0, s23, 16896
 v_mfma_f32_16x16x32_bf16 v[80:83], a[64:67], v[48:51], v[80:83]
 buffer_load_dwordx4 v4, s[8:11], s21 offen nt lds
 v_mfma_f32_16x16x32_bf16 v[80:83], a[96:99], v[52:55], v[80:83]
 ds_read_b128 a[0:3], v1 offset:0
 v_cvt_pk_bf16_f32 v65, v18, v19
 v_mfma_f32_16x16x32_bf16 v[112:115], a[64:67], v[56:59], v[112:115]
 s_add_u32 m0, s23, 16904
 v_exp_f32 v20, v20
 v_mfma_f32_16x16x32_bf16 v[112:115], a[96:99], v[60:63], v[112:115]
 buffer_load_dwordx4 v4, s[8:11], s21 offen offset:1024 nt lds
 v_mfma_f32_16x16x32_bf16 v[84:87], a[68:71], v[48:51], v[84:87]
 s_add_u32 s21, s21, 8192
 ds_read_b128 a[4:7], v1 offset:64
 v_mul_f32 v31, s46, v31
 v_mfma_f32_16x16x32_bf16 v[84:87], a[100:103], v[52:55], v[84:87]
 s_add_u32 m0, s23, 25344
 v_exp_f32 v21, v21
 v_mfma_f32_16x16x32_bf16 v[116:119], a[68:71], v[56:59], v[116:119]
 buffer_load_dwordx4 v4, s[8:11], s21 offen nt lds
 v_mfma_f32_16x16x32_bf16 v[116:119], a[100:103], v[60:63], v[116:119]
 ds_read_b128 a[8:11], v1 offset:128
 v_cvt_pk_bf16_f32 v66, v20, v21
 v_mfma_f32_16x16x32_bf16 v[88:91], a[72:75], v[48:51], v[88:91]
 s_add_u32 m0, s23, 25352
 v_exp_f32 v22, v22
 v_mfma_f32_16x16x32_bf16 v[88:91], a[104:107], v[52:55], v[88:91]
 buffer_load_dwordx4 v4, s[8:11], s21 offen offset:1024 nt lds
 v_mfma_f32_16x16x32_bf16 v[120:123], a[72:75], v[56:59], v[120:123]
 s_add_u32 s21, s21, 8192
 ds_read_b128 a[12:15], v1 offset:192
 v_mul_f32 v40, s46, v40
 v_mfma_f32_16x16x32_bf16 v[120:123], a[104:107], v[60:63], v[120:123]
 v_exp_f32 v23, v23
 v_mfma_f32_16x16x32_bf16 v[92:95], a[76:79], v[48:51], v[92:95]
 ds_read_b128 a[16:19], v1 offset:512
 v_cvt_pk_bf16_f32 v67, v22, v23
 v_mfma_f32_16x16x32_bf16 v[92:95], a[108:111], v[52:55], v[92:95]
 s_add_u32 m0, s48, 0
 v_exp_f32 v24, v24
 v_mfma_f32_16x16x32_bf16 v[124:127], a[76:79], v[56:59], v[124:127]
 buffer_load_dwordx4 v5, s[12:15], 0 offen nt lds
 v_mfma_f32_16x16x32_bf16 v[124:127], a[108:111], v[60:63], v[124:127]
 ds_read_b128 a[20:23], v1 offset:576
 v_mul_f32 v41, s46, v41
 v_mfma_f32_16x16x32_bf16 v[96:99], a[80:83], v[48:51], v[96:99]
 v_exp_f32 v25, v25
 v_mfma_f32_16x16x32_bf16 v[96:99], a[112:115], v[52:55], v[96:99]
 ds_read_b128 a[24:27], v1 offset:640
 v_cvt_pk_bf16_f32 v72, v24, v25
 v_mfma_f32_16x16x32_bf16 v[128:131], a[80:83], v[56:59], v[128:131]
 v_exp_f32 v26, v26
 v_mfma_f32_16x16x32_bf16 v[128:131], a[112:115], v[60:63], v[128:131]
 ds_read_b128 a[28:31], v1 offset:704
 v_mul_f32 v42, s46, v42
 v_mfma_f32_16x16x32_bf16 v[100:103], a[84:87], v[48:51], v[100:103]
 v_exp_f32 v27, v27
 v_mfma_f32_16x16x32_bf16 v[100:103], a[116:119], v[52:55], v[100:103]
 ds_read_b128 a[32:35], v1 offset:8448
 v_cvt_pk_bf16_f32 v73, v26, v27
 v_mfma_f32_16x16x32_bf16 v[132:135], a[84:87], v[56:59], v[132:135]
 v_exp_f32 v28, v28
 v_mfma_f32_16x16x32_bf16 v[132:135], a[116:119], v[60:63], v[132:135]
 ds_read_b128 a[36:39], v1 offset:8512
 v_mul_f32 v43, s46, v43
 v_mfma_f32_16x16x32_bf16 v[104:107], a[88:91], v[48:51], v[104:107]
 v_exp_f32 v29, v29
 v_mfma_f32_16x16x32_bf16 v[104:107], a[120:123], v[52:55], v[104:107]
 ds_read_b128 a[40:43], v1 offset:8576
 v_cvt_pk_bf16_f32 v74, v28, v29
 v_mfma_f32_16x16x32_bf16 v[136:139], a[88:91], v[56:59], v[136:139]
 v_exp_f32 v30, v30
 v_mfma_f32_16x16x32_bf16 v[136:139], a[120:123], v[60:63], v[136:139]
 ds_read_b128 a[44:47], v1 offset:8640
 v_mul_f32 v44, s46, v44
 v_mfma_f32_16x16x32_bf16 v[108:111], a[92:95], v[48:51], v[108:111]
 v_exp_f32 v31, v31
 v_mfma_f32_16x16x32_bf16 v[108:111], a[124:127], v[52:55], v[108:111]
 ds_read_b128 a[48:51], v1 offset:8960
 v_cvt_pk_bf16_f32 v75, v30, v31
 v_mfma_f32_16x16x32_bf16 v[140:143], a[92:95], v[56:59], v[140:143]
 s_waitcnt lgkmcnt(9)
 v_exp_f32 v32, v32
 v_mfma_f32_16x16x32_bf16 v[140:143], a[124:127], v[60:63], v[140:143]
 ds_read_b128 a[52:55], v1 offset:9024
 v_mul_f32 v45, s46, v45
 v_mfma_f32_16x16x32_bf16 v[16:19], a[0:3], v[208:211], 0
 v_exp_f32 v33, v33
 v_mfma_f32_16x16x32_bf16 v[16:19], a[4:7], v[212:215], v[16:19]
 ds_read_b128 a[56:59], v1 offset:9088
 v_cvt_pk_bf16_f32 v68, v32, v33
 v_mfma_f32_16x16x32_bf16 v[16:19], a[8:11], v[216:219], v[16:19]
 s_waitcnt lgkmcnt(7)
 v_exp_f32 v34, v34
 v_mfma_f32_16x16x32_bf16 v[16:19], a[12:15], v[220:223], v[16:19]
 ds_read_b128 a[60:63], v1 offset:9152
 v_mul_f32 v46, s46, v46
 v_mfma_f32_16x16x32_bf16 v[20:23], a[16:19], v[208:211], 0
 v_exp_f32 v35, v35
 v_mfma_f32_16x16x32_bf16 v[20:23], a[20:23], v[212:215], v[20:23]
 v_exp_f32 v36, v36
 v_mfma_f32_16x16x32_bf16 v[20:23], a[24:27], v[216:219], v[20:23]
 v_exp_f32 v37, v37
 v_mfma_f32_16x16x32_bf16 v[20:23], a[28:31], v[220:223], v[20:23]
 v_exp_f32 v38, v38
 v_mfma_f32_16x16x32_bf16 v[24:27], a[0:3], a[164:167], 0
 v_exp_f32 v39, v39
 v_mfma_f32_16x16x32_bf16 v[24:27], a[4:7], a[168:171], v[24:27]
 v_exp_f32 v40, v40
 v_mfma_f32_16x16x32_bf16 v[24:27], a[8:11], a[172:175], v[24:27]
 v_exp_f32 v41, v41
 v_mfma_f32_16x16x32_bf16 v[24:27], a[12:15], a[176:179], v[24:27]
 v_exp_f32 v42, v42
 v_mfma_f32_16x16x32_bf16 v[28:31], a[16:19], a[164:167], 0
 v_exp_f32 v43, v43
 v_mfma_f32_16x16x32_bf16 v[28:31], a[20:23], a[168:171], v[28:31]
 s_add_u32 m0, s48, 800
 v_exp_f32 v44, v44
 v_mfma_f32_16x16x32_bf16 v[28:31], a[24:27], a[172:175], v[28:31]
 s_waitcnt lgkmcnt(4)
 buffer_load_dwordx4 v5, s[12:15], 0 offen offset:256 nt lds
 v_mfma_f32_16x16x32_bf16 v[28:31], a[28:31], a[176:179], v[28:31]
 v_cvt_pk_bf16_f32 v69, v34, v35
 v_cvt_pk_bf16_f32 v70, v36, v37
 v_mfma_f32_16x16x32_bf16 v[32:35], a[32:35], v[208:211], 0
 v_exp_f32 v45, v45
 v_mfma_f32_16x16x32_bf16 v[32:35], a[36:39], v[212:215], v[32:35]
 v_exp_f32 v46, v46
 v_mfma_f32_16x16x32_bf16 v[32:35], a[40:43], v[216:219], v[32:35]
 s_waitcnt lgkmcnt(0)
 v_exp_f32 v16, v16
 v_mfma_f32_16x16x32_bf16 v[32:35], a[44:47], v[220:223], v[32:35]
 v_cvt_pk_bf16_f32 v71, v38, v39
 v_cvt_pk_bf16_f32 v76, v40, v41
 v_mfma_f32_16x16x32_bf16 v[36:39], a[48:51], v[208:211], 0
 v_exp_f32 v17, v17
 v_mfma_f32_16x16x32_bf16 v[36:39], a[52:55], v[212:215], v[36:39]
 v_exp_f32 v18, v18
 v_mfma_f32_16x16x32_bf16 v[36:39], a[56:59], v[216:219], v[36:39]
 v_exp_f32 v19, v19
 v_mfma_f32_16x16x32_bf16 v[36:39], a[60:63], v[220:223], v[36:39]
 v_cvt_pk_bf16_f32 v77, v42, v43
 v_mul_f32 v47, s46, v47
 v_mfma_f32_16x16x32_bf16 v[40:43], a[32:35], a[164:167], 0
 v_exp_f32 v47, v47
 v_mfma_f32_16x16x32_bf16 v[40:43], a[36:39], a[168:171], v[40:43]
 v_exp_f32 v20, v20
 v_mfma_f32_16x16x32_bf16 v[40:43], a[40:43], a[172:175], v[40:43]
 v_exp_f32 v21, v21
 v_mfma_f32_16x16x32_bf16 v[40:43], a[44:47], a[176:179], v[40:43]
 v_cvt_pk_bf16_f32 v78, v44, v45
 v_cvt_pk_bf16_f32 v79, v46, v47
 v_mfma_f32_16x16x32_bf16 v[44:47], a[48:51], a[164:167], 0
 v_exp_f32 v22, v22
 v_mfma_f32_16x16x32_bf16 v[44:47], a[52:55], a[168:171], v[44:47]
 v_exp_f32 v23, v23
 v_mfma_f32_16x16x32_bf16 v[44:47], a[56:59], a[172:175], v[44:47]
 v_cvt_pk_bf16_f32 v48, v16, v17
 v_cvt_pk_bf16_f32 v49, v18, v19
 v_mfma_f32_16x16x32_bf16 v[44:47], a[60:63], a[176:179], v[44:47]
 v_cvt_pk_bf16_f32 v50, v20, v21
 v_cvt_pk_bf16_f32 v51, v22, v23
 v_smfmac_f32_16x16x64_bf16 a[140:143], a[128:131], v[64:71], v242
 s_waitcnt vmcnt(10) lgkmcnt(0)
 s_barrier
 v_smfmac_f32_16x16x64_bf16 a[144:147], a[128:131], v[72:79], v242
 s_add_u32 m0, s22, 0
 v_mul_f32 v24, s46, v24
 v_mfma_f32_16x16x32_bf16 v[144:147], a[64:67], v[64:67], v[144:147]
 buffer_load_dwordx4 v4, s[4:7], s20 offen nt lds
 v_mfma_f32_16x16x32_bf16 v[144:147], a[96:99], v[68:71], v[144:147]
 v_exp_f32 v24, v24
 v_mfma_f32_16x16x32_bf16 v[176:179], a[64:67], v[72:75], v[176:179]
 s_add_u32 m0, s22, 32
 v_mul_f32 v25, s46, v25
 v_mul_f32 v26, s46, v26
 v_mfma_f32_16x16x32_bf16 v[176:179], a[96:99], v[76:79], v[176:179]
 buffer_load_dwordx4 v4, s[4:7], s20 offen offset:1024 nt lds
 v_mfma_f32_16x16x32_bf16 v[148:151], a[68:71], v[64:67], v[148:151]
 s_add_u32 s20, s20, 8192
 ds_read_b64_tr_b16 a[64:65], v2 offset:0
 v_mul_f32 v27, s46, v27
 v_mfma_f32_16x16x32_bf16 v[148:151], a[100:103], v[68:71], v[148:151]
 s_add_u32 m0, s22, 8448
 ds_read_b64_tr_b16 a[66:67], v2 offset:512
 v_mul_f32 v28, s46, v28
 v_mfma_f32_16x16x32_bf16 v[180:183], a[68:71], v[72:75], v[180:183]
 buffer_load_dwordx4 v4, s[4:7], s20 offen nt lds
 v_mfma_f32_16x16x32_bf16 v[180:183], a[100:103], v[76:79], v[180:183]
 ds_read_b64_tr_b16 a[96:97], v2 offset:8448
 v_mul_f32 v29, s46, v29
 v_mfma_f32_16x16x32_bf16 v[152:155], a[72:75], v[64:67], v[152:155]
 s_add_u32 m0, s22, 8480
 ds_read_b64_tr_b16 a[98:99], v2 offset:8960
 v_mul_f32 v30, s46, v30
 v_mfma_f32_16x16x32_bf16 v[152:155], a[104:107], v[68:71], v[152:155]
 buffer_load_dwordx4 v4, s[4:7], s20 offen offset:1024 nt lds
 v_mfma_f32_16x16x32_bf16 v[184:187], a[72:75], v[72:75], v[184:187]
 s_add_u32 s20, s20, 8192
 ds_read_b64_tr_b16 a[68:69], v2 offset:8
 v_mul_f32 v31, s46, v31
 v_mfma_f32_16x16x32_bf16 v[184:187], a[104:107], v[76:79], v[184:187]
 ds_read_b64_tr_b16 a[70:71], v2 offset:520
 v_mul_f32 v40, s46, v40
 v_mfma_f32_16x16x32_bf16 v[156:159], a[76:79], v[64:67], v[156:159]
 ds_read_b64_tr_b16 a[100:101], v2 offset:8456
 v_mul_f32 v41, s46, v41
 v_mfma_f32_16x16x32_bf16 v[156:159], a[108:111], v[68:71], v[156:159]
 s_add_u32 m0, s48, 1600
 ds_read_b64_tr_b16 a[102:103], v2 offset:8968
 v_mul_f32 v42, s46, v42
 v_mfma_f32_16x16x32_bf16 v[188:191], a[76:79], v[72:75], v[188:191]
 buffer_load_dwordx4 v5, s[12:15], 0 offen offset:512 nt lds
 v_mfma_f32_16x16x32_bf16 v[188:191], a[108:111], v[76:79], v[188:191]
 ds_read_b64_tr_b16 a[72:73], v2 offset:64
 v_mul_f32 v43, s46, v43
 v_mfma_f32_16x16x32_bf16 v[160:163], a[80:83], v[64:67], v[160:163]
 ds_read_b64_tr_b16 a[74:75], v2 offset:576
 v_mul_f32 v44, s46, v44
 v_mfma_f32_16x16x32_bf16 v[160:163], a[112:115], v[68:71], v[160:163]
 ds_read_b64_tr_b16 a[104:105], v2 offset:8512
 v_mul_f32 v45, s46, v45
 v_mfma_f32_16x16x32_bf16 v[192:195], a[80:83], v[72:75], v[192:195]
 ds_read_b64_tr_b16 a[106:107], v2 offset:9024
 v_mul_f32 v46, s46, v46
 v_mfma_f32_16x16x32_bf16 v[192:195], a[112:115], v[76:79], v[192:195]
 ds_read_b64_tr_b16 a[76:77], v2 offset:72
 v_mul_f32 v47, s46, v47
 v_mfma_f32_16x16x32_bf16 v[164:167], a[84:87], v[64:67], v[164:167]
 v_exp_f32 v25, v25
 v_mfma_f32_16x16x32_bf16 v[164:167], a[116:119], v[68:71], v[164:167]
 ds_read_b64_tr_b16 a[78:79], v2 offset:584
 v_cvt_pk_bf16_f32 v56, v24, v25
 v_mfma_f32_16x16x32_bf16 v[196:199], a[84:87], v[72:75], v[196:199]
 v_exp_f32 v26, v26
 v_mfma_f32_16x16x32_bf16 v[196:199], a[116:119], v[76:79], v[196:199]
 v_exp_f32 v27, v27
 v_mfma_f32_16x16x32_bf16 v[168:171], a[88:91], v[64:67], v[168:171]
 ds_read_b64_tr_b16 a[108:109], v2 offset:8520
 v_cvt_pk_bf16_f32 v57, v26, v27
 v_mfma_f32_16x16x32_bf16 v[168:171], a[120:123], v[68:71], v[168:171]
 v_exp_f32 v28, v28
 v_mfma_f32_16x16x32_bf16 v[200:203], a[88:91], v[72:75], v[200:203]
 v_exp_f32 v29, v29
 v_mfma_f32_16x16x32_bf16 v[200:203], a[120:123], v[76:79], v[200:203]
 ds_read_b64_tr_b16 a[110:111], v2 offset:9032
 v_cvt_pk_bf16_f32 v58, v28, v29
 v_mfma_f32_16x16x32_bf16 v[172:175], a[92:95], v[64:67], v[172:175]
 v_exp_f32 v30, v30
 v_mfma_f32_16x16x32_bf16 v[172:175], a[124:127], v[68:71], v[172:175]
 v_exp_f32 v31, v31
 v_mfma_f32_16x16x32_bf16 v[204:207], a[92:95], v[72:75], v[204:207]
 ds_read_b64_tr_b16 a[80:81], v2 offset:128
 v_cvt_pk_bf16_f32 v59, v30, v31
 v_mfma_f32_16x16x32_bf16 v[204:207], a[124:127], v[76:79], v[204:207]
 v_exp_f32 v32, v32
 v_mfma_f32_16x16x32_bf16 v[16:19], a[0:3], v[224:227], 0
 v_exp_f32 v33, v33
 v_mfma_f32_16x16x32_bf16 v[16:19], a[4:7], v[228:231], v[16:19]
 ds_read_b64_tr_b16 a[82:83], v2 offset:640
 v_cvt_pk_bf16_f32 v52, v32, v33
 v_mfma_f32_16x16x32_bf16 v[16:19], a[8:11], v[232:235], v[16:19]
 v_exp_f32 v34, v34
 v_mfma_f32_16x16x32_bf16 v[16:19], a[12:15], v[236:239], v[16:19]
 v_exp_f32 v35, v35
 v_mfma_f32_16x16x32_bf16 v[20:23], a[16:19], v[224:227], 0
 ds_read_b64_tr_b16 a[112:113], v2 offset:8576
 v_cvt_pk_bf16_f32 v53, v34, v35
 v_mfma_f32_16x16x32_bf16 v[20:23], a[20:23], v[228:231], v[20:23]
 v_exp_f32 v36, v36
 v_mfma_f32_16x16x32_bf16 v[20:23], a[24:27], v[232:235], v[20:23]
 v_exp_f32 v37, v37
 v_mfma_f32_16x16x32_bf16 v[20:23], a[28:31], v[236:239], v[20:23]
 ds_read_b64_tr_b16 a[114:115], v2 offset:9088
 v_cvt_pk_bf16_f32 v54, v36, v37
 v_mfma_f32_16x16x32_bf16 v[24:27], a[0:3], a[180:183], 0
 v_exp_f32 v38, v38
 v_mfma_f32_16x16x32_bf16 v[24:27], a[4:7], a[184:187], v[24:27]
 v_exp_f32 v39, v39
 v_mfma_f32_16x16x32_bf16 v[24:27], a[8:11], a[188:191], v[24:27]
 ds_read_b64_tr_b16 a[84:85], v2 offset:136
 v_cvt_pk_bf16_f32 v55, v38, v39
 v_mfma_f32_16x16x32_bf16 v[24:27], a[12:15], a[192:195], v[24:27]
 v_exp_f32 v40, v40
 v_mfma_f32_16x16x32_bf16 v[28:31], a[16:19], a[180:183], 0
 v_exp_f32 v41, v41
 v_mfma_f32_16x16x32_bf16 v[28:31], a[20:23], a[184:187], v[28:31]
 s_add_u32 m0, s48, 2400
 ds_read_b64_tr_b16 a[86:87], v2 offset:648
 v_cvt_pk_bf16_f32 v60, v40, v41
 v_mfma_f32_16x16x32_bf16 v[28:31], a[24:27], a[188:191], v[28:31]
 buffer_load_dwordx4 v5, s[12:15], 0 offen offset:768 nt lds
 v_mfma_f32_16x16x32_bf16 v[28:31], a[28:31], a[192:195], v[28:31]
 ds_read_b64_tr_b16 a[116:117], v2 offset:8584
 v_mul_f32 v24, s46, v24
 v_mfma_f32_16x16x32_bf16 v[32:35], a[32:35], v[224:227], 0
 ds_read_b64_tr_b16 a[118:119], v2 offset:9096
 v_mul_f32 v25, s46, v25
 v_mfma_f32_16x16x32_bf16 v[32:35], a[36:39], v[228:231], v[32:35]
 ds_read_b64_tr_b16 a[88:89], v2 offset:192
 v_mul_f32 v26, s46, v26
 v_mfma_f32_16x16x32_bf16 v[32:35], a[40:43], v[232:235], v[32:35]
 ds_read_b64_tr_b16 a[90:91], v2 offset:704
 v_mul_f32 v27, s46, v27
 v_mfma_f32_16x16x32_bf16 v[32:35], a[44:47], v[236:239], v[32:35]
 ds_read_b64_tr_b16 a[120:121], v2 offset:8640
 v_mul_f32 v28, s46, v28
 v_mfma_f32_16x16x32_bf16 v[36:39], a[48:51], v[224:227], 0
 ds_read_b64_tr_b16 a[122:123], v2 offset:9152
 v_mul_f32 v29, s46, v29
 v_mfma_f32_16x16x32_bf16 v[36:39], a[52:55], v[228:231], v[36:39]
 ds_read_b64_tr_b16 a[92:93], v2 offset:200
 v_mul_f32 v30, s46, v30
 v_mfma_f32_16x16x32_bf16 v[36:39], a[56:59], v[232:235], v[36:39]
 v_exp_f32 v42, v42
 v_exp_f32 v43, v43
 v_mfma_f32_16x16x32_bf16 v[36:39], a[60:63], v[236:239], v[36:39]
 ds_read_b64_tr_b16 a[94:95], v2 offset:712
 v_cvt_pk_bf16_f32 v61, v42, v43
 v_mfma_f32_16x16x32_bf16 v[40:43], a[32:35], a[180:183], 0
 ds_read_b64_tr_b16 a[124:125], v2 offset:8648
 v_mul_f32 v31, s46, v31
 v_mfma_f32_16x16x32_bf16 v[40:43], a[36:39], a[184:187], v[40:43]
 ds_read_b64_tr_b16 a[126:127], v2 offset:9160
 v_mfma_f32_16x16x32_bf16 v[40:43], a[40:43], a[188:191], v[40:43]
 v_exp_f32 v44, v44
 v_exp_f32 v45, v45
 v_exp_f32 v46, v46
 v_exp_f32 v47, v47
 v_mfma_f32_16x16x32_bf16 v[40:43], a[44:47], a[192:195], v[40:43]
 v_cvt_pk_bf16_f32 v62, v44, v45
 v_cvt_pk_bf16_f32 v63, v46, v47
 v_mfma_f32_16x16x32_bf16 v[44:47], a[48:51], a[180:183], 0
 v_exp_f32 v16, v16
 v_mfma_f32_16x16x32_bf16 v[44:47], a[52:55], a[184:187], v[44:47]
 v_exp_f32 v17, v17
 v_mfma_f32_16x16x32_bf16 v[44:47], a[56:59], a[188:191], v[44:47]
 v_exp_f32 v18, v18
 v_mfma_f32_16x16x32_bf16 v[44:47], a[60:63], a[192:195], v[44:47]
 v_exp_f32 v19, v19
 v_smfmac_f32_16x16x64_bf16 a[132:135], a[128:131], v[48:55], v242
 s_waitcnt vmcnt(12) lgkmcnt(0)
 s_barrier
 v_smfmac_f32_16x16x64_bf16 a[136:139], a[128:131], v[56:63], v242
 s_add_u32 m0, s23, 0
 v_mfma_f32_16x16x32_bf16 v[80:83], a[64:67], v[48:51], v[80:83]
 buffer_load_dwordx4 v4, s[8:11], s21 offen nt lds
 v_mfma_f32_16x16x32_bf16 v[80:83], a[96:99], v[52:55], v[80:83]
 ds_read_b128 a[0:3], v1 offset:16896
 v_cvt_pk_bf16_f32 v64, v16, v17
 v_mfma_f32_16x16x32_bf16 v[112:115], a[64:67], v[56:59], v[112:115]
 s_add_u32 m0, s23, 8
 v_exp_f32 v20, v20
 v_mfma_f32_16x16x32_bf16 v[112:115], a[96:99], v[60:63], v[112:115]
 buffer_load_dwordx4 v4, s[8:11], s21 offen offset:1024 nt lds
 v_mfma_f32_16x16x32_bf16 v[84:87], a[68:71], v[48:51], v[84:87]
 s_add_u32 s21, s21, 8192
 ds_read_b128 a[4:7], v1 offset:16960
 v_cvt_pk_bf16_f32 v65, v18, v19
 v_mfma_f32_16x16x32_bf16 v[84:87], a[100:103], v[52:55], v[84:87]
 s_add_u32 m0, s23, 8448
 v_exp_f32 v21, v21
 v_mfma_f32_16x16x32_bf16 v[116:119], a[68:71], v[56:59], v[116:119]
 buffer_load_dwordx4 v4, s[8:11], s21 offen nt lds
 v_mfma_f32_16x16x32_bf16 v[116:119], a[100:103], v[60:63], v[116:119]
 ds_read_b128 a[8:11], v1 offset:17024
 v_cvt_pk_bf16_f32 v66, v20, v21
 v_mfma_f32_16x16x32_bf16 v[88:91], a[72:75], v[48:51], v[88:91]
 s_add_u32 m0, s23, 8456
 v_exp_f32 v22, v22
 v_mfma_f32_16x16x32_bf16 v[88:91], a[104:107], v[52:55], v[88:91]
 buffer_load_dwordx4 v4, s[8:11], s21 offen offset:1024 nt lds
 v_mfma_f32_16x16x32_bf16 v[120:123], a[72:75], v[56:59], v[120:123]
 s_add_u32 s21, s21, 8192
 ds_read_b128 a[12:15], v1 offset:17088
 v_mul_f32 v40, s46, v40
 v_mfma_f32_16x16x32_bf16 v[120:123], a[104:107], v[60:63], v[120:123]
 v_exp_f32 v23, v23
 v_mfma_f32_16x16x32_bf16 v[92:95], a[76:79], v[48:51], v[92:95]
 ds_read_b128 a[16:19], v1 offset:17408
 v_cvt_pk_bf16_f32 v67, v22, v23
 v_mfma_f32_16x16x32_bf16 v[92:95], a[108:111], v[52:55], v[92:95]
 s_add_u32 m0, s48, 3200
 v_exp_f32 v24, v24
 v_mfma_f32_16x16x32_bf16 v[124:127], a[76:79], v[56:59], v[124:127]
 buffer_load_dwordx4 v5, s[12:15], 0 offen offset:1024 nt lds
 v_mfma_f32_16x16x32_bf16 v[124:127], a[108:111], v[60:63], v[124:127]
 ds_read_b128 a[20:23], v1 offset:17472
 v_mul_f32 v41, s46, v41
 v_mfma_f32_16x16x32_bf16 v[96:99], a[80:83], v[48:51], v[96:99]
 v_exp_f32 v25, v25
 v_mfma_f32_16x16x32_bf16 v[96:99], a[112:115], v[52:55], v[96:99]
 ds_read_b128 a[24:27], v1 offset:17536
 v_cvt_pk_bf16_f32 v72, v24, v25
 v_mfma_f32_16x16x32_bf16 v[128:131], a[80:83], v[56:59], v[128:131]
 v_exp_f32 v26, v26
 v_mfma_f32_16x16x32_bf16 v[128:131], a[112:115], v[60:63], v[128:131]
 ds_read_b128 a[28:31], v1 offset:17600
 v_mul_f32_e64 v42, s46, v42
 v_mfma_f32_16x16x32_bf16 v[100:103], a[84:87], v[48:51], v[100:103]
L_pad2:
 s_cbranch_scc1 L_pad6
 v_exp_f32 v27, v27
 v_mfma_f32_16x16x32_bf16 v[100:103], a[116:119], v[52:55], v[100:103]
 ds_read_b128 a[32:35], v1 offset:25344
 v_cvt_pk_bf16_f32 v73, v26, v27
 v_mfma_f32_16x16x32_bf16 v[132:135], a[84:87], v[56:59], v[132:135]
 v_exp_f32 v28, v28
 v_mfma_f32_16x16x32_bf16 v[132:135], a[116:119], v[60:63], v[132:135]
 ds_read_b128 a[36:39], v1 offset:25408
 v_mul_f32 v43, s46, v43
 v_mfma_f32_16x16x32_bf16 v[104:107], a[88:91], v[48:51], v[104:107]
 v_exp_f32 v29, v29
 v_mfma_f32_16x16x32_bf16 v[104:107], a[120:123], v[52:55], v[104:107]
 ds_read_b128 a[40:43], v1 offset:25472
 v_cvt_pk_bf16_f32 v74, v28, v29
 v_mfma_f32_16x16x32_bf16 v[136:139], a[88:91], v[56:59], v[136:139]
 v_exp_f32 v30, v30
 v_mfma_f32_16x16x32_bf16 v[136:139], a[120:123], v[60:63], v[136:139]
 ds_read_b128 a[44:47], v1 offset:25536
 v_mul_f32 v44, s46, v44
 v_mfma_f32_16x16x32_bf16 v[108:111], a[92:95], v[48:51], v[108:111]
 v_exp_f32 v31, v31
 v_mfma_f32_16x16x32_bf16 v[108:111], a[124:127], v[52:55], v[108:111]
 ds_read_b128 a[48:51], v1 offset:25856
 v_cvt_pk_bf16_f32 v75, v30, v31
 v_mfma_f32_16x16x32_bf16 v[140:143], a[92:95], v[56:59], v[140:143]
 s_waitcnt lgkmcnt(9)
 v_exp_f32 v32, v32
 v_mfma_f32_16x16x32_bf16 v[140:143], a[124:127], v[60:63], v[140:143]
 ds_read_b128 a[52:55], v1 offset:25920
 v_mul_f32 v45, s46, v45
 v_mfma_f32_16x16x32_bf16 v[16:19], a[0:3], v[208:211], 0
 v_exp_f32 v33, v33
 v_mfma_f32_16x16x32_bf16 v[16:19], a[4:7], v[212:215], v[16:19]
 ds_read_b128 a[56:59], v1 offset:25984
 v_cvt_pk_bf16_f32 v68, v32, v33
 v_mfma_f32_16x16x32_bf16 v[16:19], a[8:11], v[216:219], v[16:19]
 s_waitcnt lgkmcnt(7)
 v_exp_f32 v34, v34
 v_mfma_f32_16x16x32_bf16 v[16:19], a[12:15], v[220:223], v[16:19]
 ds_read_b128 a[60:63], v1 offset:26048
 v_mul_f32 v46, s46, v46
 v_mfma_f32_16x16x32_bf16 v[20:23], a[16:19], v[208:211], 0
 v_exp_f32 v35, v35
 v_mfma_f32_16x16x32_bf16 v[20:23], a[20:23], v[212:215], v[20:23]
 v_exp_f32 v36, v36
 v_mfma_f32_16x16x32_bf16 v[20:23], a[24:27], v[216:219], v[20:23]
 v_exp_f32 v37, v37
 v_mfma_f32_16x16x32_bf16 v[20:23], a[28:31], v[220:223], v[20:23]
 v_exp_f32 v38, v38
 v_mfma_f32_16x16x32_bf16 v[24:27], a[0:3], a[164:167], 0
 v_exp_f32 v39, v39
 v_mfma_f32_16x16x32_bf16 v[24:27], a[4:7], a[168:171], v[24:27]
 v_exp_f32 v40, v40
 v_mfma_f32_16x16x32_bf16 v[24:27], a[8:11], a[172:175], v[24:27]
 v_exp_f32 v41, v41
 v_mfma_f32_16x16x32_bf16 v[24:27], a[12:15], a[176:179], v[24:27]
 v_exp_f32 v42, v42
 v_mfma_f32_16x16x32_bf16 v[28:31], a[16:19], a[164:167], 0
 v_exp_f32 v43, v43
 v_mfma_f32_16x16x32_bf16 v[28:31], a[20:23], a[168:171], v[28:31]
 s_add_u32 m0, s48, 4000
 v_exp_f32 v44, v44
 v_mfma_f32_16x16x32_bf16 v[28:31], a[24:27], a[172:175], v[28:31]
 s_waitcnt lgkmcnt(4)
 buffer_load_dwordx4 v5, s[12:15], 0 offen offset:1280 nt lds
 v_mfma_f32_16x16x32_bf16 v[28:31], a[28:31], a[176:179], v[28:31]
 v_cvt_pk_bf16_f32 v69, v34, v35
 v_cvt_pk_bf16_f32 v70, v36, v37
 v_mfma_f32_16x16x32_bf16 v[32:35], a[32:35], v[208:211], 0
 v_exp_f32 v45, v45
 v_mfma_f32_16x16x32_bf16 v[32:35], a[36:39], v[212:215], v[32:35]
 v_exp_f32 v46, v46
 v_mfma_f32_16x16x32_bf16 v[32:35], a[40:43], v[216:219], v[32:35]
 s_waitcnt lgkmcnt(0)
 v_exp_f32 v16, v16
 v_mfma_f32_16x16x32_bf16 v[32:35], a[44:47], v[220:223], v[32:35]
 v_cvt_pk_bf16_f32 v71, v38, v39
 v_cvt_pk_bf16_f32 v76, v40, v41
 v_mfma_f32_16x16x32_bf16 v[36:39], a[48:51], v[208:211], 0
 v_exp_f32 v17, v17
 v_mfma_f32_16x16x32_bf16 v[36:39], a[52:55], v[212:215], v[36:39]
 v_exp_f32 v18, v18
 v_mfma_f32_16x16x32_bf16 v[36:39], a[56:59], v[216:219], v[36:39]
 v_exp_f32 v19, v19
 v_mfma_f32_16x16x32_bf16 v[36:39], a[60:63], v[220:223], v[36:39]
 v_cvt_pk_bf16_f32 v77, v42, v43
 v_mul_f32 v47, s46, v47
 v_mfma_f32_16x16x32_bf16 v[40:43], a[32:35], a[164:167], 0
 v_exp_f32 v47, v47
 v_mfma_f32_16x16x32_bf16 v[40:43], a[36:39], a[168:171], v[40:43]
 v_exp_f32 v20, v20
 v_mfma_f32_16x16x32_bf16 v[40:43], a[40:43], a[172:175], v[40:43]
 v_exp_f32 v21, v21
 v_mfma_f32_16x16x32_bf16 v[40:43], a[44:47], a[176:179], v[40:43]
 v_cvt_pk_bf16_f32 v78, v44, v45
 v_cvt_pk_bf16_f32 v79, v46, v47
 v_mfma_f32_16x16x32_bf16 v[44:47], a[48:51], a[164:167], 0
 v_exp_f32 v22, v22
 v_mfma_f32_16x16x32_bf16 v[44:47], a[52:55], a[168:171], v[44:47]
 v_exp_f32 v23, v23
 v_mfma_f32_16x16x32_bf16 v[44:47], a[56:59], a[172:175], v[44:47]
 v_cvt_pk_bf16_f32 v48, v16, v17
 v_cvt_pk_bf16_f32 v49, v18, v19
 v_mfma_f32_16x16x32_bf16 v[44:47], a[60:63], a[176:179], v[44:47]
 v_cvt_pk_bf16_f32 v50, v20, v21
 v_cvt_pk_bf16_f32 v51, v22, v23
 v_smfmac_f32_16x16x64_bf16 a[140:143], a[128:131], v[64:71], v242
 s_waitcnt vmcnt(14) lgkmcnt(0)
 s_barrier
 v_smfmac_f32_16x16x64_bf16 a[144:147], a[128:131], v[72:79], v242
 s_add_u32 m0, s22, 16896
 v_mul_f32 v24, s46, v24
 v_mfma_f32_16x16x32_bf16 v[144:147], a[64:67], v[64:67], v[144:147]
 buffer_load_dwordx4 v4, s[4:7], s20 offen nt lds
 v_mfma_f32_16x16x32_bf16 v[144:147], a[96:99], v[68:71], v[144:147]
 v_exp_f32 v24, v24
 v_mfma_f32_16x16x32_bf16 v[176:179], a[64:67], v[72:75], v[176:179]
 s_add_u32 m0, s22, 16928
 v_mul_f32 v25, s46, v25
 v_mul_f32 v26, s46, v26
 v_mfma_f32_16x16x32_bf16 v[176:179], a[96:99], v[76:79], v[176:179]
 buffer_load_dwordx4 v4, s[4:7], s20 offen offset:1024 nt lds
 v_mfma_f32_16x16x32_bf16 v[148:151], a[68:71], v[64:67], v[148:151]
 s_add_u32 s20, s20, 8192
 ds_read_b64_tr_b16 a[64:65], v2 offset:16896
 v_mul_f32 v27, s46, v27
 v_mfma_f32_16x16x32_bf16 v[148:151], a[100:103], v[68:71], v[148:151]
 s_add_u32 m0, s22, 25344
 ds_read_b64_tr_b16 a[66:67], v2 offset:17408
 v_mul_f32 v28, s46, v28
 v_mfma_f32_16x16x32_bf16 v[180:183], a[68:71], v[72:75], v[180:183]
 buffer_load_dwordx4 v4, s[4:7], s20 offen nt lds
 v_mfma_f32_16x16x32_bf16 v[180:183], a[100:103], v[76:79], v[180:183]
 ds_read_b64_tr_b16 a[96:97], v2 offset:25344
 v_mul_f32 v29, s46, v29
 v_mfma_f32_16x16x32_bf16 v[152:155], a[72:75], v[64:67], v[152:155]
 s_add_u32 m0, s22, 25376
 ds_read_b64_tr_b16 a[98:99], v2 offset:25856
 v_mul_f32 v30, s46, v30
 v_mfma_f32_16x16x32_bf16 v[152:155], a[104:107], v[68:71], v[152:155]
 buffer_load_dwordx4 v4, s[4:7], s20 offen offset:1024 nt lds
 v_mfma_f32_16x16x32_bf16 v[184:187], a[72:75], v[72:75], v[184:187]
 s_add_u32 s20, s20, 8192
 ds_read_b64_tr_b16 a[68:69], v2 offset:16904
 v_mul_f32 v31, s46, v31
 v_mfma_f32_16x16x32_bf16 v[184:187], a[104:107], v[76:79], v[184:187]
 ds_read_b64_tr_b16 a[70:71], v2 offset:17416
 v_mul_f32 v40, s46, v40
 v_mfma_f32_16x16x32_bf16 v[156:159], a[76:79], v[64:67], v[156:159]
 ds_read_b64_tr_b16 a[100:101], v2 offset:25352
 v_mul_f32 v41, s46, v41
 v_mfma_f32_16x16x32_bf16 v[156:159], a[108:111], v[68:71], v[156:159]
 s_add_u32 m0, s48, 4800
 ds_read_b64_tr_b16 a[102:103], v2 offset:25864
 v_mul_f32 v42, s46, v42
 v_mfma_f32_16x16x32_bf16 v[188:191], a[76:79], v[72:75], v[188:191]
 buffer_load_dwordx4 v5, s[12:15], 0 offen offset:1536 nt lds
 v_mfma_f32_16x16x32_bf16 v[188:191], a[108:111], v[76:79], v[188:191]
 ds_read_b64_tr_b16 a[72:73], v2 offset:16960
 v_mul_f32 v43, s46, v43
 v_mfma_f32_16x16x32_bf16 v[160:163], a[80:83], v[64:67], v[160:163]
 ds_read_b64_tr_b16 a[74:75], v2 offset:17472
 v_mul_f32 v44, s46, v44
 v_mfma_f32_16x16x32_bf16 v[160:163], a[112:115], v[68:71], v[160:163]
 ds_read_b64_tr_b16 a[104:105], v2 offset:25408
 v_mul_f32 v45, s46, v45
 v_mfma_f32_16x16x32_bf16 v[192:195], a[80:83], v[72:75], v[192:195]
 ds_read_b64_tr_b16 a[106:107], v2 offset:25920
 v_mul_f32 v46, s46, v46
 v_mfma_f32_16x16x32_bf16 v[192:195], a[112:115], v[76:79], v[192:195]
 ds_read_b64_tr_b16 a[76:77], v2 offset:16968
 v_mul_f32 v47, s46, v47
 v_mfma_f32_16x16x32_bf16 v[164:167], a[84:87], v[64:67], v[164:167]
 v_exp_f32 v25, v25
 v_mfma_f32_16x16x32_bf16 v[164:167], a[116:119], v[68:71], v[164:167]
 ds_read_b64_tr_b16 a[78:79], v2 offset:17480
 v_cvt_pk_bf16_f32 v56, v24, v25
 v_mfma_f32_16x16x32_bf16 v[196:199], a[84:87], v[72:75], v[196:199]
 v_exp_f32 v26, v26
 v_mfma_f32_16x16x32_bf16 v[196:199], a[116:119], v[76:79], v[196:199]
 v_exp_f32 v27, v27
 v_mfma_f32_16x16x32_bf16 v[168:171], a[88:91], v[64:67], v[168:171]
 ds_read_b64_tr_b16 a[108:109], v2 offset:25416
 v_cvt_pk_bf16_f32 v57, v26, v27
 v_mfma_f32_16x16x32_bf16 v[168:171], a[120:123], v[68:71], v[168:171]
 v_exp_f32 v28, v28
 v_mfma_f32_16x16x32_bf16 v[200:203], a[88:91], v[72:75], v[200:203]
 v_exp_f32 v29, v29
 v_mfma_f32_16x16x32_bf16 v[200:203], a[120:123], v[76:79], v[200:203]
 ds_read_b64_tr_b16 a[110:111], v2 offset:25928
 v_cvt_pk_bf16_f32 v58, v28, v29
 v_mfma_f32_16x16x32_bf16 v[172:175], a[92:95], v[64:67], v[172:175]
 v_exp_f32 v30, v30
 v_mfma_f32_16x16x32_bf16 v[172:175], a[124:127], v[68:71], v[172:175]
 v_exp_f32 v31, v31
 v_mfma_f32_16x16x32_bf16 v[204:207], a[92:95], v[72:75], v[204:207]
 ds_read_b64_tr_b16 a[80:81], v2 offset:17024
 v_cvt_pk_bf16_f32 v59, v30, v31
 v_mfma_f32_16x16x32_bf16 v[204:207], a[124:127], v[76:79], v[204:207]
 v_exp_f32 v32, v32
 v_mfma_f32_16x16x32_bf16 v[16:19], a[0:3], v[224:227], 0
 v_exp_f32 v33, v33
 v_mfma_f32_16x16x32_bf16 v[16:19], a[4:7], v[228:231], v[16:19]
 ds_read_b64_tr_b16 a[82:83], v2 offset:17536
 v_cvt_pk_bf16_f32 v52, v32, v33
 v_mfma_f32_16x16x32_bf16 v[16:19], a[8:11], v[232:235], v[16:19]
 v_exp_f32 v34, v34
 v_mfma_f32_16x16x32_bf16 v[16:19], a[12:15], v[236:239], v[16:19]
 v_exp_f32 v35, v35
 v_mfma_f32_16x16x32_bf16 v[20:23], a[16:19], v[224:227], 0
 ds_read_b64_tr_b16 a[112:113], v2 offset:25472
 v_cvt_pk_bf16_f32 v53, v34, v35
 v_mfma_f32_16x16x32_bf16 v[20:23], a[20:23], v[228:231], v[20:23]
 v_exp_f32 v36, v36
 v_mfma_f32_16x16x32_bf16 v[20:23], a[24:27], v[232:235], v[20:23]
 v_exp_f32 v37, v37
 v_mfma_f32_16x16x32_bf16 v[20:23], a[28:31], v[236:239], v[20:23]
 ds_read_b64_tr_b16 a[114:115], v2 offset:25984
 v_cvt_pk_bf16_f32 v54, v36, v37
 v_mfma_f32_16x16x32_bf16 v[24:27], a[0:3], a[180:183], 0
 v_exp_f32 v38, v38
 v_mfma_f32_16x16x32_bf16 v[24:27], a[4:7], a[184:187], v[24:27]
 v_exp_f32 v39, v39
 v_mfma_f32_16x16x32_bf16 v[24:27], a[8:11], a[188:191], v[24:27]
 ds_read_b64_tr_b16 a[84:85], v2 offset:17032
 v_cvt_pk_bf16_f32 v55, v38, v39
 v_mfma_f32_16x16x32_bf16 v[24:27], a[12:15], a[192:195], v[24:27]
 v_exp_f32 v40, v40
 v_mfma_f32_16x16x32_bf16 v[28:31], a[16:19], a[180:183], 0
 v_exp_f32 v41, v41
 v_mfma_f32_16x16x32_bf16 v[28:31], a[20:23], a[184:187], v[28:31]
 s_add_u32 m0, s48, 5600
 ds_read_b64_tr_b16 a[86:87], v2 offset:17544
 v_cvt_pk_bf16_f32 v60, v40, v41
 v_mfma_f32_16x16x32_bf16 v[28:31], a[24:27], a[188:191], v[28:31]
 buffer_load_dwordx4 v5, s[12:15], 0 offen offset:1792 nt lds
 v_mfma_f32_16x16x32_bf16 v[28:31], a[28:31], a[192:195], v[28:31]
 ds_read_b64_tr_b16 a[116:117], v2 offset:25480
 v_mul_f32 v24, s46, v24
 v_mfma_f32_16x16x32_bf16 v[32:35], a[32:35], v[224:227], 0
 ds_read_b64_tr_b16 a[118:119], v2 offset:25992
 v_mul_f32 v25, s46, v25
 v_mfma_f32_16x16x32_bf16 v[32:35], a[36:39], v[228:231], v[32:35]
 ds_read_b64_tr_b16 a[88:89], v2 offset:17088
 v_mul_f32 v26, s46, v26
 v_mfma_f32_16x16x32_bf16 v[32:35], a[40:43], v[232:235], v[32:35]
 ds_read_b64_tr_b16 a[90:91], v2 offset:17600
 v_mul_f32 v27, s46, v27
 v_mfma_f32_16x16x32_bf16 v[32:35], a[44:47], v[236:239], v[32:35]
 ds_read_b64_tr_b16 a[120:121], v2 offset:25536
 v_mul_f32 v28, s46, v28
 v_mfma_f32_16x16x32_bf16 v[36:39], a[48:51], v[224:227], 0
 ds_read_b64_tr_b16 a[122:123], v2 offset:26048
 v_mul_f32 v29, s46, v29
 v_mfma_f32_16x16x32_bf16 v[36:39], a[52:55], v[228:231], v[36:39]
 ds_read_b64_tr_b16 a[92:93], v2 offset:17096
 v_mul_f32 v30, s46, v30
 v_mfma_f32_16x16x32_bf16 v[36:39], a[56:59], v[232:235], v[36:39]
 v_exp_f32 v42, v42
 v_exp_f32 v43, v43
 v_mfma_f32_16x16x32_bf16 v[36:39], a[60:63], v[236:239], v[36:39]
 ds_read_b64_tr_b16 a[94:95], v2 offset:17608
 v_cvt_pk_bf16_f32 v61, v42, v43
 v_mfma_f32_16x16x32_bf16 v[40:43], a[32:35], a[180:183], 0
 ds_read_b64_tr_b16 a[124:125], v2 offset:25544
 v_mul_f32 v31, s46, v31
 v_mfma_f32_16x16x32_bf16 v[40:43], a[36:39], a[184:187], v[40:43]
 ds_read_b64_tr_b16 a[126:127], v2 offset:26056
 v_mfma_f32_16x16x32_bf16 v[40:43], a[40:43], a[188:191], v[40:43]
 v_exp_f32 v44, v44
 v_exp_f32 v45, v45
 v_exp_f32 v46, v46
 v_exp_f32 v47, v47
 v_mfma_f32_16x16x32_bf16 v[40:43], a[44:47], a[192:195], v[40:43]
 v_cvt_pk_bf16_f32 v62, v44, v45
 v_cvt_pk_bf16_f32 v63, v46, v47
 v_mfma_f32_16x16x32_bf16 v[44:47], a[48:51], a[180:183], 0
 v_exp_f32 v16, v16
 v_mfma_f32_16x16x32_bf16 v[44:47], a[52:55], a[184:187], v[44:47]
 v_exp_f32 v17, v17
 v_mfma_f32_16x16x32_bf16 v[44:47], a[56:59], a[188:191], v[44:47]
 v_exp_f32 v18, v18
 v_mfma_f32_16x16x32_bf16 v[44:47], a[60:63], a[192:195], v[44:47]
 v_exp_f32 v19, v19
 v_smfmac_f32_16x16x64_bf16 a[132:135], a[128:131], v[48:55], v242
 s_waitcnt vmcnt(14) lgkmcnt(0)
 s_barrier
 v_smfmac_f32_16x16x64_bf16 a[136:139], a[128:131], v[56:63], v242
 s_add_u32 m0, s23, 16896
 v_mfma_f32_16x16x32_bf16 v[80:83], a[64:67], v[48:51], v[80:83]
 buffer_load_dwordx4 v4, s[8:11], s21 offen nt lds
 v_mfma_f32_16x16x32_bf16 v[80:83], a[96:99], v[52:55], v[80:83]
 ds_read_b128 a[0:3], v1 offset:0
 v_cvt_pk_bf16_f32 v64, v16, v17
 v_mfma_f32_16x16x32_bf16 v[112:115], a[64:67], v[56:59], v[112:115]
 s_add_u32 m0, s23, 16904
 v_exp_f32 v20, v20
 v_mfma_f32_16x16x32_bf16 v[112:115], a[96:99], v[60:63], v[112:115]
 buffer_load_dwordx4 v4, s[8:11], s21 offen offset:1024 nt lds
 v_mfma_f32_16x16x32_bf16 v[84:87], a[68:71], v[48:51], v[84:87]
 s_add_u32 s21, s21, 8192
 ds_read_b128 a[4:7], v1 offset:64
 v_cvt_pk_bf16_f32 v65, v18, v19
 v_mfma_f32_16x16x32_bf16 v[84:87], a[100:103], v[52:55], v[84:87]
 s_add_u32 m0, s23, 25344
 v_exp_f32 v21, v21
 v_mfma_f32_16x16x32_bf16 v[116:119], a[68:71], v[56:59], v[116:119]
 buffer_load_dwordx4 v4, s[8:11], s21 offen nt lds
 v_mfma_f32_16x16x32_bf16 v[116:119], a[100:103], v[60:63], v[116:119]
 ds_read_b128 a[8:11], v1 offset:128
 v_cvt_pk_bf16_f32 v66, v20, v21
 v_mfma_f32_16x16x32_bf16 v[88:91], a[72:75], v[48:51], v[88:91]
 s_add_u32 m0, s23, 25352
 v_exp_f32 v22, v22
 v_mfma_f32_16x16x32_bf16 v[88:91], a[104:107], v[52:55], v[88:91]
 buffer_load_dwordx4 v4, s[8:11], s21 offen offset:1024 nt lds
 v_mfma_f32_16x16x32_bf16 v[120:123], a[72:75], v[56:59], v[120:123]
 s_add_u32 s21, s21, 8192
 ds_read_b128 a[12:15], v1 offset:192
 v_mul_f32 v40, s46, v40
 v_mfma_f32_16x16x32_bf16 v[120:123], a[104:107], v[60:63], v[120:123]
 v_exp_f32 v23, v23
 v_mfma_f32_16x16x32_bf16 v[92:95], a[76:79], v[48:51], v[92:95]
 ds_read_b128 a[16:19], v1 offset:512
 v_cvt_pk_bf16_f32 v67, v22, v23
 v_mfma_f32_16x16x32_bf16 v[92:95], a[108:111], v[52:55], v[92:95]
 s_add_u32 m0, s48, 8448
 v_exp_f32 v24, v24
 v_mfma_f32_16x16x32_bf16 v[124:127], a[76:79], v[56:59], v[124:127]
 buffer_load_dwordx4 v5, s[12:15], s25 offen nt lds
 v_mfma_f32_16x16x32_bf16 v[124:127], a[108:111], v[60:63], v[124:127]
 ds_read_b128 a[20:23], v1 offset:576
 v_mul_f32 v41, s46, v41
 v_mfma_f32_16x16x32_bf16 v[96:99], a[80:83], v[48:51], v[96:99]
 v_exp_f32 v25, v25
 v_mfma_f32_16x16x32_bf16 v[96:99], a[112:115], v[52:55], v[96:99]
 ds_read_b128 a[24:27], v1 offset:640
 v_cvt_pk_bf16_f32 v72, v24, v25
 v_mfma_f32_16x16x32_bf16 v[128:131], a[80:83], v[56:59], v[128:131]
 v_exp_f32 v26, v26
 v_mfma_f32_16x16x32_bf16 v[128:131], a[112:115], v[60:63], v[128:131]
 ds_read_b128 a[28:31], v1 offset:704
 v_mul_f32 v42, s46, v42
 v_mfma_f32_16x16x32_bf16 v[100:103], a[84:87], v[48:51], v[100:103]
 v_exp_f32 v27, v27
 v_mfma_f32_16x16x32_bf16 v[100:103], a[116:119], v[52:55], v[100:103]
 ds_read_b128 a[32:35], v1 offset:8448
 v_cvt_pk_bf16_f32 v73, v26, v27
 v_mfma_f32_16x16x32_bf16 v[132:135], a[84:87], v[56:59], v[132:135]
 v_exp_f32 v28, v28
 v_mfma_f32_16x16x32_bf16 v[132:135], a[116:119], v[60:63], v[132:135]
 ds_read_b128 a[36:39], v1 offset:8512
 v_mul_f32 v43, s46, v43
 v_mfma_f32_16x16x32_bf16 v[104:107], a[88:91], v[48:51], v[104:107]
 v_exp_f32 v29, v29
 v_mfma_f32_16x16x32_bf16 v[104:107], a[120:123], v[52:55], v[104:107]
 ds_read_b128 a[40:43], v1 offset:8576
 v_cvt_pk_bf16_f32 v74, v28, v29
 v_mfma_f32_16x16x32_bf16 v[136:139], a[88:91], v[56:59], v[136:139]
 v_exp_f32 v30, v30
 v_mfma_f32_16x16x32_bf16 v[136:139], a[120:123], v[60:63], v[136:139]
 ds_read_b128 a[44:47], v1 offset:8640
 v_mul_f32 v44, s46, v44
 v_mfma_f32_16x16x32_bf16 v[108:111], a[92:95], v[48:51], v[108:111]
 v_exp_f32 v31, v31
 v_mfma_f32_16x16x32_bf16 v[108:111], a[124:127], v[52:55], v[108:111]
 ds_read_b128 a[48:51], v1 offset:8960
 v_cvt_pk_bf16_f32 v75, v30, v31
 v_mfma_f32_16x16x32_bf16 v[140:143], a[92:95], v[56:59], v[140:143]
 s_waitcnt lgkmcnt(9)
 v_exp_f32 v32, v32
 v_mfma_f32_16x16x32_bf16 v[140:143], a[124:127], v[60:63], v[140:143]
 ds_read_b128 a[52:55], v1 offset:9024
 v_mul_f32 v45, s46, v45
 v_mfma_f32_16x16x32_bf16 v[16:19], a[0:3], v[208:211], 0
 v_exp_f32 v33, v33
 v_mfma_f32_16x16x32_bf16 v[16:19], a[4:7], v[212:215], v[16:19]
 ds_read_b128 a[56:59], v1 offset:9088
 v_cvt_pk_bf16_f32 v68, v32, v33
 v_mfma_f32_16x16x32_bf16 v[16:19], a[8:11], v[216:219], v[16:19]
 s_waitcnt lgkmcnt(7)
 v_exp_f32 v34, v34
 v_mfma_f32_16x16x32_bf16 v[16:19], a[12:15], v[220:223], v[16:19]
 ds_read_b128 a[60:63], v1 offset:9152
 v_mul_f32 v46, s46, v46
 v_mfma_f32_16x16x32_bf16 v[20:23], a[16:19], v[208:211], 0
 v_exp_f32 v35, v35
 v_mfma_f32_16x16x32_bf16 v[20:23], a[20:23], v[212:215], v[20:23]
 v_exp_f32 v36, v36
 v_mfma_f32_16x16x32_bf16 v[20:23], a[24:27], v[216:219], v[20:23]
 v_exp_f32 v37, v37
 v_mfma_f32_16x16x32_bf16 v[20:23], a[28:31], v[220:223], v[20:23]
 v_exp_f32 v38, v38
 v_mfma_f32_16x16x32_bf16 v[24:27], a[0:3], a[164:167], 0
 v_exp_f32 v39, v39
 v_mfma_f32_16x16x32_bf16 v[24:27], a[4:7], a[168:171], v[24:27]
 v_exp_f32 v40, v40
 v_mfma_f32_16x16x32_bf16 v[24:27], a[8:11], a[172:175], v[24:27]
 v_exp_f32 v41, v41
 v_mfma_f32_16x16x32_bf16 v[24:27], a[12:15], a[176:179], v[24:27]
 v_exp_f32 v42, v42
 v_mfma_f32_16x16x32_bf16 v[28:31], a[16:19], a[164:167], 0
 v_exp_f32 v43, v43
 v_mfma_f32_16x16x32_bf16 v[28:31], a[20:23], a[168:171], v[28:31]
 s_add_u32 m0, s48, 9248
 v_exp_f32 v44, v44
 v_mfma_f32_16x16x32_bf16 v[28:31], a[24:27], a[172:175], v[28:31]
 s_waitcnt lgkmcnt(4)
 buffer_load_dwordx4 v5, s[12:15], s25 offen offset:256 nt lds
 v_mfma_f32_16x16x32_bf16 v[28:31], a[28:31], a[176:179], v[28:31]
 v_cvt_pk_bf16_f32 v69, v34, v35
 v_cvt_pk_bf16_f32 v70, v36, v37
 v_mfma_f32_16x16x32_bf16 v[32:35], a[32:35], v[208:211], 0
 v_exp_f32 v45, v45
 v_mfma_f32_16x16x32_bf16 v[32:35], a[36:39], v[212:215], v[32:35]
 v_exp_f32 v46, v46
 v_mfma_f32_16x16x32_bf16 v[32:35], a[40:43], v[216:219], v[32:35]
 s_waitcnt lgkmcnt(0)
 v_exp_f32 v16, v16
 v_mfma_f32_16x16x32_bf16 v[32:35], a[44:47], v[220:223], v[32:35]
 v_cvt_pk_bf16_f32 v71, v38, v39
 v_cvt_pk_bf16_f32 v76, v40, v41
 v_mfma_f32_16x16x32_bf16 v[36:39], a[48:51], v[208:211], 0
 v_exp_f32 v17, v17
 v_mfma_f32_16x16x32_bf16 v[36:39], a[52:55], v[212:215], v[36:39]
 v_exp_f32 v18, v18
 v_mfma_f32_16x16x32_bf16 v[36:39], a[56:59], v[216:219], v[36:39]
 v_exp_f32 v19, v19
 v_mfma_f32_16x16x32_bf16 v[36:39], a[60:63], v[220:223], v[36:39]
 v_cvt_pk_bf16_f32 v77, v42, v43
 v_mul_f32 v47, s46, v47
 v_mfma_f32_16x16x32_bf16 v[40:43], a[32:35], a[164:167], 0
 v_exp_f32 v47, v47
 v_mfma_f32_16x16x32_bf16 v[40:43], a[36:39], a[168:171], v[40:43]
 v_exp_f32 v20, v20
 v_mfma_f32_16x16x32_bf16 v[40:43], a[40:43], a[172:175], v[40:43]
 v_exp_f32 v21, v21
 v_mfma_f32_16x16x32_bf16 v[40:43], a[44:47], a[176:179], v[40:43]
 v_cvt_pk_bf16_f32 v78, v44, v45
 v_cvt_pk_bf16_f32 v79, v46, v47
 v_mfma_f32_16x16x32_bf16 v[44:47], a[48:51], a[164:167], 0
 v_exp_f32 v22, v22
 v_mfma_f32_16x16x32_bf16 v[44:47], a[52:55], a[168:171], v[44:47]
 v_exp_f32 v23, v23
 v_mfma_f32_16x16x32_bf16 v[44:47], a[56:59], a[172:175], v[44:47]
 v_cvt_pk_bf16_f32 v48, v16, v17
 v_cvt_pk_bf16_f32 v49, v18, v19
 v_mfma_f32_16x16x32_bf16 v[44:47], a[60:63], a[176:179], v[44:47]
 s_cmp_eq_u32 s24, 3
 s_cbranch_scc1 L_last
 v_smfmac_f32_16x16x64_bf16 a[140:143], a[128:131], v[64:71], v242
 s_waitcnt vmcnt(14) lgkmcnt(0)
 s_barrier
 v_smfmac_f32_16x16x64_bf16 a[144:147], a[128:131], v[72:79], v242
 s_add_u32 m0, s22, 0
 v_cvt_pk_bf16_f32 v50, v20, v21
 v_mfma_f32_16x16x32_bf16 v[144:147], a[64:67], v[64:67], v[144:147]
 buffer_load_dwordx4 v4, s[4:7], s20 offen nt lds
 v_mfma_f32_16x16x32_bf16 v[144:147], a[96:99], v[68:71], v[144:147]
 v_cvt_pk_bf16_f32 v51, v22, v23
 v_mul_f32 v24, s46, v24
 v_mfma_f32_16x16x32_bf16 v[176:179], a[64:67], v[72:75], v[176:179]
 s_add_u32 m0, s22, 32
 v_exp_f32 v24, v24
 v_mfma_f32_16x16x32_bf16 v[176:179], a[96:99], v[76:79], v[176:179]
 buffer_load_dwordx4 v4, s[4:7], s20 offen offset:1024 nt lds
 v_mfma_f32_16x16x32_bf16 v[148:151], a[68:71], v[64:67], v[148:151]
 s_add_u32 s20, s20, 8192
 ds_read_b64_tr_b16 a[64:65], v2 offset:0
 v_mul_f32 v25, s46, v25
 v_mfma_f32_16x16x32_bf16 v[148:151], a[100:103], v[68:71], v[148:151]
 s_add_u32 m0, s22, 8448
 ds_read_b64_tr_b16 a[66:67], v2 offset:512
 v_mul_f32 v26, s46, v26
 v_mfma_f32_16x16x32_bf16 v[180:183], a[68:71], v[72:75], v[180:183]
 buffer_load_dwordx4 v4, s[4:7], s20 offen nt lds
 v_mfma_f32_16x16x32_bf16 v[180:183], a[100:103], v[76:79], v[180:183]
 ds_read_b64_tr_b16 a[96:97], v2 offset:8448
 v_mul_f32 v27, s46, v27
 v_mfma_f32_16x16x32_bf16 v[152:155], a[72:75], v[64:67], v[152:155]
 s_add_u32 m0, s22, 8480
 ds_read_b64_tr_b16 a[98:99], v2 offset:8960
 v_mul_f32 v28, s46, v28
 v_mfma_f32_16x16x32_bf16 v[152:155], a[104:107], v[68:71], v[152:155]
 buffer_load_dwordx4 v4, s[4:7], s20 offen offset:1024 nt lds
 v_mfma_f32_16x16x32_bf16 v[184:187], a[72:75], v[72:75], v[184:187]
 s_add_u32 s20, s20, 8192
 ds_read_b64_tr_b16 a[68:69], v2 offset:8
 v_mul_f32 v29, s46, v29
 v_mfma_f32_16x16x32_bf16 v[184:187], a[104:107], v[76:79], v[184:187]
 ds_read_b64_tr_b16 a[70:71], v2 offset:520
 v_mul_f32 v30, s46, v30
 v_mfma_f32_16x16x32_bf16 v[156:159], a[76:79], v[64:67], v[156:159]
 ds_read_b64_tr_b16 a[100:101], v2 offset:8456
 v_mul_f32 v31, s46, v31
 v_mfma_f32_16x16x32_bf16 v[156:159], a[108:111], v[68:71], v[156:159]
 s_add_u32 m0, s48, 10048
 ds_read_b64_tr_b16 a[102:103], v2 offset:8968
 v_mul_f32 v40, s46, v40
 v_mfma_f32_16x16x32_bf16 v[188:191], a[76:79], v[72:75], v[188:191]
 buffer_load_dwordx4 v5, s[12:15], s25 offen offset:512 nt lds
 v_mfma_f32_16x16x32_bf16 v[188:191], a[108:111], v[76:79], v[188:191]
 ds_read_b64_tr_b16 a[72:73], v2 offset:64
 v_mul_f32 v41, s46, v41
 v_mfma_f32_16x16x32_bf16 v[160:163], a[80:83], v[64:67], v[160:163]
 ds_read_b64_tr_b16 a[74:75], v2 offset:576
 v_mul_f32 v42, s46, v42
 v_mfma_f32_16x16x32_bf16 v[160:163], a[112:115], v[68:71], v[160:163]
 ds_read_b64_tr_b16 a[104:105], v2 offset:8512
 v_mul_f32 v43, s46, v43
 v_mfma_f32_16x16x32_bf16 v[192:195], a[80:83], v[72:75], v[192:195]
 ds_read_b64_tr_b16 a[106:107], v2 offset:9024
 v_mul_f32 v44, s46, v44
 v_mfma_f32_16x16x32_bf16 v[192:195], a[112:115], v[76:79], v[192:195]
 ds_read_b64_tr_b16 a[76:77], v2 offset:72
 v_mul_f32 v45, s46, v45
 v_mfma_f32_16x16x32_bf16 v[164:167], a[84:87], v[64:67], v[164:167]
 ds_read_b64_tr_b16 a[78:79], v2 offset:584
 v_mul_f32 v46, s46, v46
 v_mfma_f32_16x16x32_bf16 v[164:167], a[116:119], v[68:71], v[164:167]
 ds_read_b64_tr_b16 a[108:109], v2 offset:8520
 v_mul_f32 v47, s46, v47
 v_mfma_f32_16x16x32_bf16 v[196:199], a[84:87], v[72:75], v[196:199]
 v_exp_f32 v25, v25
 v_mfma_f32_16x16x32_bf16 v[196:199], a[116:119], v[76:79], v[196:199]
 ds_read_b64_tr_b16 a[110:111], v2 offset:9032
 v_cvt_pk_bf16_f32 v56, v24, v25
 v_mfma_f32_16x16x32_bf16 v[168:171], a[88:91], v[64:67], v[168:171]
 v_exp_f32 v26, v26
 v_mfma_f32_16x16x32_bf16 v[168:171], a[120:123], v[68:71], v[168:171]
 v_exp_f32 v27, v27
 v_mfma_f32_16x16x32_bf16 v[200:203], a[88:91], v[72:75], v[200:203]
 ds_read_b64_tr_b16 a[80:81], v2 offset:128
 v_cvt_pk_bf16_f32 v57, v26, v27
 v_mfma_f32_16x16x32_bf16 v[200:203], a[120:123], v[76:79], v[200:203]
 v_exp_f32 v28, v28
 v_mfma_f32_16x16x32_bf16 v[172:175], a[92:95], v[64:67], v[172:175]
 v_exp_f32 v29, v29
 v_mfma_f32_16x16x32_bf16 v[172:175], a[124:127], v[68:71], v[172:175]
 ds_read_b64_tr_b16 a[82:83], v2 offset:640
 v_cvt_pk_bf16_f32 v58, v28, v29
 v_mfma_f32_16x16x32_bf16 v[204:207], a[92:95], v[72:75], v[204:207]
 v_exp_f32 v30, v30
 v_mfma_f32_16x16x32_bf16 v[204:207], a[124:127], v[76:79], v[204:207]
 v_exp_f32 v31, v31
 v_mfma_f32_16x16x32_bf16 v[16:19], a[0:3], v[224:227], 0
 ds_read_b64_tr_b16 a[112:113], v2 offset:8576
 v_cvt_pk_bf16_f32 v59, v30, v31
 v_mfma_f32_16x16x32_bf16 v[16:19], a[4:7], v[228:231], v[16:19]
 v_exp_f32 v32, v32
 v_mfma_f32_16x16x32_bf16 v[16:19], a[8:11], v[232:235], v[16:19]
 v_exp_f32 v33, v33
 v_mfma_f32_16x16x32_bf16 v[16:19], a[12:15], v[236:239], v[16:19]
 ds_read_b64_tr_b16 a[114:115], v2 offset:9088
 v_cvt_pk_bf16_f32 v52, v32, v33
 v_mfma_f32_16x16x32_bf16 v[20:23], a[16:19], v[224:227], 0
 v_exp_f32 v34, v34
 v_mfma_f32_16x16x32_bf16 v[20:23], a[20:23], v[228:231], v[20:23]
 v_exp_f32 v35, v35
 v_mfma_f32_16x16x32_bf16 v[20:23], a[24:27], v[232:235], v[20:23]
 ds_read_b64_tr_b16 a[84:85], v2 offset:136
 v_cvt_pk_bf16_f32 v53, v34, v35
 v_mfma_f32_16x16x32_bf16 v[20:23], a[28:31], v[236:239], v[20:23]
 v_exp_f32 v36, v36
 v_mfma_f32_16x16x32_bf16 v[24:27], a[0:3], a[180:183], 0
 v_exp_f32 v37, v37
 v_mfma_f32_16x16x32_bf16 v[24:27], a[4:7], a[184:187], v[24:27]
 ds_read_b64_tr_b16 a[86:87], v2 offset:648
 v_cvt_pk_bf16_f32 v54, v36, v37
 v_mfma_f32_16x16x32_bf16 v[24:27], a[8:11], a[188:191], v[24:27]
 v_exp_f32 v38, v38
 v_mfma_f32_16x16x32_bf16 v[24:27], a[12:15], a[192:195], v[24:27]
 v_exp_f32 v39, v39
 v_mfma_f32_16x16x32_bf16 v[28:31], a[16:19], a[180:183], 0
 ds_read_b64_tr_b16 a[116:117], v2 offset:8584
 v_cvt_pk_bf16_f32 v55, v38, v39
 v_mfma_f32_16x16x32_bf16 v[28:31], a[20:23], a[184:187], v[28:31]
 s_add_u32 m0, s48, 10848
 v_exp_f32 v40, v40
 v_mfma_f32_16x16x32_bf16 v[28:31], a[24:27], a[188:191], v[28:31]
 buffer_load_dwordx4 v5, s[12:15], s25 offen offset:768 nt lds
 v_mfma_f32_16x16x32_bf16 v[28:31], a[28:31], a[192:195], v[28:31]
 ds_read_b64_tr_b16 a[118:119], v2 offset:9096
 v_mul_f32 v24, s46, v24
 v_mfma_f32_16x16x32_bf16 v[32:35], a[32:35], v[224:227], 0
 ds_read_b64_tr_b16 a[88:89], v2 offset:192
 v_mul_f32 v25, s46, v25
 v_mfma_f32_16x16x32_bf16 v[32:35], a[36:39], v[228:231], v[32:35]
 ds_read_b64_tr_b16 a[90:91], v2 offset:704
 v_mul_f32 v26, s46, v26
 v_mfma_f32_16x16x32_bf16 v[32:35], a[40:43], v[232:235], v[32:35]
 ds_read_b64_tr_b16 a[120:121], v2 offset:8640
 v_mul_f32 v27, s46, v27
 v_mfma_f32_16x16x32_bf16 v[32:35], a[44:47], v[236:239], v[32:35]
 ds_read_b64_tr_b16 a[122:123], v2 offset:9152
 v_mul_f32 v28, s46, v28
 v_mfma_f32_16x16x32_bf16 v[36:39], a[48:51], v[224:227], 0
 ds_read_b64_tr_b16 a[92:93], v2 offset:200
 v_mul_f32 v29, s46, v29
 v_mfma_f32_16x16x32_bf16 v[36:39], a[52:55], v[228:231], v[36:39]
 ds_read_b64_tr_b16 a[94:95], v2 offset:712
 v_mul_f32 v30, s46, v30
 v_mfma_f32_16x16x32_bf16 v[36:39], a[56:59], v[232:235], v[36:39]
 v_exp_f32 v41, v41
 v_exp_f32 v42, v42
 v_exp_f32 v43, v43
 v_mfma_f32_16x16x32_bf16 v[36:39], a[60:63], v[236:239], v[36:39]
L_pad3:
 s_cbranch_scc1 L_pad7
 v_cvt_pk_bf16_f32 v60, v40, v41
 v_cvt_pk_bf16_f32 v61, v42, v43
 v_mfma_f32_16x16x32_bf16 v[40:43], a[32:35], a[180:183], 0
 ds_read_b64_tr_b16 a[124:125], v2 offset:8648
 v_mul_f32 v31, s46, v31
 v_mfma_f32_16x16x32_bf16 v[40:43], a[36:39], a[184:187], v[40:43]
 ds_read_b64_tr_b16 a[126:127], v2 offset:9160
 v_mfma_f32_16x16x32_bf16 v[40:43], a[40:43], a[188:191], v[40:43]
 v_exp_f32 v44, v44
 v_exp_f32 v45, v45
 v_exp_f32 v46, v46
 v_exp_f32 v47, v47
 v_mfma_f32_16x16x32_bf16 v[40:43], a[44:47], a[192:195], v[40:43]
 v_cvt_pk_bf16_f32 v62, v44, v45
 v_cvt_pk_bf16_f32 v63, v46, v47
 v_mfma_f32_16x16x32_bf16 v[44:47], a[48:51], a[180:183], 0
 v_exp_f32 v16, v16
 v_mfma_f32_16x16x32_bf16 v[44:47], a[52:55], a[184:187], v[44:47]
 v_exp_f32 v17, v17
 v_mfma_f32_16x16x32_bf16 v[44:47], a[56:59], a[188:191], v[44:47]
 v_exp_f32 v18, v18
 v_mfma_f32_16x16x32_bf16 v[44:47], a[60:63], a[192:195], v[44:47]
 v_exp_f32 v19, v19
 v_smfmac_f32_16x16x64_bf16 a[132:135], a[128:131], v[48:55], v242
 s_waitcnt vmcnt(14) lgkmcnt(0)
 s_barrier
 v_smfmac_f32_16x16x64_bf16 a[136:139], a[128:131], v[56:63], v242
 s_add_u32 m0, s23, 0
 v_mfma_f32_16x16x32_bf16 v[80:83], a[64:67], v[48:51], v[80:83]
 buffer_load_dwordx4 v4, s[8:11], s21 offen nt lds
 v_mfma_f32_16x16x32_bf16 v[80:83], a[96:99], v[52:55], v[80:83]
 ds_read_b128 a[0:3], v1 offset:16896
 v_cvt_pk_bf16_f32 v64, v16, v17
 v_mfma_f32_16x16x32_bf16 v[112:115], a[64:67], v[56:59], v[112:115]
 s_add_u32 m0, s23, 8
 v_exp_f32 v20, v20
 v_mfma_f32_16x16x32_bf16 v[112:115], a[96:99], v[60:63], v[112:115]
 buffer_load_dwordx4 v4, s[8:11], s21 offen offset:1024 nt lds
 v_mfma_f32_16x16x32_bf16 v[84:87], a[68:71], v[48:51], v[84:87]
 s_add_u32 s21, s21, 8192
 ds_read_b128 a[4:7], v1 offset:16960
 v_cvt_pk_bf16_f32 v65, v18, v19
 v_mfma_f32_16x16x32_bf16 v[84:87], a[100:103], v[52:55], v[84:87]
 s_add_u32 m0, s23, 8448
 v_exp_f32 v21, v21
 v_mfma_f32_16x16x32_bf16 v[116:119], a[68:71], v[56:59], v[116:119]
 buffer_load_dwordx4 v4, s[8:11], s21 offen nt lds
 v_mfma_f32_16x16x32_bf16 v[116:119], a[100:103], v[60:63], v[116:119]
 ds_read_b128 a[8:11], v1 offset:17024
 v_cvt_pk_bf16_f32 v66, v20, v21
 v_mfma_f32_16x16x32_bf16 v[88:91], a[72:75], v[48:51], v[88:91]
 s_add_u32 m0, s23, 8456
 v_exp_f32 v22, v22
 v_mfma_f32_16x16x32_bf16 v[88:91], a[104:107], v[52:55], v[88:91]
 buffer_load_dwordx4 v4, s[8:11], s21 offen offset:1024 nt lds
 v_mfma_f32_16x16x32_bf16 v[120:123], a[72:75], v[56:59], v[120:123]
 s_add_u32 s21, s21, 8192
 ds_read_b128 a[12:15], v1 offset:17088
 v_mul_f32 v40, s46, v40
 v_mfma_f32_16x16x32_bf16 v[120:123], a[104:107], v[60:63], v[120:123]
 v_exp_f32 v23, v23
 v_mfma_f32_16x16x32_bf16 v[92:95], a[76:79], v[48:51], v[92:95]
 ds_read_b128 a[16:19], v1 offset:17408
 v_cvt_pk_bf16_f32 v67, v22, v23
 v_mfma_f32_16x16x32_bf16 v[92:95], a[108:111], v[52:55], v[92:95]
 s_add_u32 m0, s48, 11648
 v_exp_f32 v24, v24
 v_mfma_f32_16x16x32_bf16 v[124:127], a[76:79], v[56:59], v[124:127]
 buffer_load_dwordx4 v5, s[12:15], s25 offen offset:1024 nt lds
 v_mfma_f32_16x16x32_bf16 v[124:127], a[108:111], v[60:63], v[124:127]
 ds_read_b128 a[20:23], v1 offset:17472
 v_mul_f32 v41, s46, v41
 v_mfma_f32_16x16x32_bf16 v[96:99], a[80:83], v[48:51], v[96:99]
 v_exp_f32 v25, v25
 v_mfma_f32_16x16x32_bf16 v[96:99], a[112:115], v[52:55], v[96:99]
 ds_read_b128 a[24:27], v1 offset:17536
 v_cvt_pk_bf16_f32 v72, v24, v25
 v_mfma_f32_16x16x32_bf16 v[128:131], a[80:83], v[56:59], v[128:131]
 v_exp_f32 v26, v26
 v_mfma_f32_16x16x32_bf16 v[128:131], a[112:115], v[60:63], v[128:131]
 ds_read_b128 a[28:31], v1 offset:17600
 v_mul_f32 v42, s46, v42
 v_mfma_f32_16x16x32_bf16 v[100:103], a[84:87], v[48:51], v[100:103]
 v_exp_f32 v27, v27
 v_mfma_f32_16x16x32_bf16 v[100:103], a[116:119], v[52:55], v[100:103]
 ds_read_b128 a[32:35], v1 offset:25344
 v_cvt_pk_bf16_f32 v73, v26, v27
 v_mfma_f32_16x16x32_bf16 v[132:135], a[84:87], v[56:59], v[132:135]
 v_exp_f32 v28, v28
 v_mfma_f32_16x16x32_bf16 v[132:135], a[116:119], v[60:63], v[132:135]
 ds_read_b128 a[36:39], v1 offset:25408
 v_mul_f32 v43, s46, v43
 v_mfma_f32_16x16x32_bf16 v[104:107], a[88:91], v[48:51], v[104:107]
 v_exp_f32 v29, v29
 v_mfma_f32_16x16x32_bf16 v[104:107], a[120:123], v[52:55], v[104:107]
 ds_read_b128 a[40:43], v1 offset:25472
 v_cvt_pk_bf16_f32 v74, v28, v29
 v_mfma_f32_16x16x32_bf16 v[136:139], a[88:91], v[56:59], v[136:139]
 v_exp_f32 v30, v30
 v_mfma_f32_16x16x32_bf16 v[136:139], a[120:123], v[60:63], v[136:139]
 ds_read_b128 a[44:47], v1 offset:25536
 v_mul_f32 v44, s46, v44
 v_mfma_f32_16x16x32_bf16 v[108:111], a[92:95], v[48:51], v[108:111]
 v_exp_f32 v31, v31
 v_mfma_f32_16x16x32_bf16 v[108:111], a[124:127], v[52:55], v[108:111]
 ds_read_b128 a[48:51], v1 offset:25856
 v_cvt_pk_bf16_f32 v75, v30, v31
 v_mfma_f32_16x16x32_bf16 v[140:143], a[92:95], v[56:59], v[140:143]
 s_waitcnt lgkmcnt(9)
 v_exp_f32 v32, v32
 v_mfma_f32_16x16x32_bf16 v[140:143], a[124:127], v[60:63], v[140:143]
 ds_read_b128 a[52:55], v1 offset:25920
 v_mul_f32 v45, s46, v45
 v_mfma_f32_16x16x32_bf16 v[16:19], a[0:3], v[208:211], 0
 v_exp_f32 v33, v33
 v_mfma_f32_16x16x32_bf16 v[16:19], a[4:7], v[212:215], v[16:19]
 ds_read_b128 a[56:59], v1 offset:25984
 v_cvt_pk_bf16_f32 v68, v32, v33
 v_mfma_f32_16x16x32_bf16 v[16:19], a[8:11], v[216:219], v[16:19]
 s_waitcnt lgkmcnt(7)
 v_exp_f32 v34, v34
 v_mfma_f32_16x16x32_bf16 v[16:19], a[12:15], v[220:223], v[16:19]
 ds_read_b128 a[60:63], v1 offset:26048
 v_mul_f32 v46, s46, v46
 v_mfma_f32_16x16x32_bf16 v[20:23], a[16:19], v[208:211], 0
 v_exp_f32 v35, v35
 v_mfma_f32_16x16x32_bf16 v[20:23], a[20:23], v[212:215], v[20:23]
 v_exp_f32 v36, v36
 v_mfma_f32_16x16x32_bf16 v[20:23], a[24:27], v[216:219], v[20:23]
 v_exp_f32 v37, v37
 v_mfma_f32_16x16x32_bf16 v[20:23], a[28:31], v[220:223], v[20:23]
 v_exp_f32 v38, v38
 v_mfma_f32_16x16x32_bf16 v[24:27], a[0:3], a[164:167], 0
 v_exp_f32 v39, v39
 v_mfma_f32_16x16x32_bf16 v[24:27], a[4:7], a[168:171], v[24:27]
 v_exp_f32 v40, v40
 v_mfma_f32_16x16x32_bf16 v[24:27], a[8:11], a[172:175], v[24:27]
 v_exp_f32 v41, v41
 v_mfma_f32_16x16x32_bf16 v[24:27], a[12:15], a[176:179], v[24:27]
 v_exp_f32 v42, v42
 v_mfma_f32_16x16x32_bf16 v[28:31], a[16:19], a[164:167], 0
 v_exp_f32 v43, v43
 v_mfma_f32_16x16x32_bf16 v[28:31], a[20:23], a[168:171], v[28:31]
 s_add_u32 m0, s48, 12448
 v_exp_f32 v44, v44
 v_mfma_f32_16x16x32_bf16 v[28:31], a[24:27], a[172:175], v[28:31]
 s_waitcnt lgkmcnt(4)
 buffer_load_dwordx4 v5, s[12:15], s25 offen offset:1280 nt lds
 v_mfma_f32_16x16x32_bf16 v[28:31], a[28:31], a[176:179], v[28:31]
 v_cvt_pk_bf16_f32 v69, v34, v35
 v_cvt_pk_bf16_f32 v70, v36, v37
 v_mfma_f32_16x16x32_bf16 v[32:35], a[32:35], v[208:211], 0
 v_exp_f32 v45, v45
 v_mfma_f32_16x16x32_bf16 v[32:35], a[36:39], v[212:215], v[32:35]
 v_exp_f32 v46, v46
 v_mfma_f32_16x16x32_bf16 v[32:35], a[40:43], v[216:219], v[32:35]
 s_waitcnt lgkmcnt(0)
 v_exp_f32 v16, v16
 v_mfma_f32_16x16x32_bf16 v[32:35], a[44:47], v[220:223], v[32:35]
 v_cvt_pk_bf16_f32 v71, v38, v39
 v_cvt_pk_bf16_f32 v76, v40, v41
 v_mfma_f32_16x16x32_bf16 v[36:39], a[48:51], v[208:211], 0
 v_exp_f32 v17, v17
 v_mfma_f32_16x16x32_bf16 v[36:39], a[52:55], v[212:215], v[36:39]
 v_exp_f32 v18, v18
 v_mfma_f32_16x16x32_bf16 v[36:39], a[56:59], v[216:219], v[36:39]
 v_exp_f32 v19, v19
 v_mfma_f32_16x16x32_bf16 v[36:39], a[60:63], v[220:223], v[36:39]
 v_cvt_pk_bf16_f32 v77, v42, v43
 v_mul_f32 v47, s46, v47
 v_mfma_f32_16x16x32_bf16 v[40:43], a[32:35], a[164:167], 0
 v_exp_f32 v47, v47
 v_mfma_f32_16x16x32_bf16 v[40:43], a[36:39], a[168:171], v[40:43]
 v_exp_f32 v20, v20
 v_mfma_f32_16x16x32_bf16 v[40:43], a[40:43], a[172:175], v[40:43]
 v_exp_f32 v21, v21
 v_mfma_f32_16x16x32_bf16 v[40:43], a[44:47], a[176:179], v[40:43]
 v_cvt_pk_bf16_f32 v78, v44, v45
 v_cvt_pk_bf16_f32 v79, v46, v47
 v_mfma_f32_16x16x32_bf16 v[44:47], a[48:51], a[164:167], 0
 v_exp_f32 v22, v22
 v_mfma_f32_16x16x32_bf16 v[44:47], a[52:55], a[168:171], v[44:47]
 v_exp_f32 v23, v23
 v_mfma_f32_16x16x32_bf16 v[44:47], a[56:59], a[172:175], v[44:47]
 v_cvt_pk_bf16_f32 v48, v16, v17
 v_cvt_pk_bf16_f32 v49, v18, v19
 v_mfma_f32_16x16x32_bf16 v[44:47], a[60:63], a[176:179], v[44:47]
 v_cvt_pk_bf16_f32 v50, v20, v21
 v_cvt_pk_bf16_f32 v51, v22, v23
 v_smfmac_f32_16x16x64_bf16 a[140:143], a[128:131], v[64:71], v242
 s_waitcnt vmcnt(14) lgkmcnt(0)
 s_barrier
 v_smfmac_f32_16x16x64_bf16 a[144:147], a[128:131], v[72:79], v242
 s_add_u32 m0, s22, 16896
 s_waitcnt vmcnt(18)
 ds_read_b128 v[208:211], v3 offset:0
 v_mfma_f32_16x16x32_bf16 v[144:147], a[64:67], v[64:67], v[144:147]
 buffer_load_dwordx4 v4, s[4:7], s20 offen nt lds
 v_mfma_f32_16x16x32_bf16 v[144:147], a[96:99], v[68:71], v[144:147]
 ds_read_b128 v[212:215], v3 offset:64
 v_mul_f32 v24, s46, v24
 v_mfma_f32_16x16x32_bf16 v[176:179], a[64:67], v[72:75], v[176:179]
 s_add_u32 m0, s22, 16928
 v_exp_f32 v24, v24
 v_mfma_f32_16x16x32_bf16 v[176:179], a[96:99], v[76:79], v[176:179]
 buffer_load_dwordx4 v4, s[4:7], s20 offen offset:1024 nt lds
 v_mfma_f32_16x16x32_bf16 v[148:151], a[68:71], v[64:67], v[148:151]
 s_add_u32 s20, s20, 8192
 ds_read_b128 v[216:219], v3 offset:128
 v_mul_f32 v25, s46, v25
 v_mfma_f32_16x16x32_bf16 v[148:151], a[100:103], v[68:71], v[148:151]
 s_add_u32 m0, s22, 25344
 s_waitcnt lgkmcnt(2)
 v_lshlrev_b32 v12, 16, v208
 v_and_b32 v13, s27, v208
 v_lshlrev_b32 v14, 16, v209
 v_and_b32_e64 v15, s27, v209
 v_pk_mul_f32 v[12:13], v[12:13], s[46:47]
 v_pk_mul_f32 v[14:15], v[14:15], s[46:47]
 v_cvt_pk_bf16_f32 v208, v12, v13
 v_cvt_pk_bf16_f32 v209, v14, v15
 v_lshlrev_b32 v12, 16, v210
 v_and_b32 v13, s27, v210
 v_lshlrev_b32 v14, 16, v211
 v_and_b32 v15, s27, v211
 v_pk_mul_f32 v[12:13], v[12:13], s[46:47]
 v_pk_mul_f32 v[14:15], v[14:15], s[46:47]
 v_cvt_pk_bf16_f32 v210, v12, v13
 v_cvt_pk_bf16_f32 v211, v14, v15
 v_mfma_f32_16x16x32_bf16 v[180:183], a[68:71], v[72:75], v[180:183]
 buffer_load_dwordx4 v4, s[4:7], s20 offen nt lds
 v_mfma_f32_16x16x32_bf16 v[180:183], a[100:103], v[76:79], v[180:183]
 ds_read_b128 v[220:223], v3 offset:192
 v_mul_f32 v26, s46, v26
 v_mfma_f32_16x16x32_bf16 v[152:155], a[72:75], v[64:67], v[152:155]
 s_add_u32 m0, s22, 25376
 ds_read_b64_tr_b16 a[64:65], v2 offset:16896
 v_mul_f32 v27, s46, v27
 v_mfma_f32_16x16x32_bf16 v[152:155], a[104:107], v[68:71], v[152:155]
 buffer_load_dwordx4 v4, s[4:7], s20 offen offset:1024 nt lds
 v_mfma_f32_16x16x32_bf16 v[184:187], a[72:75], v[72:75], v[184:187]
 s_add_u32 s20, s20, 8192
 s_waitcnt lgkmcnt(3)
 v_lshlrev_b32 v12, 16, v212
 v_and_b32 v13, s27, v212
 v_lshlrev_b32 v14, 16, v213
 v_and_b32_e64 v15, s27, v213
 v_pk_mul_f32 v[12:13], v[12:13], s[46:47]
 v_pk_mul_f32 v[14:15], v[14:15], s[46:47]
 v_cvt_pk_bf16_f32 v212, v12, v13
 v_cvt_pk_bf16_f32 v213, v14, v15
 v_lshlrev_b32 v12, 16, v214
 v_and_b32 v13, s27, v214
 v_lshlrev_b32 v14, 16, v215
 v_and_b32 v15, s27, v215
 v_pk_mul_f32 v[12:13], v[12:13], s[46:47]
 v_pk_mul_f32 v[14:15], v[14:15], s[46:47]
 v_cvt_pk_bf16_f32 v214, v12, v13
 v_cvt_pk_bf16_f32 v215, v14, v15
 v_mfma_f32_16x16x32_bf16 v[184:187], a[104:107], v[76:79], v[184:187]
 ds_read_b128 a[164:167], v3 offset:512
 v_mul_f32 v28, s46, v28
 v_mfma_f32_16x16x32_bf16 v[156:159], a[76:79], v[64:67], v[156:159]
 ds_read_b64_tr_b16 a[66:67], v2 offset:17408
 v_mul_f32 v29, s46, v29
 v_mfma_f32_16x16x32_bf16 v[156:159], a[108:111], v[68:71], v[156:159]
 s_add_u32 m0, s48, 13248
 ds_read_b128 a[168:171], v3 offset:576
 v_mul_f32 v30, s46, v30
 v_mfma_f32_16x16x32_bf16 v[188:191], a[76:79], v[72:75], v[188:191]
 buffer_load_dwordx4 v5, s[12:15], s25 offen offset:1536 nt lds
 v_mfma_f32_16x16x32_bf16 v[188:191], a[108:111], v[76:79], v[188:191]
 s_waitcnt lgkmcnt(5)
 v_lshlrev_b32 v12, 16, v216
 v_and_b32 v13, s27, v216
 v_lshlrev_b32 v14, 16, v217
 v_and_b32 v15, s27, v217
 v_pk_mul_f32 v[12:13], v[12:13], s[46:47]
 v_pk_mul_f32 v[14:15], v[14:15], s[46:47]
 v_cvt_pk_bf16_f32 v216, v12, v13
 v_cvt_pk_bf16_f32 v217, v14, v15
 v_lshlrev_b32 v12, 16, v218
 v_and_b32 v13, s27, v218
 v_lshlrev_b32 v14, 16, v219
 v_and_b32 v15, s27, v219
 v_pk_mul_f32 v[12:13], v[12:13], s[46:47]
 v_pk_mul_f32 v[14:15], v[14:15], s[46:47]
 v_cvt_pk_bf16_f32 v218, v12, v13
 v_cvt_pk_bf16_f32 v219, v14, v15
 v_mfma_f32_16x16x32_bf16 v[160:163], a[80:83], v[64:67], v[160:163]
 ds_read_b128 a[172:175], v3 offset:640
 v_mul_f32 v31, s46, v31
 v_mfma_f32_16x16x32_bf16 v[160:163], a[112:115], v[68:71], v[160:163]
 ds_read_b64_tr_b16 a[96:97], v2 offset:25344
 v_mul_f32 v40, s46, v40
 v_mfma_f32_16x16x32_bf16 v[192:195], a[80:83], v[72:75], v[192:195]
 ds_read_b128 a[176:179], v3 offset:704
 v_mul_f32 v41, s46, v41
 v_mfma_f32_16x16x32_bf16 v[192:195], a[112:115], v[76:79], v[192:195]
 ds_read_b64_tr_b16 a[98:99], v2 offset:25856
 v_mul_f32 v42, s46, v42
 v_mfma_f32_16x16x32_bf16 v[164:167], a[84:87], v[64:67], v[164:167]
 s_waitcnt lgkmcnt(8)
 v_lshlrev_b32 v12, 16, v220
 v_and_b32 v13, s27, v220
 v_lshlrev_b32 v14, 16, v221
 v_and_b32_e64 v15, s27, v221
 v_pk_mul_f32 v[12:13], v[12:13], s[46:47]
 v_pk_mul_f32 v[14:15], v[14:15], s[46:47]
 v_cvt_pk_bf16_f32 v220, v12, v13
 v_cvt_pk_bf16_f32 v221, v14, v15
 v_lshlrev_b32 v12, 16, v222
 v_and_b32 v13, s27, v222
 v_lshlrev_b32 v14, 16, v223
 v_and_b32 v15, s27, v223
 v_pk_mul_f32 v[12:13], v[12:13], s[46:47]
 v_pk_mul_f32 v[14:15], v[14:15], s[46:47]
 v_cvt_pk_bf16_f32 v222, v12, v13
 v_cvt_pk_bf16_f32 v223, v14, v15
 v_mfma_f32_16x16x32_bf16 v[164:167], a[116:119], v[68:71], v[164:167]
 ds_read_b64_tr_b16 a[68:69], v2 offset:16904
 v_mul_f32 v43, s46, v43
 v_mfma_f32_16x16x32_bf16 v[196:199], a[84:87], v[72:75], v[196:199]
 ds_read_b64_tr_b16 a[70:71], v2 offset:17416
 v_mul_f32 v44, s46, v44
 v_mfma_f32_16x16x32_bf16 v[196:199], a[116:119], v[76:79], v[196:199]
 ds_read_b64_tr_b16 a[100:101], v2 offset:25352
 v_mul_f32 v45, s46, v45
 v_mfma_f32_16x16x32_bf16 v[168:171], a[88:91], v[64:67], v[168:171]
 ds_read_b64_tr_b16 a[102:103], v2 offset:25864
 v_mul_f32 v46, s46, v46
 v_mfma_f32_16x16x32_bf16 v[168:171], a[120:123], v[68:71], v[168:171]
 ds_read_b64_tr_b16 a[72:73], v2 offset:16960
 v_mul_f32 v47, s46, v47
 v_mfma_f32_16x16x32_bf16 v[200:203], a[88:91], v[72:75], v[200:203]
 v_exp_f32 v25, v25
 v_mfma_f32_16x16x32_bf16 v[200:203], a[120:123], v[76:79], v[200:203]
 ds_read_b64_tr_b16 a[74:75], v2 offset:17472
 v_cvt_pk_bf16_f32 v56, v24, v25
 v_mfma_f32_16x16x32_bf16 v[172:175], a[92:95], v[64:67], v[172:175]
 v_exp_f32 v26, v26
 v_mfma_f32_16x16x32_bf16 v[172:175], a[124:127], v[68:71], v[172:175]
 v_exp_f32 v27, v27
 v_mfma_f32_16x16x32_bf16 v[204:207], a[92:95], v[72:75], v[204:207]
 ds_read_b64_tr_b16 a[104:105], v2 offset:25408
 v_cvt_pk_bf16_f32 v57, v26, v27
 v_mfma_f32_16x16x32_bf16 v[204:207], a[124:127], v[76:79], v[204:207]
 v_exp_f32 v28, v28
 v_mfma_f32_16x16x32_bf16 v[16:19], a[0:3], v[224:227], 0
 v_exp_f32 v29, v29
 v_mfma_f32_16x16x32_bf16 v[16:19], a[4:7], v[228:231], v[16:19]
 ds_read_b64_tr_b16 a[106:107], v2 offset:25920
 v_cvt_pk_bf16_f32 v58, v28, v29
 v_mfma_f32_16x16x32_bf16 v[16:19], a[8:11], v[232:235], v[16:19]
 v_exp_f32 v30, v30
 v_mfma_f32_16x16x32_bf16 v[16:19], a[12:15], v[236:239], v[16:19]
 v_exp_f32 v31, v31
 v_mfma_f32_16x16x32_bf16 v[20:23], a[16:19], v[224:227], 0
 ds_read_b64_tr_b16 a[76:77], v2 offset:16968
 v_cvt_pk_bf16_f32 v59, v30, v31
 v_mfma_f32_16x16x32_bf16 v[20:23], a[20:23], v[228:231], v[20:23]
 v_exp_f32 v32, v32
 v_mfma_f32_16x16x32_bf16 v[20:23], a[24:27], v[232:235], v[20:23]
 v_exp_f32 v33, v33
 v_mfma_f32_16x16x32_bf16 v[20:23], a[28:31], v[236:239], v[20:23]
 ds_read_b64_tr_b16 a[78:79], v2 offset:17480
 v_cvt_pk_bf16_f32 v52, v32, v33
 v_mfma_f32_16x16x32_bf16 v[24:27], a[0:3], a[180:183], 0
 ds_read_b64_tr_b16 a[108:109], v2 offset:25416
 ds_read_b64_tr_b16 a[110:111], v2 offset:25928
 v_mfma_f32_16x16x32_bf16 v[24:27], a[4:7], a[184:187], v[24:27]
 v_exp_f32 v34, v34
 v_mfma_f32_16x16x32_bf16 v[24:27], a[8:11], a[188:191], v[24:27]
 ds_read_b64_tr_b16 a[80:81], v2 offset:17024
 ds_read_b64_tr_b16 a[82:83], v2 offset:17536
 v_mfma_f32_16x16x32_bf16 v[24:27], a[12:15], a[192:195], v[24:27]
 v_exp_f32 v35, v35
 v_mfma_f32_16x16x32_bf16 v[28:31], a[16:19], a[180:183], 0
 ds_read_b64_tr_b16 a[112:113], v2 offset:25472
 v_cvt_pk_bf16_f32 v53, v34, v35
 v_mfma_f32_16x16x32_bf16 v[28:31], a[20:23], a[184:187], v[28:31]
 s_add_u32 m0, s48, 14048
 ds_read_b64_tr_b16 a[114:115], v2 offset:25984
 ds_read_b64_tr_b16 a[84:85], v2 offset:17032
 v_mfma_f32_16x16x32_bf16 v[28:31], a[24:27], a[188:191], v[28:31]
 buffer_load_dwordx4 v5, s[12:15], s25 offen offset:1792 nt lds
 v_mfma_f32_16x16x32_bf16 v[28:31], a[28:31], a[192:195], v[28:31]
 ds_read_b64_tr_b16 a[86:87], v2 offset:17544
 v_mul_f32 v24, s46, v24
 v_mfma_f32_16x16x32_bf16 v[32:35], a[32:35], v[224:227], 0
 s_add_u32 s12, s12, 253952
 s_addc_u32 s13, s13, 0
 ds_read_b64_tr_b16 a[116:117], v2 offset:25480
 v_mfma_f32_16x16x32_bf16 v[32:35], a[36:39], v[228:231], v[32:35]
 s_cmp_lt_u32 s24, 2
 s_cselect_b32 s14, 253952, 0
 ds_read_b64_tr_b16 a[118:119], v2 offset:25992
 v_mfma_f32_16x16x32_bf16 v[32:35], a[40:43], v[232:235], v[32:35]
 ds_read_b64_tr_b16 a[88:89], v2 offset:17088
 v_exp_f32 v36, v36
 v_exp_f32 v37, v37
 v_exp_f32 v38, v38
 v_exp_f32 v39, v39
 v_mfma_f32_16x16x32_bf16 v[32:35], a[44:47], v[236:239], v[32:35]
 ds_read_b64_tr_b16 a[90:91], v2 offset:17600
 v_cvt_pk_bf16_f32 v54, v36, v37
 v_cvt_pk_bf16_f32 v55, v38, v39
 v_mfma_f32_16x16x32_bf16 v[36:39], a[48:51], v[224:227], 0
 ds_read_b64_tr_b16 a[120:121], v2 offset:25536
 v_mul_f32 v25, s46, v25
 v_mfma_f32_16x16x32_bf16 v[36:39], a[52:55], v[228:231], v[36:39]
 ds_read_b64_tr_b16 a[122:123], v2 offset:26048
 v_mul_f32 v26, s46, v26
 v_mfma_f32_16x16x32_bf16 v[36:39], a[56:59], v[232:235], v[36:39]
 ds_read_b64_tr_b16 a[92:93], v2 offset:17096
 v_exp_f32 v40, v40
 v_exp_f32 v41, v41
 v_exp_f32 v42, v42
 v_exp_f32 v43, v43
 v_mfma_f32_16x16x32_bf16 v[36:39], a[60:63], v[236:239], v[36:39]
 ds_read_b64_tr_b16 a[94:95], v2 offset:17608
 v_cvt_pk_bf16_f32 v60, v40, v41
 v_cvt_pk_bf16_f32 v61, v42, v43
 v_mfma_f32_16x16x32_bf16 v[40:43], a[32:35], a[180:183], 0
 ds_read_b64_tr_b16 a[124:125], v2 offset:25544
 v_mul_f32 v27, s46, v27
 v_mfma_f32_16x16x32_bf16 v[40:43], a[36:39], a[184:187], v[40:43]
 ds_read_b64_tr_b16 a[126:127], v2 offset:26056
 v_mul_f32 v28, s46, v28
 v_mfma_f32_16x16x32_bf16 v[40:43], a[40:43], a[188:191], v[40:43]
 v_exp_f32 v44, v44
 v_exp_f32 v45, v45
 v_exp_f32 v46, v46
 v_exp_f32 v47, v47
 v_mfma_f32_16x16x32_bf16 v[40:43], a[44:47], a[192:195], v[40:43]
 v_cvt_pk_bf16_f32 v62, v44, v45
 v_cvt_pk_bf16_f32 v63, v46, v47
 v_mfma_f32_16x16x32_bf16 v[44:47], a[48:51], a[180:183], 0
 v_exp_f32 v16, v16
 v_mfma_f32_16x16x32_bf16 v[44:47], a[52:55], a[184:187], v[44:47]
 v_exp_f32 v17, v17
 v_mfma_f32_16x16x32_bf16 v[44:47], a[56:59], a[188:191], v[44:47]
 v_exp_f32 v18, v18
 v_mfma_f32_16x16x32_bf16 v[44:47], a[60:63], a[192:195], v[44:47]
 v_exp_f32 v19, v19
 v_smfmac_f32_16x16x64_bf16 a[132:135], a[128:131], v[48:55], v242
 s_waitcnt vmcnt(14) lgkmcnt(0)
 s_barrier
 v_smfmac_f32_16x16x64_bf16 a[136:139], a[128:131], v[56:63], v242
 s_add_u32 m0, s23, 16896
 v_mfma_f32_16x16x32_bf16 v[80:83], a[64:67], v[48:51], v[80:83]
 buffer_load_dwordx4 v4, s[8:11], s21 offen nt lds
 v_mfma_f32_16x16x32_bf16 v[80:83], a[96:99], v[52:55], v[80:83]
 ds_read_b128 a[0:3], v1 offset:0
 v_cvt_pk_bf16_f32 v64, v16, v17
 v_mfma_f32_16x16x32_bf16 v[112:115], a[64:67], v[56:59], v[112:115]
 s_add_u32 m0, s23, 16904
 v_exp_f32 v20, v20
 v_mfma_f32_16x16x32_bf16 v[112:115], a[96:99], v[60:63], v[112:115]
 buffer_load_dwordx4 v4, s[8:11], s21 offen offset:1024 nt lds
 v_mfma_f32_16x16x32_bf16 v[84:87], a[68:71], v[48:51], v[84:87]
 s_add_u32 s21, s21, 8192
 ds_read_b128 a[4:7], v1 offset:64
 v_cvt_pk_bf16_f32 v65, v18, v19
 v_mfma_f32_16x16x32_bf16 v[84:87], a[100:103], v[52:55], v[84:87]
 s_add_u32 m0, s23, 25344
 v_exp_f32 v21, v21
 v_mfma_f32_16x16x32_bf16 v[116:119], a[68:71], v[56:59], v[116:119]
 buffer_load_dwordx4 v4, s[8:11], s21 offen nt lds
 v_mfma_f32_16x16x32_bf16 v[116:119], a[100:103], v[60:63], v[116:119]
 ds_read_b128 a[8:11], v1 offset:128
 v_cvt_pk_bf16_f32 v66, v20, v21
 v_mfma_f32_16x16x32_bf16 v[88:91], a[72:75], v[48:51], v[88:91]
 s_add_u32 m0, s23, 25352
 v_exp_f32 v22, v22
 v_mfma_f32_16x16x32_bf16 v[88:91], a[104:107], v[52:55], v[88:91]
 buffer_load_dwordx4 v4, s[8:11], s21 offen offset:1024 nt lds
 v_mfma_f32_16x16x32_bf16 v[120:123], a[72:75], v[56:59], v[120:123]
 s_add_u32 s21, s21, 8192
 ds_read_b128 a[12:15], v1 offset:192
 v_mul_f32 v29, s46, v29
 v_mfma_f32_16x16x32_bf16 v[120:123], a[104:107], v[60:63], v[120:123]
 v_exp_f32 v23, v23
 v_mfma_f32_16x16x32_bf16 v[92:95], a[76:79], v[48:51], v[92:95]
 v_accvgpr_read_b32 v9, a132
 v_accvgpr_read_b32 v8, a133
 v_add_f32 v9, v9, v8
 v_accvgpr_read_b32 v11, a136
 v_accvgpr_read_b32 v10, a137
 v_add_f32 v11, v11, v10
 v_rcp_f32 v8, v9
 v_rcp_f32 v10, v11
 v_accvgpr_write_b32 a132, 0
 v_accvgpr_write_b32 a133, 0
 v_subrev_u32 v9, s30, v9
 v_cmp_lt_u32 s[50:51], s31, v9
 s_or_b64 s[28:29], s[28:29], s[50:51]
 v_accvgpr_write_b32 a136, 0
 v_accvgpr_write_b32 a137, 0
 v_subrev_u32 v11, s30, v11
 v_cmp_lt_u32 s[50:51], s31, v11
 s_or_b64 s[28:29], s[28:29], s[50:51]
 v_pk_mul_f32 v[80:81], v[80:81], v[8:9] op_sel_hi:[1,0]
 v_pk_mul_f32 v[82:83], v[82:83], v[8:9] op_sel_hi:[1,0]
 v_pk_mul_f32 v[84:85], v[84:85], v[8:9] op_sel_hi:[1,0]
 v_pk_mul_f32 v[86:87], v[86:87], v[8:9] op_sel_hi:[1,0]
 v_pk_mul_f32 v[112:113], v[112:113], v[10:11] op_sel_hi:[1,0]
 v_pk_mul_f32 v[114:115], v[114:115], v[10:11] op_sel_hi:[1,0]
 v_pk_mul_f32 v[116:117], v[116:117], v[10:11] op_sel_hi:[1,0]
 v_pk_mul_f32 v[118:119], v[118:119], v[10:11] op_sel_hi:[1,0]
 v_cvt_pk_bf16_f32 v80, v80, v81
 v_cvt_pk_bf16_f32 v81, v82, v83
 v_cvt_pk_bf16_f32 v82, v84, v85
 v_cvt_pk_bf16_f32 v83, v86, v87
 v_cvt_pk_bf16_f32 v112, v112, v113
 v_cvt_pk_bf16_f32 v113, v114, v115
 v_cvt_pk_bf16_f32 v114, v116, v117
 v_cvt_pk_bf16_f32 v115, v118, v119
 v_mfma_f32_16x16x32_bf16 v[92:95], a[108:111], v[52:55], v[92:95]
 ds_write_b128 v6, v[80:83] offset:0
 v_mfma_f32_16x16x32_bf16 v[124:127], a[76:79], v[56:59], v[124:127]
 v_exp_f32 v24, v24
 v_mfma_f32_16x16x32_bf16 v[124:127], a[108:111], v[60:63], v[124:127]
 ds_read_b128 a[16:19], v1 offset:512
 v_cvt_pk_bf16_f32 v67, v22, v23
 v_mfma_f32_16x16x32_bf16 v[96:99], a[80:83], v[48:51], v[96:99]
 v_exp_f32 v25, v25
 v_mfma_f32_16x16x32_bf16 v[96:99], a[112:115], v[52:55], v[96:99]
 ds_read_b128 a[20:23], v1 offset:576
 v_cvt_pk_bf16_f32 v72, v24, v25
 v_mfma_f32_16x16x32_bf16 v[128:131], a[80:83], v[56:59], v[128:131]
 v_exp_f32 v26, v26
 v_mfma_f32_16x16x32_bf16 v[128:131], a[112:115], v[60:63], v[128:131]
 ds_read_b128 a[24:27], v1 offset:640
 v_mul_f32 v30, s46, v30
 v_mfma_f32_16x16x32_bf16 v[100:103], a[84:87], v[48:51], v[100:103]
 ds_write_b128 v6, v[112:115] offset:512
 v_pk_mul_f32 v[88:89], v[88:89], v[8:9] op_sel_hi:[1,0]
 v_pk_mul_f32 v[90:91], v[90:91], v[8:9] op_sel_hi:[1,0]
 v_pk_mul_f32 v[92:93], v[92:93], v[8:9] op_sel_hi:[1,0]
 v_pk_mul_f32 v[94:95], v[94:95], v[8:9] op_sel_hi:[1,0]
 v_pk_mul_f32 v[120:121], v[120:121], v[10:11] op_sel_hi:[1,0]
 v_pk_mul_f32 v[122:123], v[122:123], v[10:11] op_sel_hi:[1,0]
 v_pk_mul_f32 v[124:125], v[124:125], v[10:11] op_sel_hi:[1,0]
 v_pk_mul_f32 v[126:127], v[126:127], v[10:11] op_sel_hi:[1,0]
 v_cvt_pk_bf16_f32 v88, v88, v89
 v_cvt_pk_bf16_f32 v89, v90, v91
 v_cvt_pk_bf16_f32 v90, v92, v93
 v_cvt_pk_bf16_f32 v91, v94, v95
 v_cvt_pk_bf16_f32 v120, v120, v121
 v_cvt_pk_bf16_f32 v121, v122, v123
 v_cvt_pk_bf16_f32 v122, v124, v125
 v_cvt_pk_bf16_f32 v123, v126, v127
 v_mfma_f32_16x16x32_bf16 v[100:103], a[116:119], v[52:55], v[100:103]
 ds_write_b128 v6, v[88:91] offset:64
 v_mfma_f32_16x16x32_bf16 v[132:135], a[84:87], v[56:59], v[132:135]
 v_exp_f32 v27, v27
 v_mfma_f32_16x16x32_bf16 v[132:135], a[116:119], v[60:63], v[132:135]
 ds_read_b128 a[28:31], v1 offset:704
 v_cvt_pk_bf16_f32 v73, v26, v27
 v_mfma_f32_16x16x32_bf16 v[104:107], a[88:91], v[48:51], v[104:107]
 v_exp_f32 v28, v28
 v_mfma_f32_16x16x32_bf16 v[104:107], a[120:123], v[52:55], v[104:107]
 ds_read_b128 a[32:35], v1 offset:8448
 v_mul_f32 v31, s46, v31
 v_mfma_f32_16x16x32_bf16 v[136:139], a[88:91], v[56:59], v[136:139]
 v_exp_f32 v29, v29
 v_mfma_f32_16x16x32_bf16 v[136:139], a[120:123], v[60:63], v[136:139]
 ds_read_b128 a[36:39], v1 offset:8512
 v_cvt_pk_bf16_f32 v74, v28, v29
 v_mfma_f32_16x16x32_bf16 v[108:111], a[92:95], v[48:51], v[108:111]
 ds_write_b128 v6, v[120:123] offset:576
 v_pk_mul_f32 v[96:97], v[96:97], v[8:9] op_sel_hi:[1,0]
 v_pk_mul_f32 v[98:99], v[98:99], v[8:9] op_sel_hi:[1,0]
 v_pk_mul_f32 v[100:101], v[100:101], v[8:9] op_sel_hi:[1,0]
 v_pk_mul_f32 v[102:103], v[102:103], v[8:9] op_sel_hi:[1,0]
 v_pk_mul_f32 v[128:129], v[128:129], v[10:11] op_sel_hi:[1,0]
 v_pk_mul_f32 v[130:131], v[130:131], v[10:11] op_sel_hi:[1,0]
 v_pk_mul_f32 v[132:133], v[132:133], v[10:11] op_sel_hi:[1,0]
 v_pk_mul_f32 v[134:135], v[134:135], v[10:11] op_sel_hi:[1,0]
 v_cvt_pk_bf16_f32 v96, v96, v97
 v_cvt_pk_bf16_f32 v97, v98, v99
 v_cvt_pk_bf16_f32 v98, v100, v101
 v_cvt_pk_bf16_f32 v99, v102, v103
 v_cvt_pk_bf16_f32 v128, v128, v129
 v_cvt_pk_bf16_f32 v129, v130, v131
 v_cvt_pk_bf16_f32 v130, v132, v133
 v_cvt_pk_bf16_f32 v131, v134, v135
 v_mfma_f32_16x16x32_bf16 v[108:111], a[124:127], v[52:55], v[108:111]
 ds_write_b128 v6, v[96:99] offset:128
 v_mfma_f32_16x16x32_bf16 v[140:143], a[92:95], v[56:59], v[140:143]
 s_waitcnt lgkmcnt(11)
 ds_read_b128 a[40:43], v1 offset:8576
 v_mul_f32_e64 v40, s46, v40
 v_mfma_f32_16x16x32_bf16 v[140:143], a[124:127], v[60:63], v[140:143]
 v_exp_f32_e64 v30, v30
 v_mfma_f32_16x16x32_bf16 v[16:19], a[0:3], v[208:211], 0
 s_cmp_lg_u32 s2, s2
L_pad4:
 s_cbranch_scc1 L_p1
 ds_read_b128 a[44:47], v1 offset:8640
 v_mul_f32 v41, s46, v41
 v_mfma_f32_16x16x32_bf16 v[16:19], a[4:7], v[212:215], v[16:19]
 v_exp_f32 v31, v31
 v_mfma_f32_16x16x32_bf16 v[16:19], a[8:11], v[216:219], v[16:19]
 s_waitcnt lgkmcnt(6)
 ds_read_b128 a[48:51], v1 offset:8960
 v_cvt_pk_bf16_f32 v75, v30, v31
 v_mfma_f32_16x16x32_bf16 v[16:19], a[12:15], v[220:223], v[16:19]
 v_exp_f32 v32, v32
 v_mfma_f32_16x16x32_bf16 v[20:23], a[16:19], v[208:211], 0
 ds_read_b128 a[52:55], v1 offset:9024
 v_mul_f32 v42, s46, v42
 v_mfma_f32_16x16x32_bf16 v[20:23], a[20:23], v[212:215], v[20:23]
 ds_write_b128 v6, v[128:131] offset:640
 v_pk_mul_f32 v[104:105], v[104:105], v[8:9] op_sel_hi:[1,0]
 v_pk_mul_f32 v[106:107], v[106:107], v[8:9] op_sel_hi:[1,0]
 v_pk_mul_f32 v[108:109], v[108:109], v[8:9] op_sel_hi:[1,0]
 v_pk_mul_f32 v[110:111], v[110:111], v[8:9] op_sel_hi:[1,0]
 v_pk_mul_f32 v[136:137], v[136:137], v[10:11] op_sel_hi:[1,0]
 v_pk_mul_f32 v[138:139], v[138:139], v[10:11] op_sel_hi:[1,0]
 v_pk_mul_f32 v[140:141], v[140:141], v[10:11] op_sel_hi:[1,0]
 v_pk_mul_f32 v[142:143], v[142:143], v[10:11] op_sel_hi:[1,0]
 v_cvt_pk_bf16_f32 v104, v104, v105
 v_cvt_pk_bf16_f32 v105, v106, v107
 v_cvt_pk_bf16_f32 v106, v108, v109
 v_cvt_pk_bf16_f32 v107, v110, v111
 v_cvt_pk_bf16_f32 v136, v136, v137
 v_cvt_pk_bf16_f32 v137, v138, v139
 v_cvt_pk_bf16_f32 v138, v140, v141
 v_cvt_pk_bf16_f32 v139, v142, v143
 v_mfma_f32_16x16x32_bf16 v[20:23], a[24:27], v[216:219], v[20:23]
 ds_read_b128 a[56:59], v1 offset:9088
 v_mul_f32 v43, s46, v43
 v_mfma_f32_16x16x32_bf16 v[20:23], a[28:31], v[220:223], v[20:23]
 ds_write_b128 v6, v[104:107] offset:192
 v_mfma_f32_16x16x32_bf16 v[24:27], a[0:3], a[164:167], 0
 ds_read_b128 a[60:63], v1 offset:9152
 v_mul_f32 v44, s46, v44
 v_mfma_f32_16x16x32_bf16 v[24:27], a[4:7], a[168:171], v[24:27]
 ds_write_b128 v6, v[136:139] offset:704
 v_mfma_f32_16x16x32_bf16 v[24:27], a[8:11], a[172:175], v[24:27]
 v_exp_f32 v33, v33
 v_mfma_f32_16x16x32_bf16 v[24:27], a[12:15], a[176:179], v[24:27]
 v_exp_f32 v34, v34
 v_mfma_f32_16x16x32_bf16 v[28:31], a[16:19], a[164:167], 0
 v_exp_f32 v35, v35
 v_mfma_f32_16x16x32_bf16 v[28:31], a[20:23], a[168:171], v[28:31]
 v_exp_f32 v36, v36
 v_mfma_f32_16x16x32_bf16 v[28:31], a[24:27], a[172:175], v[28:31]
 s_waitcnt lgkmcnt(7)
 s_waitcnt vmcnt(4)
 ds_read_b128 v[224:227], v3 offset:8448
 v_cvt_pk_bf16_f32 v68, v32, v33
 v_mfma_f32_16x16x32_bf16 v[28:31], a[28:31], a[176:179], v[28:31]
 v_cvt_pk_bf16_f32 v69, v34, v35
 v_mul_f32 v45, s46, v45
 v_mfma_f32_16x16x32_bf16 v[32:35], a[32:35], v[208:211], 0
 ds_read_b128 v[228:231], v3 offset:8512
 v_mul_f32 v46, s46, v46
 v_mfma_f32_16x16x32_bf16 v[32:35], a[36:39], v[212:215], v[32:35]
 v_exp_f32 v37, v37
 v_mfma_f32_16x16x32_bf16 v[32:35], a[40:43], v[216:219], v[32:35]
 s_waitcnt lgkmcnt(3)
 v_exp_f32 v38, v38
 v_exp_f32 v39, v39
 v_mfma_f32_16x16x32_bf16 v[32:35], a[44:47], v[220:223], v[32:35]
 v_cvt_pk_bf16_f32 v70, v36, v37
 v_cvt_pk_bf16_f32 v71, v38, v39
 v_mfma_f32_16x16x32_bf16 v[36:39], a[48:51], v[208:211], 0
 s_waitcnt lgkmcnt(1)
 v_lshlrev_b32 v12, 16, v224
 v_and_b32 v13, s27, v224
 v_lshlrev_b32 v14, 16, v225
 v_and_b32_e64 v15, s27, v225
 v_pk_mul_f32 v[12:13], v[12:13], s[46:47]
 v_pk_mul_f32 v[14:15], v[14:15], s[46:47]
 v_cvt_pk_bf16_f32 v224, v12, v13
 v_cvt_pk_bf16_f32 v225, v14, v15
 v_lshlrev_b32 v12, 16, v226
 v_and_b32 v13, s27, v226
 v_lshlrev_b32 v14, 16, v227
 v_and_b32 v15, s27, v227
 v_pk_mul_f32 v[12:13], v[12:13], s[46:47]
 v_pk_mul_f32 v[14:15], v[14:15], s[46:47]
 v_cvt_pk_bf16_f32 v226, v12, v13
 v_cvt_pk_bf16_f32 v227, v14, v15
 v_mfma_f32_16x16x32_bf16 v[36:39], a[52:55], v[212:215], v[36:39]
 ds_read_b128 v[232:235], v3 offset:8576
 v_mul_f32 v47, s46, v47
 v_mfma_f32_16x16x32_bf16 v[36:39], a[56:59], v[216:219], v[36:39]
 v_exp_f32 v40, v40
 v_exp_f32 v41, v41
 v_exp_f32 v42, v42
 v_exp_f32 v43, v43
 v_mfma_f32_16x16x32_bf16 v[36:39], a[60:63], v[220:223], v[36:39]
 v_cvt_pk_bf16_f32 v76, v40, v41
 v_cvt_pk_bf16_f32 v77, v42, v43
 v_mfma_f32_16x16x32_bf16 v[40:43], a[32:35], a[164:167], 0
 ds_read_b128 v[236:239], v3 offset:8640
 v_mul_f32 v24, s46, v24
 v_mfma_f32_16x16x32_bf16 v[40:43], a[36:39], a[168:171], v[40:43]
 s_waitcnt lgkmcnt(2)
 v_lshlrev_b32 v12, 16, v228
 v_and_b32 v13, s27, v228
 v_lshlrev_b32 v14, 16, v229
 v_and_b32_e64 v15, s27, v229
 v_pk_mul_f32 v[12:13], v[12:13], s[46:47]
 v_pk_mul_f32 v[14:15], v[14:15], s[46:47]
 v_cvt_pk_bf16_f32 v228, v12, v13
 v_cvt_pk_bf16_f32 v229, v14, v15
 v_lshlrev_b32 v12, 16, v230
 v_and_b32 v13, s27, v230
 v_lshlrev_b32 v14, 16, v231
 v_and_b32 v15, s27, v231
 v_pk_mul_f32 v[12:13], v[12:13], s[46:47]
 v_pk_mul_f32 v[14:15], v[14:15], s[46:47]
 v_cvt_pk_bf16_f32 v230, v12, v13
 v_cvt_pk_bf16_f32 v231, v14, v15
 v_mfma_f32_16x16x32_bf16 v[40:43], a[40:43], a[172:175], v[40:43]
 v_exp_f32 v44, v44
 v_exp_f32 v45, v45
 v_exp_f32 v46, v46
 v_exp_f32 v47, v47
 v_mfma_f32_16x16x32_bf16 v[40:43], a[44:47], a[176:179], v[40:43]
 v_cvt_pk_bf16_f32 v78, v44, v45
 v_cvt_pk_bf16_f32 v79, v46, v47
 v_mfma_f32_16x16x32_bf16 v[44:47], a[48:51], a[164:167], 0
 ds_read_b128 a[180:183], v3 offset:8960
 v_mul_f32 v25, s46, v25
 v_mfma_f32_16x16x32_bf16 v[44:47], a[52:55], a[168:171], v[44:47]
 v_exp_f32 v16, v16
 v_mfma_f32_16x16x32_bf16 v[44:47], a[56:59], a[172:175], v[44:47]
 s_waitcnt lgkmcnt(2)
 v_lshlrev_b32 v12, 16, v232
 v_and_b32 v13, s27, v232
 v_lshlrev_b32 v14, 16, v233
 v_and_b32_e64 v15, s27, v233
 v_pk_mul_f32 v[12:13], v[12:13], s[46:47]
 v_pk_mul_f32 v[14:15], v[14:15], s[46:47]
 v_cvt_pk_bf16_f32 v232, v12, v13
 v_cvt_pk_bf16_f32 v233, v14, v15
 v_lshlrev_b32 v12, 16, v234
 v_and_b32 v13, s27, v234
 v_lshlrev_b32 v14, 16, v235
 v_and_b32 v15, s27, v235
 v_pk_mul_f32 v[12:13], v[12:13], s[46:47]
 v_pk_mul_f32 v[14:15], v[14:15], s[46:47]
 v_cvt_pk_bf16_f32 v234, v12, v13
 v_cvt_pk_bf16_f32 v235, v14, v15
 v_mfma_f32_16x16x32_bf16 v[44:47], a[60:63], a[176:179], v[44:47]
 ds_read_b128 a[184:187], v3 offset:9024
 v_mul_f32 v26, s46, v26
 v_smfmac_f32_16x16x64_bf16 a[140:143], a[128:131], v[64:71], v242
 s_waitcnt vmcnt(12) lgkmcnt(7)
 s_barrier
 v_smfmac_f32_16x16x64_bf16 a[144:147], a[128:131], v[72:79], v242
 s_add_u32 m0, s22, 0
 ds_read_b128 a[188:191], v3 offset:9088
 v_mfma_f32_16x16x32_bf16 v[144:147], a[64:67], v[64:67], v[144:147]
 buffer_load_dwordx4 v4, s[4:7], s20 offen nt lds
 v_mfma_f32_16x16x32_bf16 v[144:147], a[96:99], v[68:71], v[144:147]
 s_waitcnt lgkmcnt(3)
 v_lshlrev_b32 v12, 16, v236
 v_and_b32 v13, s27, v236
 v_lshlrev_b32 v14, 16, v237
 v_and_b32_e64 v15, s27, v237
 v_pk_mul_f32 v[12:13], v[12:13], s[46:47]
 v_pk_mul_f32 v[14:15], v[14:15], s[46:47]
 v_cvt_pk_bf16_f32 v236, v12, v13
 v_cvt_pk_bf16_f32 v237, v14, v15
 v_lshlrev_b32 v12, 16, v238
 v_and_b32 v13, s27, v238
 v_lshlrev_b32 v14, 16, v239
 v_and_b32 v15, s27, v239
 v_pk_mul_f32 v[12:13], v[12:13], s[46:47]
 v_pk_mul_f32 v[14:15], v[14:15], s[46:47]
 v_cvt_pk_bf16_f32 v238, v12, v13
 v_cvt_pk_bf16_f32 v239, v14, v15
 v_mfma_f32_16x16x32_bf16 v[176:179], a[64:67], v[72:75], v[176:179]
 s_add_u32 m0, s22, 32
 ds_read_b128 a[148:151], v7 offset:0
 v_mul_f32 v27, s46, v27
 v_mfma_f32_16x16x32_bf16 v[176:179], a[96:99], v[76:79], v[176:179]
 buffer_load_dwordx4 v4, s[4:7], s20 offen offset:1024 nt lds
 v_mfma_f32_16x16x32_bf16 v[148:151], a[68:71], v[64:67], v[148:151]
 s_add_u32 s20, s20, 8192
 ds_read_b128 a[192:195], v3 offset:9152
 v_mul_f32 v28, s46, v28
 v_mfma_f32_16x16x32_bf16 v[148:151], a[100:103], v[68:71], v[148:151]
 s_add_u32 m0, s22, 8448
 ds_read_b64_tr_b16 a[64:65], v2 offset:0
 v_mul_f32 v29, s46, v29
 v_mfma_f32_16x16x32_bf16 v[180:183], a[68:71], v[72:75], v[180:183]
 buffer_load_dwordx4 v4, s[4:7], s20 offen nt lds
 v_mfma_f32_16x16x32_bf16 v[180:183], a[100:103], v[76:79], v[180:183]
 ds_read_b128 a[152:155], v7 offset:1056
 v_mul_f32 v30, s46, v30
 v_mfma_f32_16x16x32_bf16 v[152:155], a[72:75], v[64:67], v[152:155]
 s_add_u32 m0, s22, 8480
 ds_read_b64_tr_b16 a[66:67], v2 offset:512
 v_mul_f32 v31, s46, v31
 v_mfma_f32_16x16x32_bf16 v[152:155], a[104:107], v[68:71], v[152:155]
 buffer_load_dwordx4 v4, s[4:7], s20 offen offset:1024 nt lds
 v_mfma_f32_16x16x32_bf16 v[184:187], a[72:75], v[72:75], v[184:187]
 s_add_u32 s20, s20, 8192
 ds_read_b64_tr_b16 a[96:97], v2 offset:8448
 v_mul_f32 v40, s46, v40
 v_mfma_f32_16x16x32_bf16 v[184:187], a[104:107], v[76:79], v[184:187]
 s_waitcnt lgkmcnt(5)
 ds_read_b64_tr_b16 a[98:99], v2 offset:8960
 v_mul_f32 v41, s46, v41
 v_mfma_f32_16x16x32_bf16 v[156:159], a[76:79], v[64:67], v[156:159]
 buffer_store_dwordx4 a[148:151], v5, s[16:19], 0 offen sc0 sc1
 v_accvgpr_read_b32 v9, a140
 v_accvgpr_read_b32 v8, a141
 v_add_f32 v9, v9, v8
 v_accvgpr_read_b32 v11, a144
 v_accvgpr_read_b32 v10, a145
 v_add_f32 v11, v11, v10
 v_rcp_f32 v8, v9
 v_rcp_f32 v10, v11
 v_accvgpr_write_b32 a140, 0
 v_accvgpr_write_b32 a141, 0
 v_subrev_u32 v9, s30, v9
 v_cmp_lt_u32 s[50:51], s31, v9
 s_or_b64 s[28:29], s[28:29], s[50:51]
 v_accvgpr_write_b32 a144, 0
 v_accvgpr_write_b32 a145, 0
 v_subrev_u32_e64 v11, s30, v11
 v_cmp_lt_u32 s[50:51], s31, v11
 s_or_b64 s[28:29], s[28:29], s[50:51]
 v_pk_mul_f32 v[144:145], v[144:145], v[8:9] op_sel_hi:[1,0]
 v_pk_mul_f32 v[146:147], v[146:147], v[8:9] op_sel_hi:[1,0]
 v_pk_mul_f32 v[148:149], v[148:149], v[8:9] op_sel_hi:[1,0]
 v_pk_mul_f32 v[150:151], v[150:151], v[8:9] op_sel_hi:[1,0]
 v_pk_mul_f32 v[176:177], v[176:177], v[10:11] op_sel_hi:[1,0]
 v_pk_mul_f32 v[178:179], v[178:179], v[10:11] op_sel_hi:[1,0]
 v_pk_mul_f32 v[180:181], v[180:181], v[10:11] op_sel_hi:[1,0]
 v_pk_mul_f32 v[182:183], v[182:183], v[10:11] op_sel_hi:[1,0]
 v_cvt_pk_bf16_f32 v144, v144, v145
 v_cvt_pk_bf16_f32 v145, v146, v147
 v_cvt_pk_bf16_f32 v146, v148, v149
 v_cvt_pk_bf16_f32 v147, v150, v151
 v_cvt_pk_bf16_f32 v176, v176, v177
 v_cvt_pk_bf16_f32 v177, v178, v179
 v_cvt_pk_bf16_f32 v178, v180, v181
 v_cvt_pk_bf16_f32 v179, v182, v183
 v_mfma_f32_16x16x32_bf16 v[156:159], a[108:111], v[68:71], v[156:159]
 ds_write_b128 v6, v[144:147] offset:8448
 v_mfma_f32_16x16x32_bf16 v[188:191], a[76:79], v[72:75], v[188:191]
 v_exp_f32 v17, v17
 v_mfma_f32_16x16x32_bf16 v[188:191], a[108:111], v[76:79], v[188:191]
 ds_read_b64_tr_b16 a[68:69], v2 offset:8
 v_cvt_pk_bf16_f32 v48, v16, v17
 v_mfma_f32_16x16x32_bf16 v[160:163], a[80:83], v[64:67], v[160:163]
 ds_read_b64_tr_b16 a[70:71], v2 offset:520
 v_mul_f32 v42, s46, v42
 v_mfma_f32_16x16x32_bf16 v[160:163], a[112:115], v[68:71], v[160:163]
 ds_read_b64_tr_b16 a[100:101], v2 offset:8456
 v_mul_f32 v43, s46, v43
 v_mfma_f32_16x16x32_bf16 v[192:195], a[80:83], v[72:75], v[192:195]
 ds_read_b64_tr_b16 a[102:103], v2 offset:8968
 v_mul_f32 v44, s46, v44
 v_mfma_f32_16x16x32_bf16 v[192:195], a[112:115], v[76:79], v[192:195]
 ds_read_b64_tr_b16 a[72:73], v2 offset:64
 v_mul_f32_e64 v45, s46, v45
 v_mfma_f32_16x16x32_bf16 v[164:167], a[84:87], v[64:67], v[164:167]
 ds_write_b128 v6, v[176:179] offset:8960
 v_pk_mul_f32 v[152:153], v[152:153], v[8:9] op_sel_hi:[1,0]
 v_pk_mul_f32 v[154:155], v[154:155], v[8:9] op_sel_hi:[1,0]
 v_pk_mul_f32 v[156:157], v[156:157], v[8:9] op_sel_hi:[1,0]
 v_pk_mul_f32 v[158:159], v[158:159], v[8:9] op_sel_hi:[1,0]
 v_pk_mul_f32 v[184:185], v[184:185], v[10:11] op_sel_hi:[1,0]
 v_pk_mul_f32 v[186:187], v[186:187], v[10:11] op_sel_hi:[1,0]
 v_pk_mul_f32 v[188:189], v[188:189], v[10:11] op_sel_hi:[1,0]
 v_pk_mul_f32 v[190:191], v[190:191], v[10:11] op_sel_hi:[1,0]
 v_cvt_pk_bf16_f32 v152, v152, v153
 v_cvt_pk_bf16_f32 v153, v154, v155
 v_cvt_pk_bf16_f32 v154, v156, v157
 v_cvt_pk_bf16_f32 v155, v158, v159
 v_cvt_pk_bf16_f32 v184, v184, v185
 v_cvt_pk_bf16_f32 v185, v186, v187
 v_cvt_pk_bf16_f32 v186, v188, v189
 v_cvt_pk_bf16_f32 v187, v190, v191
 v_mfma_f32_16x16x32_bf16 v[164:167], a[116:119], v[68:71], v[164:167]
 ds_write_b128 v6, v[152:155] offset:8512
 v_mfma_f32_16x16x32_bf16 v[196:199], a[84:87], v[72:75], v[196:199]
 v_exp_f32 v18, v18
 v_mfma_f32_16x16x32_bf16 v[196:199], a[116:119], v[76:79], v[196:199]
 ds_read_b64_tr_b16 a[74:75], v2 offset:576
 v_mul_f32 v46, s46, v46
 v_mfma_f32_16x16x32_bf16 v[168:171], a[88:91], v[64:67], v[168:171]
 ds_read_b64_tr_b16 a[104:105], v2 offset:8512
 v_mul_f32 v47, s46, v47
 v_mfma_f32_16x16x32_bf16 v[168:171], a[120:123], v[68:71], v[168:171]
 v_exp_f32 v19, v19
 v_mfma_f32_16x16x32_bf16 v[200:203], a[88:91], v[72:75], v[200:203]
 ds_read_b64_tr_b16 a[106:107], v2 offset:9024
 v_cvt_pk_bf16_f32 v49, v18, v19
 v_mfma_f32_16x16x32_bf16 v[200:203], a[120:123], v[76:79], v[200:203]
 s_waitcnt lgkmcnt(14)
 v_exp_f32 v20, v20
 v_mfma_f32_16x16x32_bf16 v[172:175], a[92:95], v[64:67], v[172:175]
 buffer_store_dwordx4 a[152:155], v5, s[16:19], 0 offen offset:256 sc0 sc1
 ds_write_b128 v6, v[184:187] offset:9024
 v_pk_mul_f32 v[160:161], v[160:161], v[8:9] op_sel_hi:[1,0]
 v_pk_mul_f32 v[162:163], v[162:163], v[8:9] op_sel_hi:[1,0]
 v_pk_mul_f32 v[164:165], v[164:165], v[8:9] op_sel_hi:[1,0]
 v_pk_mul_f32 v[166:167], v[166:167], v[8:9] op_sel_hi:[1,0]
 v_pk_mul_f32 v[192:193], v[192:193], v[10:11] op_sel_hi:[1,0]
 v_pk_mul_f32 v[194:195], v[194:195], v[10:11] op_sel_hi:[1,0]
 v_pk_mul_f32 v[196:197], v[196:197], v[10:11] op_sel_hi:[1,0]
 v_pk_mul_f32 v[198:199], v[198:199], v[10:11] op_sel_hi:[1,0]
 v_cvt_pk_bf16_f32 v160, v160, v161
 v_cvt_pk_bf16_f32 v161, v162, v163
 v_cvt_pk_bf16_f32 v162, v164, v165
 v_cvt_pk_bf16_f32 v163, v166, v167
 v_cvt_pk_bf16_f32 v192, v192, v193
 v_cvt_pk_bf16_f32 v193, v194, v195
 v_cvt_pk_bf16_f32 v194, v196, v197
 v_cvt_pk_bf16_f32 v195, v198, v199
 v_mfma_f32_16x16x32_bf16 v[172:175], a[124:127], v[68:71], v[172:175]
 ds_write_b128 v6, v[160:163] offset:8576
 v_mfma_f32_16x16x32_bf16 v[204:207], a[92:95], v[72:75], v[204:207]
 v_exp_f32 v21, v21
 v_mfma_f32_16x16x32_bf16 v[204:207], a[124:127], v[76:79], v[204:207]
 ds_read_b128 a[156:159], v7 offset:2112
 v_cvt_pk_bf16_f32 v50, v20, v21
 v_mfma_f32_16x16x32_bf16 v[16:19], a[0:3], v[224:227], 0
 v_exp_f32 v22, v22
 v_mfma_f32_16x16x32_bf16 v[16:19], a[4:7], v[228:231], v[16:19]
 v_exp_f32 v23, v23
 v_mfma_f32_16x16x32_bf16 v[16:19], a[8:11], v[232:235], v[16:19]
 ds_read_b64_tr_b16 a[76:77], v2 offset:72
 v_cvt_pk_bf16_f32 v51, v22, v23
 v_mfma_f32_16x16x32_bf16 v[16:19], a[12:15], v[236:239], v[16:19]
 v_exp_f32 v24, v24
 v_mfma_f32_16x16x32_bf16 v[20:23], a[16:19], v[224:227], 0
 ds_write_b128 v6, v[192:195] offset:9088
 v_pk_mul_f32 v[168:169], v[168:169], v[8:9] op_sel_hi:[1,0]
 v_pk_mul_f32 v[170:171], v[170:171], v[8:9] op_sel_hi:[1,0]
 v_pk_mul_f32 v[172:173], v[172:173], v[8:9] op_sel_hi:[1,0]
 v_pk_mul_f32 v[174:175], v[174:175], v[8:9] op_sel_hi:[1,0]
 v_pk_mul_f32 v[200:201], v[200:201], v[10:11] op_sel_hi:[1,0]
 v_pk_mul_f32 v[202:203], v[202:203], v[10:11] op_sel_hi:[1,0]
 v_pk_mul_f32 v[204:205], v[204:205], v[10:11] op_sel_hi:[1,0]
 v_pk_mul_f32 v[206:207], v[206:207], v[10:11] op_sel_hi:[1,0]
 v_cvt_pk_bf16_f32 v168, v168, v169
 v_cvt_pk_bf16_f32 v169, v170, v171
 v_cvt_pk_bf16_f32 v170, v172, v173
 v_cvt_pk_bf16_f32 v171, v174, v175
 v_cvt_pk_bf16_f32 v200, v200, v201
 v_cvt_pk_bf16_f32 v201, v202, v203
 v_cvt_pk_bf16_f32 v202, v204, v205
 v_cvt_pk_bf16_f32 v203, v206, v207
 v_mfma_f32_16x16x32_bf16 v[20:23], a[20:23], v[228:231], v[20:23]
 ds_write_b128 v6, v[168:171] offset:8640
 v_mfma_f32_16x16x32_bf16 v[20:23], a[24:27], v[232:235], v[20:23]
 v_exp_f32 v25, v25
 v_exp_f32 v26, v26
 v_exp_f32 v27, v27
 v_mfma_f32_16x16x32_bf16 v[20:23], a[28:31], v[236:239], v[20:23]
 ds_read_b64_tr_b16 a[78:79], v2 offset:584
 v_cvt_pk_bf16_f32 v56, v24, v25
 v_cvt_pk_bf16_f32 v57, v26, v27
 v_mfma_f32_16x16x32_bf16 v[24:27], a[0:3], a[180:183], 0
 ds_read_b64_tr_b16 a[108:109], v2 offset:8520
 ds_read_b64_tr_b16 a[110:111], v2 offset:9032
 v_mfma_f32_16x16x32_bf16 v[24:27], a[4:7], a[184:187], v[24:27]
 ds_write_b128 v6, v[200:203] offset:9152
 v_mfma_f32_16x16x32_bf16 v[24:27], a[8:11], a[188:191], v[24:27]
 ds_read_b64_tr_b16 a[80:81], v2 offset:128
 v_exp_f32 v28, v28
 v_exp_f32 v29, v29
 v_exp_f32 v30, v30
 v_exp_f32 v31, v31
 v_mfma_f32_16x16x32_bf16 v[24:27], a[12:15], a[192:195], v[24:27]
 s_waitcnt lgkmcnt(8)
 ds_read_b64_tr_b16 a[82:83], v2 offset:640
 v_cvt_pk_bf16_f32 v58, v28, v29
 v_cvt_pk_bf16_f32 v59, v30, v31
 v_mfma_f32_16x16x32_bf16 v[28:31], a[16:19], a[180:183], 0
 buffer_store_dwordx4 a[156:159], v5, s[16:19], 0 offen offset:512 sc0 sc1
 ds_read_b64_tr_b16 a[112:113], v2 offset:8576
 v_exp_f32 v32, v32
 v_mfma_f32_16x16x32_bf16 v[28:31], a[20:23], a[184:187], v[28:31]
 ds_read_b64_tr_b16 a[114:115], v2 offset:9088
 ds_read_b64_tr_b16 a[84:85], v2 offset:136
 v_mfma_f32_16x16x32_bf16 v[28:31], a[24:27], a[188:191], v[28:31]
 v_exp_f32 v33, v33
 v_exp_f32 v34, v34
 v_exp_f32 v35, v35
 v_mfma_f32_16x16x32_bf16 v[28:31], a[28:31], a[192:195], v[28:31]
 ds_read_b64_tr_b16 a[86:87], v2 offset:648
 v_cvt_pk_bf16_f32 v52, v32, v33
 v_cvt_pk_bf16_f32 v53, v34, v35
 v_mfma_f32_16x16x32_bf16 v[32:35], a[32:35], v[224:227], 0
 ds_read_b64_tr_b16 a[116:117], v2 offset:8584
 v_mul_f32 v24, s46, v24
 v_mfma_f32_16x16x32_bf16 v[32:35], a[36:39], v[228:231], v[32:35]
 ds_read_b64_tr_b16 a[118:119], v2 offset:9096
 v_mul_f32 v25, s46, v25
 v_mfma_f32_16x16x32_bf16 v[32:35], a[40:43], v[232:235], v[32:35]
 ds_read_b64_tr_b16 a[88:89], v2 offset:192
 v_exp_f32 v36, v36
 v_exp_f32 v37, v37
 v_exp_f32 v38, v38
 v_exp_f32 v39, v39
 v_mfma_f32_16x16x32_bf16 v[32:35], a[44:47], v[236:239], v[32:35]
 ds_read_b64_tr_b16 a[90:91], v2 offset:704
 v_cvt_pk_bf16_f32 v54, v36, v37
 v_cvt_pk_bf16_f32 v55, v38, v39
 v_mfma_f32_16x16x32_bf16 v[36:39], a[48:51], v[224:227], 0
 ds_read_b64_tr_b16 a[120:121], v2 offset:8640
 v_mul_f32 v26, s46, v26
 v_mfma_f32_16x16x32_bf16 v[36:39], a[52:55], v[228:231], v[36:39]
 ds_read_b64_tr_b16 a[122:123], v2 offset:9152
 ds_read_b128 a[160:163], v7 offset:3168
 v_mfma_f32_16x16x32_bf16 v[36:39], a[56:59], v[232:235], v[36:39]
 ds_read_b64_tr_b16 a[92:93], v2 offset:200
 v_exp_f32 v40, v40
 v_exp_f32 v41, v41
 v_exp_f32 v42, v42
 v_exp_f32 v43, v43
 v_mfma_f32_16x16x32_bf16 v[36:39], a[60:63], v[236:239], v[36:39]
 ds_read_b64_tr_b16 a[94:95], v2 offset:712
 v_cvt_pk_bf16_f32 v60, v40, v41
 v_cvt_pk_bf16_f32 v61, v42, v43
 v_mfma_f32_16x16x32_bf16 v[40:43], a[32:35], a[180:183], 0
 ds_read_b64_tr_b16 a[124:125], v2 offset:8648
 v_mul_f32 v27, s46, v27
 v_mfma_f32_16x16x32_bf16 v[40:43], a[36:39], a[184:187], v[40:43]
 ds_read_b64_tr_b16 a[126:127], v2 offset:9160
 v_mul_f32 v28, s46, v28
 v_mfma_f32_16x16x32_bf16 v[40:43], a[40:43], a[188:191], v[40:43]
 v_exp_f32 v44, v44
 v_exp_f32 v45, v45
 v_exp_f32 v46, v46
 v_exp_f32 v47, v47
 v_mfma_f32_16x16x32_bf16 v[40:43], a[44:47], a[192:195], v[40:43]
 s_waitcnt lgkmcnt(4)
 v_cvt_pk_bf16_f32 v62, v44, v45
 v_cvt_pk_bf16_f32 v63, v46, v47
 v_mfma_f32_16x16x32_bf16 v[44:47], a[48:51], a[180:183], 0
 buffer_store_dwordx4 a[160:163], v5, s[16:19], 0 offen offset:768 sc0 sc1
 ds_read_b128 a[148:151], v7 offset:4240
 v_exp_f32 v16, v16
 v_mfma_f32_16x16x32_bf16 v[44:47], a[52:55], a[184:187], v[44:47]
 v_exp_f32 v17, v17
 v_mfma_f32_16x16x32_bf16 v[44:47], a[56:59], a[188:191], v[44:47]
 v_exp_f32 v18, v18
 v_mfma_f32_16x16x32_bf16 v[44:47], a[60:63], a[192:195], v[44:47]
 v_exp_f32 v19, v19
 v_smfmac_f32_16x16x64_bf16 a[132:135], a[128:131], v[48:55], v242
 s_waitcnt vmcnt(14) lgkmcnt(1)
 s_barrier
 v_smfmac_f32_16x16x64_bf16 a[136:139], a[128:131], v[56:63], v242
 s_add_u32 m0, s23, 0
 v_mfma_f32_16x16x32_bf16 v[80:83], a[64:67], v[48:51], 0
 buffer_load_dwordx4 v4, s[8:11], s21 offen nt lds
 v_mfma_f32_16x16x32_bf16 v[80:83], a[96:99], v[52:55], v[80:83]
 ds_read_b128 a[0:3], v1 offset:16896
 v_cvt_pk_bf16_f32 v64, v16, v17
 v_mfma_f32_16x16x32_bf16 v[112:115], a[64:67], v[56:59], 0
 s_add_u32 m0, s23, 8
 v_exp_f32 v20, v20
 v_mfma_f32_16x16x32_bf16 v[112:115], a[96:99], v[60:63], v[112:115]
 buffer_load_dwordx4 v4, s[8:11], s21 offen offset:1024 nt lds
 v_mfma_f32_16x16x32_bf16 v[84:87], a[68:71], v[48:51], 0
 s_add_u32 s21, s21, 8192
 ds_read_b128 a[4:7], v1 offset:16960
 v_cvt_pk_bf16_f32 v65, v18, v19
 v_mfma_f32_16x16x32_bf16 v[84:87], a[100:103], v[52:55], v[84:87]
 s_add_u32 m0, s23, 8448
 v_exp_f32 v21, v21
 v_mfma_f32_16x16x32_bf16 v[116:119], a[68:71], v[56:59], 0
 buffer_load_dwordx4 v4, s[8:11], s21 offen nt lds
 v_mfma_f32_16x16x32_bf16 v[116:119], a[100:103], v[60:63], v[116:119]
 ds_read_b128 a[8:11], v1 offset:17024
 v_cvt_pk_bf16_f32 v66, v20, v21
 v_mfma_f32_16x16x32_bf16 v[88:91], a[72:75], v[48:51], 0
 s_add_u32 m0, s23, 8456
 v_exp_f32 v22, v22
 v_mfma_f32_16x16x32_bf16 v[88:91], a[104:107], v[52:55], v[88:91]
 buffer_load_dwordx4 v4, s[8:11], s21 offen offset:1024 nt lds
 v_mfma_f32_16x16x32_bf16 v[120:123], a[72:75], v[56:59], 0
 s_add_u32 s21, s21, 8192
 ds_read_b128 a[12:15], v1 offset:17088
 v_mul_f32 v29, s46, v29
 v_mfma_f32_16x16x32_bf16 v[120:123], a[104:107], v[60:63], v[120:123]
 v_exp_f32 v23, v23
 v_mfma_f32_16x16x32_bf16 v[92:95], a[76:79], v[48:51], 0
 ds_read_b128 a[16:19], v1 offset:17408
 v_cvt_pk_bf16_f32 v67, v22, v23
 v_mfma_f32_16x16x32_bf16 v[92:95], a[108:111], v[52:55], v[92:95]
 s_waitcnt lgkmcnt(5)
 v_exp_f32 v24, v24
 v_mfma_f32_16x16x32_bf16 v[124:127], a[76:79], v[56:59], 0
 buffer_store_dwordx4 a[148:151], v5, s[16:19], 0 offen offset:1024 sc0 sc1
 ds_read_b128 a[20:23], v1 offset:17472
 v_exp_f32 v25, v25
 v_mfma_f32_16x16x32_bf16 v[124:127], a[108:111], v[60:63], v[124:127]
 v_exp_f32 v26, v26
 v_mfma_f32_16x16x32_bf16 v[96:99], a[80:83], v[48:51], 0
 ds_read_b128 a[24:27], v1 offset:17536
 v_cvt_pk_bf16_f32 v72, v24, v25
 v_mfma_f32_16x16x32_bf16 v[96:99], a[112:115], v[52:55], v[96:99]
 v_exp_f32 v27, v27
 v_mfma_f32_16x16x32_bf16 v[128:131], a[80:83], v[56:59], 0
 ds_read_b128 a[28:31], v1 offset:17600
 v_cvt_pk_bf16_f32 v73, v26, v27
 v_mfma_f32_16x16x32_bf16 v[128:131], a[112:115], v[60:63], v[128:131]
 v_exp_f32 v28, v28
 v_mfma_f32_16x16x32_bf16 v[100:103], a[84:87], v[48:51], 0
 ds_read_b128 a[32:35], v1 offset:25344
 v_mul_f32 v30, s46, v30
 v_mfma_f32_16x16x32_bf16 v[100:103], a[116:119], v[52:55], v[100:103]
 v_exp_f32 v29, v29
 v_mfma_f32_16x16x32_bf16 v[132:135], a[84:87], v[56:59], 0
 ds_read_b128 a[36:39], v1 offset:25408
 v_mul_f32 v31, s46, v31
 v_mfma_f32_16x16x32_bf16 v[132:135], a[116:119], v[60:63], v[132:135]
 v_exp_f32 v30, v30
 v_mfma_f32_16x16x32_bf16 v[104:107], a[88:91], v[48:51], 0
 ds_read_b128 a[40:43], v1 offset:25472
 v_cvt_pk_bf16_f32 v74, v28, v29
 v_mfma_f32_16x16x32_bf16 v[104:107], a[120:123], v[52:55], v[104:107]
 v_exp_f32 v31, v31
 v_mfma_f32_16x16x32_bf16 v[136:139], a[88:91], v[56:59], 0
 ds_read_b128 a[44:47], v1 offset:25536
 v_cvt_pk_bf16_f32 v75, v30, v31
 v_mfma_f32_16x16x32_bf16 v[136:139], a[120:123], v[60:63], v[136:139]
 v_exp_f32 v32, v32
 v_mfma_f32_16x16x32_bf16 v[108:111], a[92:95], v[48:51], 0
 ds_read_b128 a[48:51], v1 offset:25856
 v_mul_f32 v40, s46, v40
 v_mfma_f32_16x16x32_bf16 v[108:111], a[124:127], v[52:55], v[108:111]
 v_exp_f32 v33, v33
 v_mfma_f32_16x16x32_bf16 v[140:143], a[92:95], v[56:59], 0
 s_waitcnt lgkmcnt(9)
 ds_read_b128 a[52:55], v1 offset:25920
 v_cvt_pk_bf16_f32 v68, v32, v33
 v_mfma_f32_16x16x32_bf16 v[140:143], a[124:127], v[60:63], v[140:143]
 v_exp_f32 v34, v34
 v_mfma_f32_16x16x32_bf16 v[16:19], a[0:3], v[208:211], 0
 ds_read_b128 a[56:59], v1 offset:25984
 v_mul_f32 v41, s46, v41
 v_mfma_f32_16x16x32_bf16 v[16:19], a[4:7], v[212:215], v[16:19]
 v_exp_f32 v35, v35
 v_mfma_f32_16x16x32_bf16 v[16:19], a[8:11], v[216:219], v[16:19]
 s_waitcnt lgkmcnt(7)
 ds_read_b128 a[152:155], v7 offset:5296
 v_cvt_pk_bf16_f32 v69, v34, v35
 v_mfma_f32_16x16x32_bf16 v[16:19], a[12:15], v[220:223], v[16:19]
 v_exp_f32 v36, v36
 v_mfma_f32_16x16x32_bf16 v[20:23], a[16:19], v[208:211], 0
 ds_read_b128 a[60:63], v1 offset:26048
 v_mul_f32 v42, s46, v42
 v_mfma_f32_16x16x32_bf16 v[20:23], a[20:23], v[212:215], v[20:23]
 v_exp_f32 v37, v37
 v_mfma_f32_16x16x32_bf16 v[20:23], a[24:27], v[216:219], v[20:23]
 v_exp_f32 v38, v38
 v_mfma_f32_16x16x32_bf16 v[20:23], a[28:31], v[220:223], v[20:23]
 v_exp_f32 v39, v39
 v_mfma_f32_16x16x32_bf16 v[24:27], a[0:3], a[164:167], 0
 v_exp_f32 v40, v40
 v_mfma_f32_16x16x32_bf16 v[24:27], a[4:7], a[168:171], v[24:27]
 v_exp_f32 v41, v41
 v_mfma_f32_16x16x32_bf16 v[24:27], a[8:11], a[172:175], v[24:27]
 v_exp_f32 v42, v42
 v_mfma_f32_16x16x32_bf16 v[24:27], a[12:15], a[176:179], v[24:27]
 v_exp_f32 v16, v16
 v_mfma_f32_16x16x32_bf16 v[28:31], a[16:19], a[164:167], 0
 v_exp_f32 v17, v17
 v_mfma_f32_16x16x32_bf16 v[28:31], a[20:23], a[168:171], v[28:31]
 s_waitcnt lgkmcnt(1)
 v_exp_f32 v18, v18
 v_mfma_f32_16x16x32_bf16 v[28:31], a[24:27], a[172:175], v[28:31]
 buffer_store_dwordx4 a[152:155], v5, s[16:19], 0 offen offset:1280 sc0 sc1
 v_exp_f32 v19, v19
 v_cvt_pk_bf16_f32 v70, v36, v37
 v_mfma_f32_16x16x32_bf16 v[28:31], a[28:31], a[176:179], v[28:31]
 v_exp_f32 v20, v20
 v_mfma_f32_16x16x32_bf16 v[32:35], a[32:35], v[208:211], 0
 v_exp_f32 v21, v21
 v_mfma_f32_16x16x32_bf16 v[32:35], a[36:39], v[212:215], v[32:35]
 v_exp_f32 v22, v22
 v_mfma_f32_16x16x32_bf16 v[32:35], a[40:43], v[216:219], v[32:35]
 s_waitcnt lgkmcnt(0)
 v_exp_f32 v23, v23
 v_mfma_f32_16x16x32_bf16 v[32:35], a[44:47], v[220:223], v[32:35]
 v_cvt_pk_bf16_f32 v71, v38, v39
 v_mul_f32 v43, s46, v43
 v_mfma_f32_16x16x32_bf16 v[36:39], a[48:51], v[208:211], 0
 v_exp_f32 v43, v43
 v_mfma_f32_16x16x32_bf16 v[36:39], a[52:55], v[212:215], v[36:39]
 v_cvt_pk_bf16_f32 v76, v40, v41
 v_cvt_pk_bf16_f32 v77, v42, v43
 v_mfma_f32_16x16x32_bf16 v[36:39], a[56:59], v[216:219], v[36:39]
L_pad5:
 s_cbranch_scc1 L_p1
 v_mul_f32 v44, s46, v44
 v_mul_f32 v45, s46, v45
 v_mfma_f32_16x16x32_bf16 v[36:39], a[60:63], v[220:223], v[36:39]
 v_exp_f32 v44, v44
 v_mfma_f32_16x16x32_bf16 v[40:43], a[32:35], a[164:167], 0
 v_exp_f32 v45, v45
 v_mfma_f32_16x16x32_bf16 v[40:43], a[36:39], a[168:171], v[40:43]
 v_mul_f32 v46, s46, v46
 v_mul_f32 v47, s46, v47
 v_mfma_f32_16x16x32_bf16 v[40:43], a[40:43], a[172:175], v[40:43]
 v_exp_f32 v46, v46
 v_exp_f32 v47, v47
 v_mfma_f32_16x16x32_bf16 v[40:43], a[44:47], a[176:179], v[40:43]
 v_cvt_pk_bf16_f32 v78, v44, v45
 v_cvt_pk_bf16_f32 v79, v46, v47
 v_mfma_f32_16x16x32_bf16 v[44:47], a[48:51], a[164:167], 0
 ds_read_b128 a[156:159], v7 offset:6352
 v_cvt_pk_bf16_f32 v48, v16, v17
 v_mfma_f32_16x16x32_bf16 v[44:47], a[52:55], a[168:171], v[44:47]
 v_cvt_pk_bf16_f32 v49, v18, v19
 v_cvt_pk_bf16_f32 v50, v20, v21
 v_mfma_f32_16x16x32_bf16 v[44:47], a[56:59], a[172:175], v[44:47]
 v_cvt_pk_bf16_f32 v51, v22, v23
 v_mul_f32 v24, s46, v24
 v_mfma_f32_16x16x32_bf16 v[44:47], a[60:63], a[176:179], v[44:47]
 v_exp_f32 v24, v24
 v_smfmac_f32_16x16x64_bf16 a[140:143], a[128:131], v[64:71], v242
 s_waitcnt vmcnt(14) lgkmcnt(1)
 s_barrier
 v_smfmac_f32_16x16x64_bf16 a[144:147], a[128:131], v[72:79], v242
 s_add_u32 m0, s22, 16896
 v_mul_f32 v25, s46, v25
 v_mfma_f32_16x16x32_bf16 v[144:147], a[64:67], v[64:67], 0
 buffer_load_dwordx4 v4, s[4:7], s20 offen nt lds
 v_mfma_f32_16x16x32_bf16 v[144:147], a[96:99], v[68:71], v[144:147]
 v_exp_f32 v25, v25
 v_mfma_f32_16x16x32_bf16 v[176:179], a[64:67], v[72:75], 0
 s_add_u32 m0, s22, 16928
 v_mul_f32 v26, s46, v26
 v_mul_f32 v27, s46, v27
 v_mfma_f32_16x16x32_bf16 v[176:179], a[96:99], v[76:79], v[176:179]
 buffer_load_dwordx4 v4, s[4:7], s20 offen offset:1024 nt lds
 v_mfma_f32_16x16x32_bf16 v[148:151], a[68:71], v[64:67], 0
 s_add_u32 s20, s20, 8192
 ds_read_b64_tr_b16 a[64:65], v2 offset:16896
 v_cvt_pk_bf16_f32 v56, v24, v25
 v_mfma_f32_16x16x32_bf16 v[148:151], a[100:103], v[68:71], v[148:151]
 s_add_u32 m0, s22, 25344
 ds_read_b64_tr_b16 a[66:67], v2 offset:17408
 v_mul_f32 v28, s46, v28
 v_mfma_f32_16x16x32_bf16 v[180:183], a[68:71], v[72:75], 0
 buffer_load_dwordx4 v4, s[4:7], s20 offen nt lds
 v_mfma_f32_16x16x32_bf16 v[180:183], a[100:103], v[76:79], v[180:183]
 ds_read_b64_tr_b16 a[96:97], v2 offset:25344
 v_mul_f32 v29, s46, v29
 v_mfma_f32_16x16x32_bf16 v[152:155], a[72:75], v[64:67], 0
 s_add_u32 m0, s22, 25376
 ds_read_b64_tr_b16 a[98:99], v2 offset:25856
 v_mul_f32 v30, s46, v30
 v_mfma_f32_16x16x32_bf16 v[152:155], a[104:107], v[68:71], v[152:155]
 buffer_load_dwordx4 v4, s[4:7], s20 offen offset:1024 nt lds
 v_mfma_f32_16x16x32_bf16 v[184:187], a[72:75], v[72:75], 0
 s_add_u32 s20, s20, 8192
 ds_read_b64_tr_b16 a[68:69], v2 offset:16904
 v_mul_f32 v31, s46, v31
 v_mfma_f32_16x16x32_bf16 v[184:187], a[104:107], v[76:79], v[184:187]
 ds_read_b64_tr_b16 a[70:71], v2 offset:17416
 v_mul_f32 v40, s46, v40
 v_mfma_f32_16x16x32_bf16 v[156:159], a[76:79], v[64:67], 0
 ds_read_b64_tr_b16 a[100:101], v2 offset:25352
 v_mul_f32 v41, s46, v41
 v_mfma_f32_16x16x32_bf16 v[156:159], a[108:111], v[68:71], v[156:159]
 s_waitcnt lgkmcnt(7)
 ds_read_b64_tr_b16 a[102:103], v2 offset:25864
 v_mul_f32 v42, s46, v42
 v_mfma_f32_16x16x32_bf16 v[188:191], a[76:79], v[72:75], 0
 buffer_store_dwordx4 a[156:159], v5, s[16:19], 0 offen offset:1536 sc0 sc1
 ds_read_b64_tr_b16 a[72:73], v2 offset:16960
 ds_read_b64_tr_b16 a[74:75], v2 offset:17472
 v_mul_f32 v43, s46, v43
 v_mfma_f32_16x16x32_bf16 v[188:191], a[108:111], v[76:79], v[188:191]
 ds_read_b64_tr_b16 a[104:105], v2 offset:25408
 v_mul_f32 v44, s46, v44
 v_mfma_f32_16x16x32_bf16 v[160:163], a[80:83], v[64:67], 0
 ds_read_b64_tr_b16 a[106:107], v2 offset:25920
 v_mul_f32 v45, s46, v45
 v_mfma_f32_16x16x32_bf16 v[160:163], a[112:115], v[68:71], v[160:163]
 ds_read_b64_tr_b16 a[76:77], v2 offset:16968
 v_mul_f32 v46, s46, v46
 v_mfma_f32_16x16x32_bf16 v[192:195], a[80:83], v[72:75], 0
 ds_read_b64_tr_b16 a[78:79], v2 offset:17480
 v_mul_f32 v47, s46, v47
 v_mfma_f32_16x16x32_bf16 v[192:195], a[112:115], v[76:79], v[192:195]
 v_exp_f32 v26, v26
 v_mfma_f32_16x16x32_bf16 v[164:167], a[84:87], v[64:67], 0
 v_exp_f32 v27, v27
 v_mfma_f32_16x16x32_bf16 v[164:167], a[116:119], v[68:71], v[164:167]
 ds_read_b64_tr_b16 a[108:109], v2 offset:25416
 v_cvt_pk_bf16_f32 v57, v26, v27
 v_mfma_f32_16x16x32_bf16 v[196:199], a[84:87], v[72:75], 0
 v_exp_f32 v28, v28
 v_mfma_f32_16x16x32_bf16 v[196:199], a[116:119], v[76:79], v[196:199]
 v_exp_f32 v29, v29
 v_mfma_f32_16x16x32_bf16 v[168:171], a[88:91], v[64:67], 0
 ds_read_b128 a[160:163], v7 offset:7408
 v_cvt_pk_bf16_f32 v58, v28, v29
 v_mfma_f32_16x16x32_bf16 v[168:171], a[120:123], v[68:71], v[168:171]
 v_exp_f32 v30, v30
 v_mfma_f32_16x16x32_bf16 v[200:203], a[88:91], v[72:75], 0
 v_exp_f32 v31, v31
 v_mfma_f32_16x16x32_bf16 v[200:203], a[120:123], v[76:79], v[200:203]
 ds_read_b64_tr_b16 a[110:111], v2 offset:25928
 v_cvt_pk_bf16_f32 v59, v30, v31
 v_mfma_f32_16x16x32_bf16 v[172:175], a[92:95], v[64:67], 0
 v_exp_f32 v32, v32
 v_mfma_f32_16x16x32_bf16 v[172:175], a[124:127], v[68:71], v[172:175]
 v_exp_f32 v33, v33
 v_mfma_f32_16x16x32_bf16 v[204:207], a[92:95], v[72:75], 0
 ds_read_b64_tr_b16 a[80:81], v2 offset:17024
 v_cvt_pk_bf16_f32 v52, v32, v33
 v_mfma_f32_16x16x32_bf16 v[204:207], a[124:127], v[76:79], v[204:207]
 v_exp_f32 v34, v34
 v_mfma_f32_16x16x32_bf16 v[16:19], a[0:3], v[224:227], 0
 v_exp_f32 v35, v35
 v_mfma_f32_16x16x32_bf16 v[16:19], a[4:7], v[228:231], v[16:19]
 ds_read_b64_tr_b16 a[82:83], v2 offset:17536
 v_cvt_pk_bf16_f32 v53, v34, v35
 v_mfma_f32_16x16x32_bf16 v[16:19], a[8:11], v[232:235], v[16:19]
 v_exp_f32 v36, v36
 v_mfma_f32_16x16x32_bf16 v[16:19], a[12:15], v[236:239], v[16:19]
 v_exp_f32 v37, v37
 v_mfma_f32_16x16x32_bf16 v[20:23], a[16:19], v[224:227], 0
 ds_read_b64_tr_b16 a[112:113], v2 offset:25472
 v_cvt_pk_bf16_f32 v54, v36, v37
 v_mfma_f32_16x16x32_bf16 v[20:23], a[20:23], v[228:231], v[20:23]
 v_exp_f32 v38, v38
 v_mfma_f32_16x16x32_bf16 v[20:23], a[24:27], v[232:235], v[20:23]
 v_exp_f32 v39, v39
 v_mfma_f32_16x16x32_bf16 v[20:23], a[28:31], v[236:239], v[20:23]
 ds_read_b64_tr_b16 a[114:115], v2 offset:25984
 v_cvt_pk_bf16_f32 v55, v38, v39
 v_mfma_f32_16x16x32_bf16 v[24:27], a[0:3], a[180:183], 0
 v_exp_f32 v40, v40
 v_mfma_f32_16x16x32_bf16 v[24:27], a[4:7], a[184:187], v[24:27]
 v_exp_f32 v41, v41
 v_mfma_f32_16x16x32_bf16 v[24:27], a[8:11], a[188:191], v[24:27]
 ds_read_b64_tr_b16 a[84:85], v2 offset:17032
 v_cvt_pk_bf16_f32 v60, v40, v41
 v_mfma_f32_16x16x32_bf16 v[24:27], a[12:15], a[192:195], v[24:27]
 v_exp_f32 v42, v42
 v_mfma_f32_16x16x32_bf16 v[28:31], a[16:19], a[180:183], 0
 v_exp_f32 v43, v43
 v_mfma_f32_16x16x32_bf16 v[28:31], a[20:23], a[184:187], v[28:31]
 s_waitcnt lgkmcnt(6)
 ds_read_b64_tr_b16 a[86:87], v2 offset:17544
 v_cvt_pk_bf16_f32 v61, v42, v43
 v_mfma_f32_16x16x32_bf16 v[28:31], a[24:27], a[188:191], v[28:31]
 buffer_store_dwordx4 a[160:163], v5, s[16:19], 0 offen offset:1792 sc0 sc1
 ds_read_b64_tr_b16 a[116:117], v2 offset:25480
 v_exp_f32 v44, v44
 v_mfma_f32_16x16x32_bf16 v[28:31], a[28:31], a[192:195], v[28:31]
 ds_read_b64_tr_b16 a[118:119], v2 offset:25992
 v_mul_f32 v24, s46, v24
 v_mfma_f32_16x16x32_bf16 v[32:35], a[32:35], v[224:227], 0
 ds_read_b64_tr_b16 a[88:89], v2 offset:17088
 v_mul_f32 v25, s46, v25
 v_mfma_f32_16x16x32_bf16 v[32:35], a[36:39], v[228:231], v[32:35]
 ds_read_b64_tr_b16 a[90:91], v2 offset:17600
 v_mul_f32 v26, s46, v26
 v_mfma_f32_16x16x32_bf16 v[32:35], a[40:43], v[232:235], v[32:35]
 ds_read_b64_tr_b16 a[120:121], v2 offset:25536
 v_mul_f32 v27, s46, v27
 v_mfma_f32_16x16x32_bf16 v[32:35], a[44:47], v[236:239], v[32:35]
 ds_read_b64_tr_b16 a[122:123], v2 offset:26048
 v_mul_f32 v28, s46, v28
 v_mfma_f32_16x16x32_bf16 v[36:39], a[48:51], v[224:227], 0
 ds_read_b64_tr_b16 a[92:93], v2 offset:17096
 v_mul_f32 v29, s46, v29
 v_mfma_f32_16x16x32_bf16 v[36:39], a[52:55], v[228:231], v[36:39]
 ds_read_b64_tr_b16 a[94:95], v2 offset:17608
 v_mul_f32 v30, s46, v30
 v_mfma_f32_16x16x32_bf16 v[36:39], a[56:59], v[232:235], v[36:39]
 ds_read_b64_tr_b16 a[124:125], v2 offset:25544
 v_mul_f32 v31, s46, v31
 v_mfma_f32_16x16x32_bf16 v[36:39], a[60:63], v[236:239], v[36:39]
 v_exp_f32 v45, v45
 v_mfma_f32_16x16x32_bf16 v[40:43], a[32:35], a[180:183], 0
 ds_read_b64_tr_b16 a[126:127], v2 offset:26056
 v_cvt_pk_bf16_f32 v62, v44, v45
 v_mfma_f32_16x16x32_bf16 v[40:43], a[36:39], a[184:187], v[40:43]
 v_exp_f32 v46, v46
 v_mfma_f32_16x16x32_bf16 v[40:43], a[40:43], a[188:191], v[40:43]
 v_exp_f32 v47, v47
 v_mfma_f32_16x16x32_bf16 v[40:43], a[44:47], a[192:195], v[40:43]
 ds_read_b128 a[148:151], v7 offset:8448
 v_cvt_pk_bf16_f32 v63, v46, v47
 v_mfma_f32_16x16x32_bf16 v[44:47], a[48:51], a[180:183], 0
 v_exp_f32 v16, v16
 v_mfma_f32_16x16x32_bf16 v[44:47], a[52:55], a[184:187], v[44:47]
 v_exp_f32 v17, v17
 v_mfma_f32_16x16x32_bf16 v[44:47], a[56:59], a[188:191], v[44:47]
 v_exp_f32 v18, v18
 v_mfma_f32_16x16x32_bf16 v[44:47], a[60:63], a[192:195], v[44:47]
 v_exp_f32 v19, v19
 v_smfmac_f32_16x16x64_bf16 a[132:135], a[128:131], v[48:55], v242
 s_waitcnt vmcnt(16) lgkmcnt(1)
 s_barrier
 v_smfmac_f32_16x16x64_bf16 a[136:139], a[128:131], v[56:63], v242
 s_add_u32 m0, s23, 16896
 v_mfma_f32_16x16x32_bf16 v[80:83], a[64:67], v[48:51], v[80:83]
 buffer_load_dwordx4 v4, s[8:11], s21 offen nt lds
 v_mfma_f32_16x16x32_bf16 v[80:83], a[96:99], v[52:55], v[80:83]
 ds_read_b128 a[0:3], v1 offset:0
 v_cvt_pk_bf16_f32 v64, v16, v17
 v_mfma_f32_16x16x32_bf16 v[112:115], a[64:67], v[56:59], v[112:115]
 s_add_u32 m0, s23, 16904
 v_exp_f32 v20, v20
 v_mfma_f32_16x16x32_bf16 v[112:115], a[96:99], v[60:63], v[112:115]
 buffer_load_dwordx4 v4, s[8:11], s21 offen offset:1024 nt lds
 v_mfma_f32_16x16x32_bf16 v[84:87], a[68:71], v[48:51], v[84:87]
 s_add_u32 s21, s21, 8192
 ds_read_b128 a[4:7], v1 offset:64
 v_cvt_pk_bf16_f32 v65, v18, v19
 v_mfma_f32_16x16x32_bf16 v[84:87], a[100:103], v[52:55], v[84:87]
 s_add_u32 m0, s23, 25344
 v_exp_f32 v21, v21
 v_mfma_f32_16x16x32_bf16 v[116:119], a[68:71], v[56:59], v[116:119]
 buffer_load_dwordx4 v4, s[8:11], s21 offen nt lds
 v_mfma_f32_16x16x32_bf16 v[116:119], a[100:103], v[60:63], v[116:119]
 ds_read_b128 a[8:11], v1 offset:128
 v_cvt_pk_bf16_f32 v66, v20, v21
 v_mfma_f32_16x16x32_bf16 v[88:91], a[72:75], v[48:51], v[88:91]
 s_add_u32 m0, s23, 25352
 v_exp_f32 v22, v22
 v_mfma_f32_16x16x32_bf16 v[88:91], a[104:107], v[52:55], v[88:91]
 buffer_load_dwordx4 v4, s[8:11], s21 offen offset:1024 nt lds
 v_mfma_f32_16x16x32_bf16 v[120:123], a[72:75], v[56:59], v[120:123]
 s_add_u32 s21, s21, 8192
 ds_read_b128 a[12:15], v1 offset:192
 v_mul_f32 v40, s46, v40
 v_mfma_f32_16x16x32_bf16 v[120:123], a[104:107], v[60:63], v[120:123]
 v_exp_f32 v23, v23
 v_mfma_f32_16x16x32_bf16 v[92:95], a[76:79], v[48:51], v[92:95]
 ds_read_b128 a[16:19], v1 offset:512
 v_cvt_pk_bf16_f32 v67, v22, v23
 v_mfma_f32_16x16x32_bf16 v[92:95], a[108:111], v[52:55], v[92:95]
 s_waitcnt lgkmcnt(5)
 v_exp_f32 v24, v24
 v_mfma_f32_16x16x32_bf16 v[124:127], a[76:79], v[56:59], v[124:127]
 buffer_store_dwordx4 a[148:151], v5, s[16:19], s25 offen sc0 sc1
 ds_read_b128 a[20:23], v1 offset:576
 v_exp_f32 v25, v25
 v_mfma_f32_16x16x32_bf16 v[124:127], a[108:111], v[60:63], v[124:127]
 v_exp_f32 v26, v26
 v_mfma_f32_16x16x32_bf16 v[96:99], a[80:83], v[48:51], v[96:99]
 ds_read_b128 a[24:27], v1 offset:640
 v_cvt_pk_bf16_f32 v72, v24, v25
 v_mfma_f32_16x16x32_bf16 v[96:99], a[112:115], v[52:55], v[96:99]
 v_exp_f32 v27, v27
 v_mfma_f32_16x16x32_bf16 v[128:131], a[80:83], v[56:59], v[128:131]
 ds_read_b128 a[28:31], v1 offset:704
 v_cvt_pk_bf16_f32 v73, v26, v27
 v_mfma_f32_16x16x32_bf16 v[128:131], a[112:115], v[60:63], v[128:131]
 v_exp_f32 v28, v28
 v_mfma_f32_16x16x32_bf16 v[100:103], a[84:87], v[48:51], v[100:103]
 ds_read_b128 a[32:35], v1 offset:8448
 v_mul_f32 v41, s46, v41
 v_mfma_f32_16x16x32_bf16 v[100:103], a[116:119], v[52:55], v[100:103]
 v_exp_f32 v29, v29
 v_mfma_f32_16x16x32_bf16 v[132:135], a[84:87], v[56:59], v[132:135]
 ds_read_b128 a[36:39], v1 offset:8512
 v_cvt_pk_bf16_f32 v74, v28, v29
 v_mfma_f32_16x16x32_bf16 v[132:135], a[116:119], v[60:63], v[132:135]
 v_exp_f32 v30, v30
 v_mfma_f32_16x16x32_bf16 v[104:107], a[88:91], v[48:51], v[104:107]
 ds_read_b128 a[40:43], v1 offset:8576
 v_mul_f32 v42, s46, v42
 v_mfma_f32_16x16x32_bf16 v[104:107], a[120:123], v[52:55], v[104:107]
 v_exp_f32 v31, v31
 v_mfma_f32_16x16x32_bf16 v[136:139], a[88:91], v[56:59], v[136:139]
 ds_read_b128 a[44:47], v1 offset:8640
 v_cvt_pk_bf16_f32 v75, v30, v31
 v_mfma_f32_16x16x32_bf16 v[136:139], a[120:123], v[60:63], v[136:139]
 v_exp_f32 v32, v32
 v_mfma_f32_16x16x32_bf16 v[108:111], a[92:95], v[48:51], v[108:111]
 ds_read_b128 a[48:51], v1 offset:8960
 v_mul_f32 v43, s46, v43
 v_mfma_f32_16x16x32_bf16 v[108:111], a[124:127], v[52:55], v[108:111]
 v_exp_f32 v33, v33
 v_mfma_f32_16x16x32_bf16 v[140:143], a[92:95], v[56:59], v[140:143]
 s_waitcnt lgkmcnt(9)
 ds_read_b128 a[52:55], v1 offset:9024
 v_cvt_pk_bf16_f32 v68, v32, v33
 v_mfma_f32_16x16x32_bf16 v[140:143], a[124:127], v[60:63], v[140:143]
 v_exp_f32 v34, v34
 v_mfma_f32_16x16x32_bf16 v[16:19], a[0:3], v[208:211], 0
 ds_read_b128 a[56:59], v1 offset:9088
 v_mul_f32 v44, s46, v44
 v_mfma_f32_16x16x32_bf16 v[16:19], a[4:7], v[212:215], v[16:19]
 v_exp_f32 v35, v35
 v_mfma_f32_16x16x32_bf16 v[16:19], a[8:11], v[216:219], v[16:19]
 s_waitcnt lgkmcnt(7)
 ds_read_b128 a[152:155], v7 offset:9504
 v_cvt_pk_bf16_f32 v69, v34, v35
 v_mfma_f32_16x16x32_bf16 v[16:19], a[12:15], v[220:223], v[16:19]
 v_exp_f32 v36, v36
 v_mfma_f32_16x16x32_bf16 v[20:23], a[16:19], v[208:211], 0
 ds_read_b128 a[60:63], v1 offset:9152
 v_mul_f32 v45, s46, v45
 v_mfma_f32_16x16x32_bf16 v[20:23], a[20:23], v[212:215], v[20:23]
 v_exp_f32 v37, v37
 v_mfma_f32_16x16x32_bf16 v[20:23], a[24:27], v[216:219], v[20:23]
 v_exp_f32 v38, v38
 v_mfma_f32_16x16x32_bf16 v[20:23], a[28:31], v[220:223], v[20:23]
 v_exp_f32 v39, v39
 v_mfma_f32_16x16x32_bf16 v[24:27], a[0:3], a[164:167], 0
 v_exp_f32 v40, v40
 v_mfma_f32_16x16x32_bf16 v[24:27], a[4:7], a[168:171], v[24:27]
 v_exp_f32 v41, v41
 v_mfma_f32_16x16x32_bf16 v[24:27], a[8:11], a[172:175], v[24:27]
 v_exp_f32 v42, v42
 v_mfma_f32_16x16x32_bf16 v[24:27], a[12:15], a[176:179], v[24:27]
 v_exp_f32 v43, v43
 v_mfma_f32_16x16x32_bf16 v[28:31], a[16:19], a[164:167], 0
 v_exp_f32 v44, v44
 v_mfma_f32_16x16x32_bf16 v[28:31], a[20:23], a[168:171], v[28:31]
 s_waitcnt lgkmcnt(1)
 v_exp_f32 v45, v45
 v_mfma_f32_16x16x32_bf16 v[28:31], a[24:27], a[172:175], v[28:31]
 buffer_store_dwordx4 a[152:155], v5, s[16:19], s25 offen offset:256 sc0 sc1
 v_exp_f32 v16, v16
 v_cvt_pk_bf16_f32 v70, v36, v37
 v_mfma_f32_16x16x32_bf16 v[28:31], a[28:31], a[176:179], v[28:31]
 v_exp_f32 v17, v17
 v_mfma_f32_16x16x32_bf16 v[32:35], a[32:35], v[208:211], 0
 v_exp_f32 v18, v18
 v_mfma_f32_16x16x32_bf16 v[32:35], a[36:39], v[212:215], v[32:35]
 v_exp_f32 v19, v19
 v_mfma_f32_16x16x32_bf16 v[32:35], a[40:43], v[216:219], v[32:35]
 s_waitcnt lgkmcnt(0)
 v_exp_f32 v20, v20
 v_mfma_f32_16x16x32_bf16 v[32:35], a[44:47], v[220:223], v[32:35]
 v_cvt_pk_bf16_f32 v71, v38, v39
 v_cvt_pk_bf16_f32 v76, v40, v41
 v_mfma_f32_16x16x32_bf16 v[36:39], a[48:51], v[208:211], 0
 v_exp_f32 v21, v21
 v_mfma_f32_16x16x32_bf16 v[36:39], a[52:55], v[212:215], v[36:39]
 v_exp_f32 v22, v22
 v_mfma_f32_16x16x32_bf16 v[36:39], a[56:59], v[216:219], v[36:39]
 v_exp_f32 v23, v23
 v_mfma_f32_16x16x32_bf16 v[36:39], a[60:63], v[220:223], v[36:39]
 v_cvt_pk_bf16_f32 v77, v42, v43
 v_mul_f32 v46, s46, v46
 v_mfma_f32_16x16x32_bf16 v[40:43], a[32:35], a[164:167], 0
 v_exp_f32 v46, v46
 v_mfma_f32_16x16x32_bf16 v[40:43], a[36:39], a[168:171], v[40:43]
 v_mul_f32 v47, s46, v47
 v_cvt_pk_bf16_f32 v78, v44, v45
 v_mfma_f32_16x16x32_bf16 v[40:43], a[40:43], a[172:175], v[40:43]
 v_exp_f32 v47, v47
 v_mfma_f32_16x16x32_bf16 v[40:43], a[44:47], a[176:179], v[40:43]
 ds_read_b128 a[156:159], v7 offset:10560
 v_cvt_pk_bf16_f32 v79, v46, v47
 v_mfma_f32_16x16x32_bf16 v[44:47], a[48:51], a[164:167], 0
 v_cvt_pk_bf16_f32 v48, v16, v17
 v_cvt_pk_bf16_f32 v49, v18, v19
 v_mfma_f32_16x16x32_bf16 v[44:47], a[52:55], a[168:171], v[44:47]
 v_cvt_pk_bf16_f32 v50, v20, v21
 v_cvt_pk_bf16_f32 v51, v22, v23
 v_mfma_f32_16x16x32_bf16 v[44:47], a[56:59], a[172:175], v[44:47]
 v_mul_f32 v24, s46, v24
 v_mul_f32 v25, s46, v25
 v_mfma_f32_16x16x32_bf16 v[44:47], a[60:63], a[176:179], v[44:47]
 v_exp_f32 v24, v24
 v_smfmac_f32_16x16x64_bf16 a[140:143], a[128:131], v[64:71], v242
 s_waitcnt vmcnt(14) lgkmcnt(1)
 s_barrier
 v_smfmac_f32_16x16x64_bf16 a[144:147], a[128:131], v[72:79], v242
 s_add_u32 m0, s22, 0
 v_mul_f32 v26, s46, v26
 v_mfma_f32_16x16x32_bf16 v[144:147], a[64:67], v[64:67], v[144:147]
 buffer_load_dwordx4 v4, s[4:7], s20 offen nt lds
 v_mfma_f32_16x16x32_bf16 v[144:147], a[96:99], v[68:71], v[144:147]
 v_exp_f32 v25, v25
 v_mfma_f32_16x16x32_bf16 v[176:179], a[64:67], v[72:75], v[176:179]
 s_add_u32 m0, s22, 32
 v_exp_f32 v26, v26
 v_mfma_f32_16x16x32_bf16 v[176:179], a[96:99], v[76:79], v[176:179]
 buffer_load_dwordx4 v4, s[4:7], s20 offen offset:1024 nt lds
 v_mfma_f32_16x16x32_bf16 v[148:151], a[68:71], v[64:67], v[148:151]
 s_add_u32 s20, s20, 8192
 ds_read_b64_tr_b16 a[64:65], v2 offset:0
 v_mul_f32 v27, s46, v27
 v_mfma_f32_16x16x32_bf16 v[148:151], a[100:103], v[68:71], v[148:151]
 s_add_u32 m0, s22, 8448
 ds_read_b64_tr_b16 a[66:67], v2 offset:512
 v_cvt_pk_bf16_f32 v56, v24, v25
 v_mfma_f32_16x16x32_bf16 v[180:183], a[68:71], v[72:75], v[180:183]
 buffer_load_dwordx4 v4, s[4:7], s20 offen nt lds
 v_mfma_f32_16x16x32_bf16 v[180:183], a[100:103], v[76:79], v[180:183]
 ds_read_b64_tr_b16 a[96:97], v2 offset:8448
 v_mul_f32 v28, s46, v28
 v_mfma_f32_16x16x32_bf16 v[152:155], a[72:75], v[64:67], v[152:155]
 s_add_u32 m0, s22, 8480
 ds_read_b64_tr_b16 a[98:99], v2 offset:8960
 v_mul_f32 v29, s46, v29
 v_mfma_f32_16x16x32_bf16 v[152:155], a[104:107], v[68:71], v[152:155]
 buffer_load_dwordx4 v4, s[4:7], s20 offen offset:1024 nt lds
 v_mfma_f32_16x16x32_bf16 v[184:187], a[72:75], v[72:75], v[184:187]
 s_add_u32 s20, s20, 8192
 ds_read_b64_tr_b16 a[68:69], v2 offset:8
 v_mul_f32 v30, s46, v30
 v_mfma_f32_16x16x32_bf16 v[184:187], a[104:107], v[76:79], v[184:187]
 ds_read_b64_tr_b16 a[70:71], v2 offset:520
 v_mul_f32 v31, s46, v31
 v_mfma_f32_16x16x32_bf16 v[156:159], a[76:79], v[64:67], v[156:159]
 ds_read_b64_tr_b16 a[100:101], v2 offset:8456
 v_mul_f32 v40, s46, v40
 v_mfma_f32_16x16x32_bf16 v[156:159], a[108:111], v[68:71], v[156:159]
 s_waitcnt lgkmcnt(7)
 ds_read_b64_tr_b16 a[102:103], v2 offset:8968
 v_mul_f32 v41, s46, v41
 v_mfma_f32_16x16x32_bf16 v[188:191], a[76:79], v[72:75], v[188:191]
 buffer_store_dwordx4 a[156:159], v5, s[16:19], s25 offen offset:512 sc0 sc1
 ds_read_b64_tr_b16 a[72:73], v2 offset:64
 ds_read_b64_tr_b16 a[74:75], v2 offset:576
 v_mul_f32 v42, s46, v42
 v_mfma_f32_16x16x32_bf16 v[188:191], a[108:111], v[76:79], v[188:191]
 ds_read_b64_tr_b16 a[104:105], v2 offset:8512
 v_mul_f32 v43, s46, v43
 v_mfma_f32_16x16x32_bf16 v[160:163], a[80:83], v[64:67], v[160:163]
 ds_read_b64_tr_b16 a[106:107], v2 offset:9024
 v_mul_f32 v44, s46, v44
 v_mfma_f32_16x16x32_bf16 v[160:163], a[112:115], v[68:71], v[160:163]
 ds_read_b64_tr_b16 a[76:77], v2 offset:72
 v_mul_f32 v45, s46, v45
 v_mfma_f32_16x16x32_bf16 v[192:195], a[80:83], v[72:75], v[192:195]
 ds_read_b64_tr_b16 a[78:79], v2 offset:584
 v_mul_f32 v46, s46, v46
 v_mfma_f32_16x16x32_bf16 v[192:195], a[112:115], v[76:79], v[192:195]
 ds_read_b64_tr_b16 a[108:109], v2 offset:8520
 v_mul_f32 v47, s46, v47
 v_mfma_f32_16x16x32_bf16 v[164:167], a[84:87], v[64:67], v[164:167]
 v_exp_f32 v27, v27
 v_mfma_f32_16x16x32_bf16 v[164:167], a[116:119], v[68:71], v[164:167]
 ds_read_b64_tr_b16 a[110:111], v2 offset:9032
 v_cvt_pk_bf16_f32 v57, v26, v27
 v_mfma_f32_16x16x32_bf16 v[196:199], a[84:87], v[72:75], v[196:199]
 v_exp_f32 v28, v28
 v_mfma_f32_16x16x32_bf16 v[196:199], a[116:119], v[76:79], v[196:199]
 v_exp_f32 v29, v29
 v_mfma_f32_16x16x32_bf16 v[168:171], a[88:91], v[64:67], v[168:171]
 ds_read_b128 a[160:163], v7 offset:11616
 v_cvt_pk_bf16_f32 v58, v28, v29
 v_mfma_f32_16x16x32_bf16 v[168:171], a[120:123], v[68:71], v[168:171]
 v_exp_f32 v30, v30
 v_mfma_f32_16x16x32_bf16 v[200:203], a[88:91], v[72:75], v[200:203]
 v_exp_f32 v31, v31
 v_mfma_f32_16x16x32_bf16 v[200:203], a[120:123], v[76:79], v[200:203]
 ds_read_b64_tr_b16 a[80:81], v2 offset:128
 v_cvt_pk_bf16_f32 v59, v30, v31
 v_mfma_f32_16x16x32_bf16 v[172:175], a[92:95], v[64:67], v[172:175]
 v_exp_f32 v32, v32
 v_mfma_f32_16x16x32_bf16 v[172:175], a[124:127], v[68:71], v[172:175]
 v_exp_f32 v33, v33
 v_mfma_f32_16x16x32_bf16 v[204:207], a[92:95], v[72:75], v[204:207]
 ds_read_b64_tr_b16 a[82:83], v2 offset:640
 v_cvt_pk_bf16_f32 v52, v32, v33
 v_mfma_f32_16x16x32_bf16 v[204:207], a[124:127], v[76:79], v[204:207]
 v_exp_f32 v34, v34
 v_mfma_f32_16x16x32_bf16 v[16:19], a[0:3], v[224:227], 0
 v_exp_f32 v35, v35
 v_mfma_f32_16x16x32_bf16 v[16:19], a[4:7], v[228:231], v[16:19]
 ds_read_b64_tr_b16 a[112:113], v2 offset:8576
 v_cvt_pk_bf16_f32 v53, v34, v35
 v_mfma_f32_16x16x32_bf16 v[16:19], a[8:11], v[232:235], v[16:19]
 v_exp_f32 v36, v36
 v_mfma_f32_16x16x32_bf16 v[16:19], a[12:15], v[236:239], v[16:19]
 v_exp_f32 v37, v37
 v_mfma_f32_16x16x32_bf16 v[20:23], a[16:19], v[224:227], 0
 ds_read_b64_tr_b16 a[114:115], v2 offset:9088
 v_cvt_pk_bf16_f32 v54, v36, v37
 v_mfma_f32_16x16x32_bf16 v[20:23], a[20:23], v[228:231], v[20:23]
 v_exp_f32 v38, v38
 v_mfma_f32_16x16x32_bf16 v[20:23], a[24:27], v[232:235], v[20:23]
 v_exp_f32 v39, v39
 v_mfma_f32_16x16x32_bf16 v[20:23], a[28:31], v[236:239], v[20:23]
 ds_read_b64_tr_b16 a[84:85], v2 offset:136
 v_cvt_pk_bf16_f32 v55, v38, v39
 v_mfma_f32_16x16x32_bf16 v[24:27], a[0:3], a[180:183], 0
 v_exp_f32 v40, v40
 v_mfma_f32_16x16x32_bf16 v[24:27], a[4:7], a[184:187], v[24:27]
 v_exp_f32 v41, v41
 v_mfma_f32_16x16x32_bf16 v[24:27], a[8:11], a[188:191], v[24:27]
 ds_read_b64_tr_b16 a[86:87], v2 offset:648
 v_cvt_pk_bf16_f32 v60, v40, v41
 v_mfma_f32_16x16x32_bf16 v[24:27], a[12:15], a[192:195], v[24:27]
 v_exp_f32 v42, v42
 v_mfma_f32_16x16x32_bf16 v[28:31], a[16:19], a[180:183], 0
 v_exp_f32 v43, v43
 v_mfma_f32_16x16x32_bf16 v[28:31], a[20:23], a[184:187], v[28:31]
 s_waitcnt lgkmcnt(6)
 ds_read_b64_tr_b16 a[116:117], v2 offset:8584
 v_cvt_pk_bf16_f32 v61, v42, v43
 v_mfma_f32_16x16x32_bf16 v[28:31], a[24:27], a[188:191], v[28:31]
 buffer_store_dwordx4 a[160:163], v5, s[16:19], s25 offen offset:768 sc0 sc1
 ds_read_b64_tr_b16 a[118:119], v2 offset:9096
 v_exp_f32 v44, v44
 v_mfma_f32_16x16x32_bf16 v[28:31], a[28:31], a[192:195], v[28:31]
 ds_read_b64_tr_b16 a[88:89], v2 offset:192
 v_mul_f32 v24, s46, v24
 v_mfma_f32_16x16x32_bf16 v[32:35], a[32:35], v[224:227], 0
 ds_read_b64_tr_b16 a[90:91], v2 offset:704
 v_mul_f32 v25, s46, v25
 v_mfma_f32_16x16x32_bf16 v[32:35], a[36:39], v[228:231], v[32:35]
 ds_read_b64_tr_b16 a[120:121], v2 offset:8640
 v_mul_f32 v26, s46, v26
 v_mfma_f32_16x16x32_bf16 v[32:35], a[40:43], v[232:235], v[32:35]
 ds_read_b64_tr_b16 a[122:123], v2 offset:9152
 v_mul_f32 v27, s46, v27
 v_mfma_f32_16x16x32_bf16 v[32:35], a[44:47], v[236:239], v[32:35]
 ds_read_b64_tr_b16 a[92:93], v2 offset:200
 v_mul_f32 v28, s46, v28
 v_mfma_f32_16x16x32_bf16 v[36:39], a[48:51], v[224:227], 0
 ds_read_b64_tr_b16 a[94:95], v2 offset:712
 v_mul_f32 v29, s46, v29
 v_mfma_f32_16x16x32_bf16 v[36:39], a[52:55], v[228:231], v[36:39]
 ds_read_b64_tr_b16 a[124:125], v2 offset:8648
 v_mul_f32 v30, s46, v30
 v_mfma_f32_16x16x32_bf16 v[36:39], a[56:59], v[232:235], v[36:39]
 ds_read_b64_tr_b16 a[126:127], v2 offset:9160
 v_mul_f32 v31, s46, v31
 v_mfma_f32_16x16x32_bf16 v[36:39], a[60:63], v[236:239], v[36:39]
 v_exp_f32 v45, v45
 v_mfma_f32_16x16x32_bf16 v[40:43], a[32:35], a[180:183], 0
 v_exp_f32 v46, v46
 v_mfma_f32_16x16x32_bf16 v[40:43], a[36:39], a[184:187], v[40:43]
 v_exp_f32 v47, v47
 v_mfma_f32_16x16x32_bf16 v[40:43], a[40:43], a[188:191], v[40:43]
 ds_read_b128 a[148:151], v7 offset:12688
 v_cvt_pk_bf16_f32 v62, v44, v45
 v_mfma_f32_16x16x32_bf16 v[40:43], a[44:47], a[192:195], v[40:43]
 v_cvt_pk_bf16_f32 v63, v46, v47
 v_mfma_f32_16x16x32_bf16 v[44:47], a[48:51], a[180:183], 0
 v_exp_f32 v16, v16
 v_mfma_f32_16x16x32_bf16 v[44:47], a[52:55], a[184:187], v[44:47]
 v_exp_f32 v17, v17
 v_mfma_f32_16x16x32_bf16 v[44:47], a[56:59], a[188:191], v[44:47]
 v_exp_f32 v18, v18
 v_mfma_f32_16x16x32_bf16 v[44:47], a[60:63], a[192:195], v[44:47]
 v_exp_f32 v19, v19
 v_smfmac_f32_16x16x64_bf16 a[132:135], a[128:131], v[48:55], v242
 s_waitcnt vmcnt(14) lgkmcnt(1)
 s_barrier
 v_smfmac_f32_16x16x64_bf16 a[136:139], a[128:131], v[56:63], v242
 s_add_u32 m0, s23, 0
 v_mfma_f32_16x16x32_bf16 v[80:83], a[64:67], v[48:51], v[80:83]
 buffer_load_dwordx4 v4, s[8:11], s21 offen nt lds
 v_mfma_f32_16x16x32_bf16 v[80:83], a[96:99], v[52:55], v[80:83]
 ds_read_b128 a[0:3], v1 offset:16896
 v_cvt_pk_bf16_f32 v64, v16, v17
 v_mfma_f32_16x16x32_bf16 v[112:115], a[64:67], v[56:59], v[112:115]
 s_add_u32 m0, s23, 8
 v_exp_f32 v20, v20
 v_mfma_f32_16x16x32_bf16 v[112:115], a[96:99], v[60:63], v[112:115]
 buffer_load_dwordx4 v4, s[8:11], s21 offen offset:1024 nt lds
 v_mfma_f32_16x16x32_bf16 v[84:87], a[68:71], v[48:51], v[84:87]
 s_add_u32 s21, s21, 8192
 ds_read_b128 a[4:7], v1 offset:16960
 v_cvt_pk_bf16_f32 v65, v18, v19
 v_mfma_f32_16x16x32_bf16 v[84:87], a[100:103], v[52:55], v[84:87]
 s_add_u32 m0, s23, 8448
 v_exp_f32 v21, v21
 v_mfma_f32_16x16x32_bf16 v[116:119], a[68:71], v[56:59], v[116:119]
 buffer_load_dwordx4 v4, s[8:11], s21 offen nt lds
 v_mfma_f32_16x16x32_bf16 v[116:119], a[100:103], v[60:63], v[116:119]
 ds_read_b128 a[8:11], v1 offset:17024
 v_cvt_pk_bf16_f32 v66, v20, v21
 v_mfma_f32_16x16x32_bf16 v[88:91], a[72:75], v[48:51], v[88:91]
 s_add_u32 m0, s23, 8456
 v_exp_f32 v22, v22
 v_mfma_f32_16x16x32_bf16 v[88:91], a[104:107], v[52:55], v[88:91]
 buffer_load_dwordx4 v4, s[8:11], s21 offen offset:1024 nt lds
 v_mfma_f32_16x16x32_bf16 v[120:123], a[72:75], v[56:59], v[120:123]
 s_add_u32 s21, s21, 8192
 ds_read_b128 a[12:15], v1 offset:17088
 v_mul_f32 v40, s46, v40
 v_mfma_f32_16x16x32_bf16 v[120:123], a[104:107], v[60:63], v[120:123]
 v_exp_f32 v23, v23
 v_mfma_f32_16x16x32_bf16 v[92:95], a[76:79], v[48:51], v[92:95]
 ds_read_b128 a[16:19], v1 offset:17408
 v_cvt_pk_bf16_f32 v67, v22, v23
 v_mfma_f32_16x16x32_bf16 v[92:95], a[108:111], v[52:55], v[92:95]
 s_waitcnt lgkmcnt(5)
 v_exp_f32 v24, v24
 v_mfma_f32_16x16x32_bf16 v[124:127], a[76:79], v[56:59], v[124:127]
 buffer_store_dwordx4 a[148:151], v5, s[16:19], s25 offen offset:1024 sc0 sc1
 ds_read_b128 a[20:23], v1 offset:17472
 v_exp_f32 v25, v25
 v_mfma_f32_16x16x32_bf16 v[124:127], a[108:111], v[60:63], v[124:127]
 v_exp_f32_e64 v26, v26
 v_mfma_f32_16x16x32_bf16 v[96:99], a[80:83], v[48:51], v[96:99]
 ds_read_b128 a[24:27], v1 offset:17536
 v_cvt_pk_bf16_f32 v72, v24, v25
 v_mfma_f32_16x16x32_bf16 v[96:99], a[112:115], v[52:55], v[96:99]
L_pad6:
 s_cbranch_scc1 L_p1
 v_exp_f32 v27, v27
 v_mfma_f32_16x16x32_bf16 v[128:131], a[80:83], v[56:59], v[128:131]
 ds_read_b128 a[28:31], v1 offset:17600
 v_cvt_pk_bf16_f32 v73, v26, v27
 v_mfma_f32_16x16x32_bf16 v[128:131], a[112:115], v[60:63], v[128:131]
 v_exp_f32 v28, v28
 v_mfma_f32_16x16x32_bf16 v[100:103], a[84:87], v[48:51], v[100:103]
 ds_read_b128 a[32:35], v1 offset:25344
 v_mul_f32 v41, s46, v41
 v_mfma_f32_16x16x32_bf16 v[100:103], a[116:119], v[52:55], v[100:103]
 v_exp_f32 v29, v29
 v_mfma_f32_16x16x32_bf16 v[132:135], a[84:87], v[56:59], v[132:135]
 ds_read_b128 a[36:39], v1 offset:25408
 v_cvt_pk_bf16_f32 v74, v28, v29
 v_mfma_f32_16x16x32_bf16 v[132:135], a[116:119], v[60:63], v[132:135]
 v_exp_f32 v30, v30
 v_mfma_f32_16x16x32_bf16 v[104:107], a[88:91], v[48:51], v[104:107]
 ds_read_b128 a[40:43], v1 offset:25472
 v_mul_f32 v42, s46, v42
 v_mfma_f32_16x16x32_bf16 v[104:107], a[120:123], v[52:55], v[104:107]
 v_exp_f32 v31, v31
 v_mfma_f32_16x16x32_bf16 v[136:139], a[88:91], v[56:59], v[136:139]
 ds_read_b128 a[44:47], v1 offset:25536
 v_cvt_pk_bf16_f32 v75, v30, v31
 v_mfma_f32_16x16x32_bf16 v[136:139], a[120:123], v[60:63], v[136:139]
 v_exp_f32 v32, v32
 v_mfma_f32_16x16x32_bf16 v[108:111], a[92:95], v[48:51], v[108:111]
 ds_read_b128 a[48:51], v1 offset:25856
 v_mul_f32 v43, s46, v43
 v_mfma_f32_16x16x32_bf16 v[108:111], a[124:127], v[52:55], v[108:111]
 v_exp_f32 v33, v33
 v_mfma_f32_16x16x32_bf16 v[140:143], a[92:95], v[56:59], v[140:143]
 s_waitcnt lgkmcnt(9)
 ds_read_b128 a[52:55], v1 offset:25920
 v_cvt_pk_bf16_f32 v68, v32, v33
 v_mfma_f32_16x16x32_bf16 v[140:143], a[124:127], v[60:63], v[140:143]
 v_exp_f32 v34, v34
 v_mfma_f32_16x16x32_bf16 v[16:19], a[0:3], v[208:211], 0
 ds_read_b128 a[56:59], v1 offset:25984
 v_mul_f32 v44, s46, v44
 v_mfma_f32_16x16x32_bf16 v[16:19], a[4:7], v[212:215], v[16:19]
 v_exp_f32 v35, v35
 v_mfma_f32_16x16x32_bf16 v[16:19], a[8:11], v[216:219], v[16:19]
 s_waitcnt lgkmcnt(7)
 ds_read_b128 a[152:155], v7 offset:13744
 v_cvt_pk_bf16_f32 v69, v34, v35
 v_mfma_f32_16x16x32_bf16 v[16:19], a[12:15], v[220:223], v[16:19]
 v_exp_f32 v36, v36
 v_mfma_f32_16x16x32_bf16 v[20:23], a[16:19], v[208:211], 0
 ds_read_b128 a[60:63], v1 offset:26048
 v_mul_f32 v45, s46, v45
 v_mfma_f32_16x16x32_bf16 v[20:23], a[20:23], v[212:215], v[20:23]
 v_exp_f32 v37, v37
 v_mfma_f32_16x16x32_bf16 v[20:23], a[24:27], v[216:219], v[20:23]
 v_exp_f32 v38, v38
 v_mfma_f32_16x16x32_bf16 v[20:23], a[28:31], v[220:223], v[20:23]
 v_exp_f32 v39, v39
 v_mfma_f32_16x16x32_bf16 v[24:27], a[0:3], a[164:167], 0
 v_exp_f32 v40, v40
 v_mfma_f32_16x16x32_bf16 v[24:27], a[4:7], a[168:171], v[24:27]
 v_exp_f32 v41, v41
 v_mfma_f32_16x16x32_bf16 v[24:27], a[8:11], a[172:175], v[24:27]
 v_exp_f32 v42, v42
 v_mfma_f32_16x16x32_bf16 v[24:27], a[12:15], a[176:179], v[24:27]
 v_exp_f32 v43, v43
 v_mfma_f32_16x16x32_bf16 v[28:31], a[16:19], a[164:167], 0
 v_exp_f32 v44, v44
 v_mfma_f32_16x16x32_bf16 v[28:31], a[20:23], a[168:171], v[28:31]
 s_waitcnt lgkmcnt(1)
 v_exp_f32 v45, v45
 v_mfma_f32_16x16x32_bf16 v[28:31], a[24:27], a[172:175], v[28:31]
 buffer_store_dwordx4 a[152:155], v5, s[16:19], s25 offen offset:1280 sc0 sc1
 v_exp_f32 v16, v16
 v_cvt_pk_bf16_f32 v70, v36, v37
 v_mfma_f32_16x16x32_bf16 v[28:31], a[28:31], a[176:179], v[28:31]
 v_exp_f32 v17, v17
 v_mfma_f32_16x16x32_bf16 v[32:35], a[32:35], v[208:211], 0
 v_exp_f32 v18, v18
 v_mfma_f32_16x16x32_bf16 v[32:35], a[36:39], v[212:215], v[32:35]
 v_exp_f32 v19, v19
 v_mfma_f32_16x16x32_bf16 v[32:35], a[40:43], v[216:219], v[32:35]
 s_waitcnt lgkmcnt(0)
 v_exp_f32 v20, v20
 v_mfma_f32_16x16x32_bf16 v[32:35], a[44:47], v[220:223], v[32:35]
 v_cvt_pk_bf16_f32 v71, v38, v39
 v_cvt_pk_bf16_f32 v76, v40, v41
 v_mfma_f32_16x16x32_bf16 v[36:39], a[48:51], v[208:211], 0
 v_exp_f32 v21, v21
 v_mfma_f32_16x16x32_bf16 v[36:39], a[52:55], v[212:215], v[36:39]
 v_exp_f32 v22, v22
 v_mfma_f32_16x16x32_bf16 v[36:39], a[56:59], v[216:219], v[36:39]
 v_exp_f32 v23, v23
 v_mfma_f32_16x16x32_bf16 v[36:39], a[60:63], v[220:223], v[36:39]
 v_cvt_pk_bf16_f32 v77, v42, v43
 v_mul_f32 v46, s46, v46
 v_mfma_f32_16x16x32_bf16 v[40:43], a[32:35], a[164:167], 0
 v_exp_f32 v46, v46
 v_mfma_f32_16x16x32_bf16 v[40:43], a[36:39], a[168:171], v[40:43]
 v_mul_f32 v47, s46, v47
 v_cvt_pk_bf16_f32 v78, v44, v45
 v_mfma_f32_16x16x32_bf16 v[40:43], a[40:43], a[172:175], v[40:43]
 v_exp_f32 v47, v47
 v_mfma_f32_16x16x32_bf16 v[40:43], a[44:47], a[176:179], v[40:43]
 ds_read_b128 a[156:159], v7 offset:14800
 v_cvt_pk_bf16_f32 v79, v46, v47
 v_mfma_f32_16x16x32_bf16 v[44:47], a[48:51], a[164:167], 0
 v_cvt_pk_bf16_f32 v48, v16, v17
 v_cvt_pk_bf16_f32 v49, v18, v19
 v_mfma_f32_16x16x32_bf16 v[44:47], a[52:55], a[168:171], v[44:47]
 v_cvt_pk_bf16_f32 v50, v20, v21
 v_cvt_pk_bf16_f32 v51, v22, v23
 v_mfma_f32_16x16x32_bf16 v[44:47], a[56:59], a[172:175], v[44:47]
 v_mul_f32 v24, s46, v24
 v_mul_f32 v25, s46, v25
 v_mfma_f32_16x16x32_bf16 v[44:47], a[60:63], a[176:179], v[44:47]
 v_exp_f32 v24, v24
 v_smfmac_f32_16x16x64_bf16 a[140:143], a[128:131], v[64:71], v242
 s_waitcnt vmcnt(14) lgkmcnt(1)
 s_barrier
 v_smfmac_f32_16x16x64_bf16 a[144:147], a[128:131], v[72:79], v242
 s_add_u32 m0, s22, 16896
 v_mul_f32 v26, s46, v26
 v_mfma_f32_16x16x32_bf16 v[144:147], a[64:67], v[64:67], v[144:147]
 buffer_load_dwordx4 v4, s[4:7], s20 offen nt lds
 v_mfma_f32_16x16x32_bf16 v[144:147], a[96:99], v[68:71], v[144:147]
 v_exp_f32 v25, v25
 v_mfma_f32_16x16x32_bf16 v[176:179], a[64:67], v[72:75], v[176:179]
 s_add_u32 m0, s22, 16928
 v_exp_f32 v26, v26
 v_mfma_f32_16x16x32_bf16 v[176:179], a[96:99], v[76:79], v[176:179]
 buffer_load_dwordx4 v4, s[4:7], s20 offen offset:1024 nt lds
 v_mfma_f32_16x16x32_bf16 v[148:151], a[68:71], v[64:67], v[148:151]
 s_add_u32 s20, s20, 8192
 ds_read_b64_tr_b16 a[64:65], v2 offset:16896
 v_mul_f32 v27, s46, v27
 v_mfma_f32_16x16x32_bf16 v[148:151], a[100:103], v[68:71], v[148:151]
 s_add_u32 m0, s22, 25344
 ds_read_b64_tr_b16 a[66:67], v2 offset:17408
 v_cvt_pk_bf16_f32 v56, v24, v25
 v_mfma_f32_16x16x32_bf16 v[180:183], a[68:71], v[72:75], v[180:183]
 buffer_load_dwordx4 v4, s[4:7], s20 offen nt lds
 v_mfma_f32_16x16x32_bf16 v[180:183], a[100:103], v[76:79], v[180:183]
 ds_read_b64_tr_b16 a[96:97], v2 offset:25344
 v_mul_f32 v28, s46, v28
 v_mfma_f32_16x16x32_bf16 v[152:155], a[72:75], v[64:67], v[152:155]
 s_add_u32 m0, s22, 25376
 ds_read_b64_tr_b16 a[98:99], v2 offset:25856
 v_mul_f32 v29, s46, v29
 v_mfma_f32_16x16x32_bf16 v[152:155], a[104:107], v[68:71], v[152:155]
 buffer_load_dwordx4 v4, s[4:7], s20 offen offset:1024 nt lds
 v_mfma_f32_16x16x32_bf16 v[184:187], a[72:75], v[72:75], v[184:187]
 s_add_u32 s20, s20, 8192
 ds_read_b64_tr_b16 a[68:69], v2 offset:16904
 v_mul_f32 v30, s46, v30
 v_mfma_f32_16x16x32_bf16 v[184:187], a[104:107], v[76:79], v[184:187]
 ds_read_b64_tr_b16 a[70:71], v2 offset:17416
 v_mul_f32 v31, s46, v31
 v_mfma_f32_16x16x32_bf16 v[156:159], a[76:79], v[64:67], v[156:159]
 ds_read_b64_tr_b16 a[100:101], v2 offset:25352
 v_mul_f32 v40, s46, v40
 v_mfma_f32_16x16x32_bf16 v[156:159], a[108:111], v[68:71], v[156:159]
 s_waitcnt lgkmcnt(7)
 ds_read_b64_tr_b16 a[102:103], v2 offset:25864
 v_mul_f32 v41, s46, v41
 v_mfma_f32_16x16x32_bf16 v[188:191], a[76:79], v[72:75], v[188:191]
 buffer_store_dwordx4 a[156:159], v5, s[16:19], s25 offen offset:1536 sc0 sc1
 ds_read_b64_tr_b16 a[72:73], v2 offset:16960
 ds_read_b64_tr_b16 a[74:75], v2 offset:17472
 v_mul_f32 v42, s46, v42
 v_mfma_f32_16x16x32_bf16 v[188:191], a[108:111], v[76:79], v[188:191]
 ds_read_b64_tr_b16 a[104:105], v2 offset:25408
 v_mul_f32 v43, s46, v43
 v_mfma_f32_16x16x32_bf16 v[160:163], a[80:83], v[64:67], v[160:163]
 ds_read_b64_tr_b16 a[106:107], v2 offset:25920
 v_mul_f32 v44, s46, v44
 v_mfma_f32_16x16x32_bf16 v[160:163], a[112:115], v[68:71], v[160:163]
 ds_read_b64_tr_b16 a[76:77], v2 offset:16968
 v_mul_f32 v45, s46, v45
 v_mfma_f32_16x16x32_bf16 v[192:195], a[80:83], v[72:75], v[192:195]
 ds_read_b64_tr_b16 a[78:79], v2 offset:17480
 v_mul_f32 v46, s46, v46
 v_mfma_f32_16x16x32_bf16 v[192:195], a[112:115], v[76:79], v[192:195]
 ds_read_b64_tr_b16 a[108:109], v2 offset:25416
 v_mul_f32 v47, s46, v47
 v_mfma_f32_16x16x32_bf16 v[164:167], a[84:87], v[64:67], v[164:167]
 v_exp_f32 v27, v27
 v_mfma_f32_16x16x32_bf16 v[164:167], a[116:119], v[68:71], v[164:167]
 ds_read_b64_tr_b16 a[110:111], v2 offset:25928
 v_cvt_pk_bf16_f32 v57, v26, v27
 v_mfma_f32_16x16x32_bf16 v[196:199], a[84:87], v[72:75], v[196:199]
 v_exp_f32 v28, v28
 v_mfma_f32_16x16x32_bf16 v[196:199], a[116:119], v[76:79], v[196:199]
 v_exp_f32 v29, v29
 v_mfma_f32_16x16x32_bf16 v[168:171], a[88:91], v[64:67], v[168:171]
 ds_read_b128 a[160:163], v7 offset:15856
 v_cvt_pk_bf16_f32 v58, v28, v29
 v_mfma_f32_16x16x32_bf16 v[168:171], a[120:123], v[68:71], v[168:171]
 v_exp_f32 v30, v30
 v_mfma_f32_16x16x32_bf16 v[200:203], a[88:91], v[72:75], v[200:203]
 v_exp_f32 v31, v31
 v_mfma_f32_16x16x32_bf16 v[200:203], a[120:123], v[76:79], v[200:203]
 ds_read_b64_tr_b16 a[80:81], v2 offset:17024
 v_cvt_pk_bf16_f32 v59, v30, v31
 v_mfma_f32_16x16x32_bf16 v[172:175], a[92:95], v[64:67], v[172:175]
 v_exp_f32 v32, v32
 v_mfma_f32_16x16x32_bf16 v[172:175], a[124:127], v[68:71], v[172:175]
 v_exp_f32 v33, v33
 v_mfma_f32_16x16x32_bf16 v[204:207], a[92:95], v[72:75], v[204:207]
 ds_read_b64_tr_b16 a[82:83], v2 offset:17536
 v_cvt_pk_bf16_f32 v52, v32, v33
 v_mfma_f32_16x16x32_bf16 v[204:207], a[124:127], v[76:79], v[204:207]
 v_exp_f32 v34, v34
 v_mfma_f32_16x16x32_bf16 v[16:19], a[0:3], v[224:227], 0
 v_exp_f32 v35, v35
 v_mfma_f32_16x16x32_bf16 v[16:19], a[4:7], v[228:231], v[16:19]
 ds_read_b64_tr_b16 a[112:113], v2 offset:25472
 v_cvt_pk_bf16_f32 v53, v34, v35
 v_mfma_f32_16x16x32_bf16 v[16:19], a[8:11], v[232:235], v[16:19]
 v_exp_f32 v36, v36
 v_mfma_f32_16x16x32_bf16 v[16:19], a[12:15], v[236:239], v[16:19]
 v_exp_f32 v37, v37
 v_mfma_f32_16x16x32_bf16 v[20:23], a[16:19], v[224:227], 0
 ds_read_b64_tr_b16 a[114:115], v2 offset:25984
 v_cvt_pk_bf16_f32 v54, v36, v37
 v_mfma_f32_16x16x32_bf16 v[20:23], a[20:23], v[228:231], v[20:23]
 v_exp_f32 v38, v38
 v_mfma_f32_16x16x32_bf16 v[20:23], a[24:27], v[232:235], v[20:23]
 v_exp_f32 v39, v39
 v_mfma_f32_16x16x32_bf16 v[20:23], a[28:31], v[236:239], v[20:23]
 ds_read_b64_tr_b16 a[84:85], v2 offset:17032
 v_cvt_pk_bf16_f32 v55, v38, v39
 v_mfma_f32_16x16x32_bf16 v[24:27], a[0:3], a[180:183], 0
 v_exp_f32 v40, v40
 v_mfma_f32_16x16x32_bf16 v[24:27], a[4:7], a[184:187], v[24:27]
 v_exp_f32 v41, v41
 v_mfma_f32_16x16x32_bf16 v[24:27], a[8:11], a[188:191], v[24:27]
 ds_read_b64_tr_b16 a[86:87], v2 offset:17544
 v_cvt_pk_bf16_f32 v60, v40, v41
 v_mfma_f32_16x16x32_bf16 v[24:27], a[12:15], a[192:195], v[24:27]
 v_exp_f32 v42, v42
 v_mfma_f32_16x16x32_bf16 v[28:31], a[16:19], a[180:183], 0
 v_exp_f32 v43, v43
 v_mfma_f32_16x16x32_bf16 v[28:31], a[20:23], a[184:187], v[28:31]
 s_waitcnt lgkmcnt(6)
 ds_read_b64_tr_b16 a[116:117], v2 offset:25480
 v_cvt_pk_bf16_f32 v61, v42, v43
 v_mfma_f32_16x16x32_bf16 v[28:31], a[24:27], a[188:191], v[28:31]
 buffer_store_dwordx4 a[160:163], v5, s[16:19], s25 offen offset:1792 sc0 sc1
 ds_read_b64_tr_b16 a[118:119], v2 offset:25992
 v_exp_f32 v44, v44
 v_mfma_f32_16x16x32_bf16 v[28:31], a[28:31], a[192:195], v[28:31]
 s_add_u32 s16, s16, s49
 s_addc_u32 s17, s17, 0
 ds_read_b64_tr_b16 a[88:89], v2 offset:17088
 v_mfma_f32_16x16x32_bf16 v[32:35], a[32:35], v[224:227], 0
 ds_read_b64_tr_b16 a[90:91], v2 offset:17600
 v_mul_f32 v24, s46, v24
 v_mfma_f32_16x16x32_bf16 v[32:35], a[36:39], v[228:231], v[32:35]
 ds_read_b64_tr_b16 a[120:121], v2 offset:25536
 v_mul_f32 v25, s46, v25
 v_mfma_f32_16x16x32_bf16 v[32:35], a[40:43], v[232:235], v[32:35]
 ds_read_b64_tr_b16 a[122:123], v2 offset:26048
 v_mul_f32 v26, s46, v26
 v_mfma_f32_16x16x32_bf16 v[32:35], a[44:47], v[236:239], v[32:35]
 ds_read_b64_tr_b16 a[92:93], v2 offset:17096
 v_mul_f32 v27, s46, v27
 v_mfma_f32_16x16x32_bf16 v[36:39], a[48:51], v[224:227], 0
 ds_read_b64_tr_b16 a[94:95], v2 offset:17608
 v_mul_f32 v28, s46, v28
 v_mfma_f32_16x16x32_bf16 v[36:39], a[52:55], v[228:231], v[36:39]
 ds_read_b64_tr_b16 a[124:125], v2 offset:25544
 v_mul_f32 v29, s46, v29
 v_mfma_f32_16x16x32_bf16 v[36:39], a[56:59], v[232:235], v[36:39]
 ds_read_b64_tr_b16 a[126:127], v2 offset:26056
 v_mul_f32 v30, s46, v30
 v_mfma_f32_16x16x32_bf16 v[36:39], a[60:63], v[236:239], v[36:39]
 v_exp_f32 v45, v45
 v_mfma_f32_16x16x32_bf16 v[40:43], a[32:35], a[180:183], 0
 s_add_u32 s24, s24, 1
 v_exp_f32 v46, v46
 v_mfma_f32_16x16x32_bf16 v[40:43], a[36:39], a[184:187], v[40:43]
 v_exp_f32 v47, v47
 v_mfma_f32_16x16x32_bf16 v[40:43], a[40:43], a[188:191], v[40:43]
 v_exp_f32 v16, v16
 v_mfma_f32_16x16x32_bf16 v[40:43], a[44:47], a[192:195], v[40:43]
 v_cvt_pk_bf16_f32 v62, v44, v45
 v_cvt_pk_bf16_f32 v63, v46, v47
 v_mfma_f32_16x16x32_bf16 v[44:47], a[48:51], a[180:183], 0
 v_exp_f32 v17, v17
 v_mfma_f32_16x16x32_bf16 v[44:47], a[52:55], a[184:187], v[44:47]
 v_exp_f32 v18, v18
 v_mfma_f32_16x16x32_bf16 v[44:47], a[56:59], a[188:191], v[44:47]
 v_exp_f32_e64 v19, v19
 v_mfma_f32_16x16x32_bf16 v[44:47], a[60:63], a[192:195], v[44:47]
 v_cvt_pk_bf16_f32 v64, v16, v17
 s_branch L_loop
L_last:
 v_smfmac_f32_16x16x64_bf16 a[140:143], a[128:131], v[64:71], v242
 s_waitcnt vmcnt(8) lgkmcnt(0)
 s_barrier
 v_smfmac_f32_16x16x64_bf16 a[144:147], a[128:131], v[72:79], v242
 ds_read_b128 a[0:3], v1 offset:16896
 v_mfma_f32_16x16x32_bf16 v[144:147], a[64:67], v[64:67], v[144:147]
 v_cvt_pk_bf16_f32 v50, v20, v21
 v_cvt_pk_bf16_f32 v51, v22, v23
 v_mfma_f32_16x16x32_bf16 v[144:147], a[96:99], v[68:71], v[144:147]
 ds_read_b128 a[4:7], v1 offset:16960
 v_mul_f32 v24, s46, v24
 v_mfma_f32_16x16x32_bf16 v[176:179], a[64:67], v[72:75], v[176:179]
 v_exp_f32 v24, v24
 v_mfma_f32_16x16x32_bf16 v[176:179], a[96:99], v[76:79], v[176:179]
 ds_read_b128 a[8:11], v1 offset:17024
 v_mul_f32 v25, s46, v25
 v_mfma_f32_16x16x32_bf16 v[148:151], a[68:71], v[64:67], v[148:151]
 ds_read_b64_tr_b16 a[64:65], v2 offset:0
 v_mul_f32 v26, s46, v26
 v_mfma_f32_16x16x32_bf16 v[148:151], a[100:103], v[68:71], v[148:151]
 ds_read_b128 a[12:15], v1 offset:17088
 v_mul_f32 v27, s46, v27
 v_mfma_f32_16x16x32_bf16 v[180:183], a[68:71], v[72:75], v[180:183]
 ds_read_b64_tr_b16 a[66:67], v2 offset:512
 v_mul_f32 v28, s46, v28
 v_mfma_f32_16x16x32_bf16 v[180:183], a[100:103], v[76:79], v[180:183]
 ds_read_b128 a[16:19], v1 offset:17408
 v_mul_f32 v29, s46, v29
 v_mfma_f32_16x16x32_bf16 v[152:155], a[72:75], v[64:67], v[152:155]
 ds_read_b64_tr_b16 a[96:97], v2 offset:8448
 v_mul_f32 v30, s46, v30
 v_mfma_f32_16x16x32_bf16 v[152:155], a[104:107], v[68:71], v[152:155]
 ds_read_b128 a[20:23], v1 offset:17472
 v_mul_f32 v31, s46, v31
 v_mfma_f32_16x16x32_bf16 v[184:187], a[72:75], v[72:75], v[184:187]
 ds_read_b64_tr_b16 a[98:99], v2 offset:8960
 v_mul_f32 v40, s46, v40
 v_mfma_f32_16x16x32_bf16 v[184:187], a[104:107], v[76:79], v[184:187]
 ds_read_b128 a[24:27], v1 offset:17536
 v_mul_f32 v41, s46, v41
 v_mfma_f32_16x16x32_bf16 v[156:159], a[76:79], v[64:67], v[156:159]
 ds_read_b64_tr_b16 a[68:69], v2 offset:8
 v_mul_f32 v42, s46, v42
 v_mfma_f32_16x16x32_bf16 v[156:159], a[108:111], v[68:71], v[156:159]
 ds_read_b128 a[28:31], v1 offset:17600
 v_mul_f32 v43, s46, v43
 v_mfma_f32_16x16x32_bf16 v[188:191], a[76:79], v[72:75], v[188:191]
 ds_read_b64_tr_b16 a[70:71], v2 offset:520
 v_mul_f32 v44, s46, v44
 v_mfma_f32_16x16x32_bf16 v[188:191], a[108:111], v[76:79], v[188:191]
 ds_read_b128 a[32:35], v1 offset:25344
 v_mul_f32 v45, s46, v45
 v_mfma_f32_16x16x32_bf16 v[160:163], a[80:83], v[64:67], v[160:163]
 ds_read_b64_tr_b16 a[100:101], v2 offset:8456
 v_mul_f32 v46, s46, v46
 v_mfma_f32_16x16x32_bf16 v[160:163], a[112:115], v[68:71], v[160:163]
 ds_read_b128 a[36:39], v1 offset:25408
 v_mul_f32 v47, s46, v47
 v_mfma_f32_16x16x32_bf16 v[192:195], a[80:83], v[72:75], v[192:195]
 v_exp_f32 v25, v25
 v_mfma_f32_16x16x32_bf16 v[192:195], a[112:115], v[76:79], v[192:195]
 ds_read_b128 a[40:43], v1 offset:25472
 v_cvt_pk_bf16_f32 v56, v24, v25
 v_mfma_f32_16x16x32_bf16 v[164:167], a[84:87], v[64:67], v[164:167]
 v_exp_f32 v26, v26
 v_mfma_f32_16x16x32_bf16 v[164:167], a[116:119], v[68:71], v[164:167]
 v_exp_f32 v27, v27
 v_mfma_f32_16x16x32_bf16 v[196:199], a[84:87], v[72:75], v[196:199]
 ds_read_b128 a[44:47], v1 offset:25536
 v_cvt_pk_bf16_f32 v57, v26, v27
 v_mfma_f32_16x16x32_bf16 v[196:199], a[116:119], v[76:79], v[196:199]
 v_exp_f32 v28, v28
 v_mfma_f32_16x16x32_bf16 v[168:171], a[88:91], v[64:67], v[168:171]
 v_exp_f32 v29, v29
 v_mfma_f32_16x16x32_bf16 v[168:171], a[120:123], v[68:71], v[168:171]
 ds_read_b128 a[48:51], v1 offset:25856
 v_cvt_pk_bf16_f32 v58, v28, v29
 v_mfma_f32_16x16x32_bf16 v[200:203], a[88:91], v[72:75], v[200:203]
 v_exp_f32 v30, v30
 v_mfma_f32_16x16x32_bf16 v[200:203], a[120:123], v[76:79], v[200:203]
 v_exp_f32 v31, v31
 v_mfma_f32_16x16x32_bf16 v[172:175], a[92:95], v[64:67], v[172:175]
 ds_read_b128 a[52:55], v1 offset:25920
 v_cvt_pk_bf16_f32 v59, v30, v31
 v_mfma_f32_16x16x32_bf16 v[172:175], a[124:127], v[68:71], v[172:175]
 v_exp_f32 v32, v32
 v_mfma_f32_16x16x32_bf16 v[204:207], a[92:95], v[72:75], v[204:207]
 s_waitcnt lgkmcnt(14)
 v_exp_f32 v33, v33
 v_mfma_f32_16x16x32_bf16 v[204:207], a[124:127], v[76:79], v[204:207]
 ds_read_b128 a[56:59], v1 offset:25984
 v_cvt_pk_bf16_f32 v52, v32, v33
 v_mfma_f32_16x16x32_bf16 v[16:19], a[0:3], v[208:211], 0
 v_exp_f32 v34, v34
 v_mfma_f32_16x16x32_bf16 v[16:19], a[4:7], v[212:215], v[16:19]
 v_exp_f32 v35, v35
 v_mfma_f32_16x16x32_bf16 v[16:19], a[8:11], v[216:219], v[16:19]
 s_waitcnt lgkmcnt(9)
 ds_read_b128 a[60:63], v1 offset:26048
 v_cvt_pk_bf16_f32 v53, v34, v35
 v_mfma_f32_16x16x32_bf16 v[16:19], a[12:15], v[220:223], v[16:19]
 v_exp_f32 v36, v36
 v_mfma_f32_16x16x32_bf16 v[20:23], a[16:19], v[208:211], 0
 v_exp_f32 v37, v37
 v_mfma_f32_16x16x32_bf16 v[20:23], a[20:23], v[212:215], v[20:23]
 ds_read_b64_tr_b16 a[102:103], v2 offset:8968
 v_cvt_pk_bf16_f32 v54, v36, v37
 v_mfma_f32_16x16x32_bf16 v[20:23], a[24:27], v[216:219], v[20:23]
 v_exp_f32 v38, v38
 v_mfma_f32_16x16x32_bf16 v[20:23], a[28:31], v[220:223], v[20:23]
 v_exp_f32 v39, v39
 v_mfma_f32_16x16x32_bf16 v[24:27], a[0:3], a[164:167], 0
 ds_read_b64_tr_b16 a[72:73], v2 offset:64
 v_cvt_pk_bf16_f32 v55, v38, v39
 v_mfma_f32_16x16x32_bf16 v[24:27], a[4:7], a[168:171], v[24:27]
 v_exp_f32 v40, v40
 v_mfma_f32_16x16x32_bf16 v[24:27], a[8:11], a[172:175], v[24:27]
 v_exp_f32 v41, v41
 v_mfma_f32_16x16x32_bf16 v[24:27], a[12:15], a[176:179], v[24:27]
 ds_read_b64_tr_b16 a[74:75], v2 offset:576
 v_cvt_pk_bf16_f32 v60, v40, v41
 v_mfma_f32_16x16x32_bf16 v[28:31], a[16:19], a[164:167], 0
 v_exp_f32 v42, v42
 v_mfma_f32_16x16x32_bf16 v[28:31], a[20:23], a[168:171], v[28:31]
 v_exp_f32 v43, v43
 v_mfma_f32_16x16x32_bf16 v[28:31], a[24:27], a[172:175], v[28:31]
 s_waitcnt lgkmcnt(7)
 ds_read_b64_tr_b16 a[104:105], v2 offset:8512
 v_cvt_pk_bf16_f32 v61, v42, v43
 v_mfma_f32_16x16x32_bf16 v[28:31], a[28:31], a[176:179], v[28:31]
 ds_read_b64_tr_b16 a[106:107], v2 offset:9024
 v_mul_f32 v24, s46, v24
 v_mfma_f32_16x16x32_bf16 v[32:35], a[32:35], v[208:211], 0
 ds_read_b64_tr_b16 a[76:77], v2 offset:72
 v_mul_f32 v25, s46, v25
 v_mfma_f32_16x16x32_bf16 v[32:35], a[36:39], v[212:215], v[32:35]
 ds_read_b64_tr_b16 a[78:79], v2 offset:584
 v_mul_f32 v26, s46, v26
 v_mfma_f32_16x16x32_bf16 v[32:35], a[40:43], v[216:219], v[32:35]
 s_waitcnt lgkmcnt(7)
 ds_read_b64_tr_b16 a[108:109], v2 offset:8520
 v_mul_f32 v27, s46, v27
 v_mfma_f32_16x16x32_bf16 v[32:35], a[44:47], v[220:223], v[32:35]
 ds_read_b64_tr_b16 a[110:111], v2 offset:9032
 v_mul_f32 v28, s46, v28
 v_mfma_f32_16x16x32_bf16 v[36:39], a[48:51], v[208:211], 0
 ds_read_b64_tr_b16 a[80:81], v2 offset:128
 v_mul_f32 v29, s46, v29
 v_mfma_f32_16x16x32_bf16 v[36:39], a[52:55], v[212:215], v[36:39]
 ds_read_b64_tr_b16 a[82:83], v2 offset:640
 v_mul_f32 v30, s46, v30
 v_mfma_f32_16x16x32_bf16 v[36:39], a[56:59], v[216:219], v[36:39]
 ds_read_b64_tr_b16 a[112:113], v2 offset:8576
 v_mul_f32 v31, s46, v31
 v_mfma_f32_16x16x32_bf16 v[36:39], a[60:63], v[220:223], v[36:39]
 v_exp_f32 v44, v44
 v_mfma_f32_16x16x32_bf16 v[40:43], a[32:35], a[164:167], 0
 v_exp_f32 v45, v45
 v_mfma_f32_16x16x32_bf16 v[40:43], a[36:39], a[168:171], v[40:43]
 ds_read_b64_tr_b16 a[114:115], v2 offset:9088
 v_cvt_pk_bf16_f32 v62, v44, v45
 v_mfma_f32_16x16x32_bf16 v[40:43], a[40:43], a[172:175], v[40:43]
 v_exp_f32 v46, v46
 v_exp_f32 v47, v47
 v_mfma_f32_16x16x32_bf16 v[40:43], a[44:47], a[176:179], v[40:43]
 ds_read_b64_tr_b16 a[84:85], v2 offset:136
 v_cvt_pk_bf16_f32 v63, v46, v47
 v_mfma_f32_16x16x32_bf16 v[44:47], a[48:51], a[164:167], 0
 v_exp_f32 v16, v16
 v_mfma_f32_16x16x32_bf16 v[44:47], a[52:55], a[168:171], v[44:47]
 v_exp_f32 v17, v17
 v_mfma_f32_16x16x32_bf16 v[44:47], a[56:59], a[172:175], v[44:47]
 ds_read_b64_tr_b16 a[86:87], v2 offset:648
 v_cvt_pk_bf16_f32 v64, v16, v17
 v_mfma_f32_16x16x32_bf16 v[44:47], a[60:63], a[176:179], v[44:47]
 ds_read_b64_tr_b16 a[116:117], v2 offset:8584
 v_mul_f32 v40, s46, v40
 v_smfmac_f32_16x16x64_bf16 a[132:135], a[128:131], v[48:55], v242
 ds_read_b64_tr_b16 a[118:119], v2 offset:9096
 v_smfmac_f32_16x16x64_bf16 a[136:139], a[128:131], v[56:63], v242
 s_waitcnt lgkmcnt(14)
 ds_read_b64_tr_b16 a[88:89], v2 offset:192
 v_mfma_f32_16x16x32_bf16 v[80:83], a[64:67], v[48:51], v[80:83]
 ds_read_b64_tr_b16 a[90:91], v2 offset:704
 v_mul_f32 v41, s46, v41
 v_mfma_f32_16x16x32_bf16 v[80:83], a[96:99], v[52:55], v[80:83]
 ds_read_b64_tr_b16 a[120:121], v2 offset:8640
 v_mul_f32 v42, s46, v42
 v_mfma_f32_16x16x32_bf16 v[112:115], a[64:67], v[56:59], v[112:115]
 ds_read_b64_tr_b16 a[122:123], v2 offset:9152
 v_mul_f32 v43, s46, v43
 v_mfma_f32_16x16x32_bf16 v[112:115], a[96:99], v[60:63], v[112:115]
 ds_read_b64_tr_b16 a[92:93], v2 offset:200
 v_mul_f32 v44, s46, v44
 v_mfma_f32_16x16x32_bf16 v[84:87], a[68:71], v[48:51], v[84:87]
 ds_read_b64_tr_b16 a[94:95], v2 offset:712
 v_mul_f32 v45, s46, v45
 v_mfma_f32_16x16x32_bf16 v[84:87], a[100:103], v[52:55], v[84:87]
 ds_read_b64_tr_b16 a[124:125], v2 offset:8648
 v_mul_f32 v46, s46, v46
 v_mfma_f32_16x16x32_bf16 v[116:119], a[68:71], v[56:59], v[116:119]
 ds_read_b64_tr_b16 a[126:127], v2 offset:9160
 v_mul_f32 v47, s46, v47
 v_mfma_f32_16x16x32_bf16 v[116:119], a[100:103], v[60:63], v[116:119]
 s_waitcnt lgkmcnt(14)
 v_exp_f32 v18, v18
 v_mfma_f32_16x16x32_bf16 v[88:91], a[72:75], v[48:51], v[88:91]
 v_exp_f32 v19, v19
 v_mfma_f32_16x16x32_bf16 v[88:91], a[104:107], v[52:55], v[88:91]
 v_exp_f32 v20, v20
 v_mfma_f32_16x16x32_bf16 v[120:123], a[72:75], v[56:59], v[120:123]
 v_exp_f32 v21, v21
 v_mfma_f32_16x16x32_bf16 v[120:123], a[104:107], v[60:63], v[120:123]
 v_exp_f32 v22, v22
 v_mfma_f32_16x16x32_bf16 v[92:95], a[76:79], v[48:51], v[92:95]
 v_exp_f32 v23, v23
 v_mfma_f32_16x16x32_bf16 v[92:95], a[108:111], v[52:55], v[92:95]
 v_exp_f32 v24, v24
 v_mfma_f32_16x16x32_bf16 v[124:127], a[76:79], v[56:59], v[124:127]
 v_exp_f32 v25, v25
 v_mfma_f32_16x16x32_bf16 v[124:127], a[108:111], v[60:63], v[124:127]
 s_waitcnt lgkmcnt(8)
 v_exp_f32 v26, v26
 v_mfma_f32_16x16x32_bf16 v[96:99], a[80:83], v[48:51], v[96:99]
 v_exp_f32 v27, v27
 v_mfma_f32_16x16x32_bf16 v[96:99], a[112:115], v[52:55], v[96:99]
 v_exp_f32 v28, v28
 v_mfma_f32_16x16x32_bf16 v[128:131], a[80:83], v[56:59], v[128:131]
 v_exp_f32 v29, v29
 v_mfma_f32_16x16x32_bf16 v[128:131], a[112:115], v[60:63], v[128:131]
 v_exp_f32 v30, v30
 v_mfma_f32_16x16x32_bf16 v[100:103], a[84:87], v[48:51], v[100:103]
 v_exp_f32 v31, v31
 v_mfma_f32_16x16x32_bf16 v[100:103], a[116:119], v[52:55], v[100:103]
 v_exp_f32 v32, v32
 v_mfma_f32_16x16x32_bf16 v[132:135], a[84:87], v[56:59], v[132:135]
 v_exp_f32 v33, v33
 v_mfma_f32_16x16x32_bf16 v[132:135], a[116:119], v[60:63], v[132:135]
 s_waitcnt lgkmcnt(0)
 v_exp_f32 v34, v34
 v_mfma_f32_16x16x32_bf16 v[104:107], a[88:91], v[48:51], v[104:107]
 s_waitcnt vmcnt(2) lgkmcnt(0)
 s_barrier
 v_mfma_f32_16x16x32_bf16 v[104:107], a[120:123], v[52:55], v[104:107]
 ds_read_b64_tr_b16 a[196:197], v2 offset:16896
 v_cvt_pk_bf16_f32 v65, v18, v19
 v_mfma_f32_16x16x32_bf16 v[136:139], a[88:91], v[56:59], v[136:139]
 ds_read_b64_tr_b16 a[198:199], v2 offset:17408
 v_cvt_pk_bf16_f32 v66, v20, v21
 v_mfma_f32_16x16x32_bf16 v[136:139], a[120:123], v[60:63], v[136:139]
 ds_read_b64_tr_b16 a[228:229], v2 offset:25344
 v_cvt_pk_bf16_f32 v67, v22, v23
 v_mfma_f32_16x16x32_bf16 v[108:111], a[92:95], v[48:51], v[108:111]
 ds_read_b64_tr_b16 a[230:231], v2 offset:25856
 v_cvt_pk_bf16_f32 v72, v24, v25
 v_mfma_f32_16x16x32_bf16 v[108:111], a[124:127], v[52:55], v[108:111]
 ds_read_b64_tr_b16 a[200:201], v2 offset:16904
 v_cvt_pk_bf16_f32 v73, v26, v27
 v_mfma_f32_16x16x32_bf16 v[140:143], a[92:95], v[56:59], v[140:143]
 ds_read_b64_tr_b16 a[202:203], v2 offset:17416
 v_cvt_pk_bf16_f32 v74, v28, v29
 v_mfma_f32_16x16x32_bf16 v[140:143], a[124:127], v[60:63], v[140:143]
 ds_read_b64_tr_b16 a[232:233], v2 offset:25352
 v_cvt_pk_bf16_f32 v75, v30, v31
 v_mfma_f32_16x16x32_bf16 v[16:19], a[0:3], v[224:227], 0
 ds_read_b64_tr_b16 a[234:235], v2 offset:25864
 v_cvt_pk_bf16_f32 v68, v32, v33
 v_mfma_f32_16x16x32_bf16 v[16:19], a[4:7], v[228:231], v[16:19]
 v_exp_f32 v35, v35
 v_mfma_f32_16x16x32_bf16 v[16:19], a[8:11], v[232:235], v[16:19]
 ds_read_b64_tr_b16 a[204:205], v2 offset:16960
 v_cvt_pk_bf16_f32 v69, v34, v35
 v_mfma_f32_16x16x32_bf16 v[16:19], a[12:15], v[236:239], v[16:19]
 v_exp_f32 v36, v36
 v_mfma_f32_16x16x32_bf16 v[20:23], a[16:19], v[224:227], 0
 v_exp_f32 v37, v37
 v_mfma_f32_16x16x32_bf16 v[20:23], a[20:23], v[228:231], v[20:23]
 ds_read_b64_tr_b16 a[206:207], v2 offset:17472
 v_cvt_pk_bf16_f32 v70, v36, v37
 v_mfma_f32_16x16x32_bf16 v[20:23], a[24:27], v[232:235], v[20:23]
 v_exp_f32 v38, v38
 v_mfma_f32_16x16x32_bf16 v[20:23], a[28:31], v[236:239], v[20:23]
 v_exp_f32 v39, v39
 v_mfma_f32_16x16x32_bf16 v[24:27], a[0:3], a[180:183], 0
 ds_read_b64_tr_b16 a[236:237], v2 offset:25408
 v_cvt_pk_bf16_f32 v71, v38, v39
 v_mfma_f32_16x16x32_bf16 v[24:27], a[4:7], a[184:187], v[24:27]
 v_exp_f32 v40, v40
 v_mfma_f32_16x16x32_bf16 v[24:27], a[8:11], a[188:191], v[24:27]
 v_exp_f32 v41, v41
 v_mfma_f32_16x16x32_bf16 v[24:27], a[12:15], a[192:195], v[24:27]
 ds_read_b64_tr_b16 a[238:239], v2 offset:25920
 v_cvt_pk_bf16_f32 v76, v40, v41
 v_mfma_f32_16x16x32_bf16 v[28:31], a[16:19], a[180:183], 0
 v_exp_f32 v42, v42
 v_mfma_f32_16x16x32_bf16 v[28:31], a[20:23], a[184:187], v[28:31]
 v_exp_f32 v43, v43
 v_mfma_f32_16x16x32_bf16 v[28:31], a[24:27], a[188:191], v[28:31]
 ds_read_b64_tr_b16 a[208:209], v2 offset:16968
 v_cvt_pk_bf16_f32 v77, v42, v43
 v_mfma_f32_16x16x32_bf16 v[28:31], a[28:31], a[192:195], v[28:31]
 ds_read_b64_tr_b16 a[210:211], v2 offset:17480
 v_mul_f32 v24, s46, v24
 v_mfma_f32_16x16x32_bf16 v[32:35], a[32:35], v[224:227], 0
 ds_read_b64_tr_b16 a[240:241], v2 offset:25416
 v_mul_f32 v25, s46, v25
 v_mfma_f32_16x16x32_bf16 v[32:35], a[36:39], v[228:231], v[32:35]
 ds_read_b64_tr_b16 a[242:243], v2 offset:25928
 v_mul_f32_e64 v26, s46, v26
 v_mfma_f32_16x16x32_bf16 v[32:35], a[40:43], v[232:235], v[32:35]
 ds_read_b64_tr_b16 a[212:213], v2 offset:17024
 v_mul_f32_e64 v27, s46, v27
 v_mfma_f32_16x16x32_bf16 v[32:35], a[44:47], v[236:239], v[32:35]
 s_cmp_lg_u32 s2, s2
L_pad7:
 s_cbranch_scc1 L_p1
 ds_read_b64_tr_b16 a[214:215], v2 offset:17536
 v_mul_f32 v28, s46, v28
 v_mfma_f32_16x16x32_bf16 v[36:39], a[48:51], v[224:227], 0
 ds_read_b64_tr_b16 a[244:245], v2 offset:25472
 v_mul_f32 v29, s46, v29
 v_mfma_f32_16x16x32_bf16 v[36:39], a[52:55], v[228:231], v[36:39]
 ds_read_b64_tr_b16 a[246:247], v2 offset:25984
 v_mul_f32 v30, s46, v30
 v_mfma_f32_16x16x32_bf16 v[36:39], a[56:59], v[232:235], v[36:39]
 ds_read_b64_tr_b16 a[216:217], v2 offset:17032
 v_mul_f32 v31, s46, v31
 v_mfma_f32_16x16x32_bf16 v[36:39], a[60:63], v[236:239], v[36:39]
 v_exp_f32 v44, v44
 v_mfma_f32_16x16x32_bf16 v[40:43], a[32:35], a[180:183], 0
 v_exp_f32 v45, v45
 v_mfma_f32_16x16x32_bf16 v[40:43], a[36:39], a[184:187], v[40:43]
 ds_read_b64_tr_b16 a[218:219], v2 offset:17544
 v_cvt_pk_bf16_f32 v78, v44, v45
 v_mfma_f32_16x16x32_bf16 v[40:43], a[40:43], a[188:191], v[40:43]
 v_exp_f32 v46, v46
 v_exp_f32 v47, v47
 v_mfma_f32_16x16x32_bf16 v[40:43], a[44:47], a[192:195], v[40:43]
 ds_read_b64_tr_b16 a[248:249], v2 offset:25480
 v_cvt_pk_bf16_f32 v79, v46, v47
 v_mfma_f32_16x16x32_bf16 v[44:47], a[48:51], a[180:183], 0
 v_exp_f32 v16, v16
 v_mfma_f32_16x16x32_bf16 v[44:47], a[52:55], a[184:187], v[44:47]
 v_exp_f32 v17, v17
 v_mfma_f32_16x16x32_bf16 v[44:47], a[56:59], a[188:191], v[44:47]
 ds_read_b64_tr_b16 a[250:251], v2 offset:25992
 v_cvt_pk_bf16_f32 v48, v16, v17
 v_mfma_f32_16x16x32_bf16 v[44:47], a[60:63], a[192:195], v[44:47]
 ds_read_b128 a[0:3], v1 offset:0
 v_mul_f32 v40, s46, v40
 v_smfmac_f32_16x16x64_bf16 a[132:135], a[128:131], v[64:71], v242
 ds_read_b64_tr_b16 a[220:221], v2 offset:17088
 v_smfmac_f32_16x16x64_bf16 a[136:139], a[128:131], v[72:79], v242
 s_waitcnt lgkmcnt(14)
 ds_read_b128 a[4:7], v1 offset:64
 v_mfma_f32_16x16x32_bf16 v[80:83], a[196:199], v[64:67], v[80:83]
 ds_read_b64_tr_b16 a[222:223], v2 offset:17600
 v_mul_f32 v41, s46, v41
 v_mfma_f32_16x16x32_bf16 v[80:83], a[228:231], v[68:71], v[80:83]
 ds_read_b64_tr_b16 a[252:253], v2 offset:25536
 v_mul_f32 v42, s46, v42
 v_mfma_f32_16x16x32_bf16 v[112:115], a[196:199], v[72:75], v[112:115]
 ds_read_b64_tr_b16 a[254:255], v2 offset:26048
 v_mul_f32 v43, s46, v43
 v_mfma_f32_16x16x32_bf16 v[112:115], a[228:231], v[76:79], v[112:115]
 ds_read_b128 a[8:11], v1 offset:128
 v_mul_f32 v44, s46, v44
 v_mfma_f32_16x16x32_bf16 v[84:87], a[200:203], v[64:67], v[84:87]
 ds_read_b64_tr_b16 a[224:225], v2 offset:17096
 v_mul_f32 v45, s46, v45
 v_mfma_f32_16x16x32_bf16 v[84:87], a[232:235], v[68:71], v[84:87]
 ds_read_b128 a[12:15], v1 offset:192
 v_mul_f32 v46, s46, v46
 v_mfma_f32_16x16x32_bf16 v[116:119], a[200:203], v[72:75], v[116:119]
 ds_read_b64_tr_b16 a[226:227], v2 offset:17608
 v_mul_f32 v47, s46, v47
 v_mfma_f32_16x16x32_bf16 v[116:119], a[232:235], v[76:79], v[116:119]
 s_waitcnt lgkmcnt(14)
 v_exp_f32 v18, v18
 v_mfma_f32_16x16x32_bf16 v[88:91], a[204:207], v[64:67], v[88:91]
 v_exp_f32 v19, v19
 v_mfma_f32_16x16x32_bf16 v[88:91], a[236:239], v[68:71], v[88:91]
 ds_read_b64_tr_b16 v[244:245], v2 offset:25544
 v_cvt_pk_bf16_f32 v49, v18, v19
 v_mfma_f32_16x16x32_bf16 v[120:123], a[204:207], v[72:75], v[120:123]
 v_exp_f32 v20, v20
 v_mfma_f32_16x16x32_bf16 v[120:123], a[236:239], v[76:79], v[120:123]
 v_exp_f32 v21, v21
 v_mfma_f32_16x16x32_bf16 v[92:95], a[208:211], v[64:67], v[92:95]
 v_accvgpr_read_b32 v9, a132
 v_accvgpr_read_b32 v8, a133
 v_add_f32 v9, v9, v8
 v_accvgpr_read_b32 v11, a136
 v_accvgpr_read_b32 v10, a137
 v_add_f32 v11, v11, v10
 v_rcp_f32 v8, v9
 v_rcp_f32 v10, v11
 v_accvgpr_write_b32 a132, 0
 v_accvgpr_write_b32 a133, 0
 v_subrev_u32 v9, s30, v9
 v_cmp_lt_u32 s[50:51], s31, v9
 s_or_b64 s[28:29], s[28:29], s[50:51]
 v_accvgpr_write_b32 a136, 0
 v_accvgpr_write_b32 a137, 0
 v_subrev_u32_e64 v11, s30, v11
 v_cmp_lt_u32 s[50:51], s31, v11
 s_or_b64 s[28:29], s[28:29], s[50:51]
 v_pk_mul_f32 v[80:81], v[80:81], v[8:9] op_sel_hi:[1,0]
 v_pk_mul_f32 v[82:83], v[82:83], v[8:9] op_sel_hi:[1,0]
 v_pk_mul_f32 v[84:85], v[84:85], v[8:9] op_sel_hi:[1,0]
 v_pk_mul_f32 v[86:87], v[86:87], v[8:9] op_sel_hi:[1,0]
 v_pk_mul_f32 v[112:113], v[112:113], v[10:11] op_sel_hi:[1,0]
 v_pk_mul_f32 v[114:115], v[114:115], v[10:11] op_sel_hi:[1,0]
 v_pk_mul_f32 v[116:117], v[116:117], v[10:11] op_sel_hi:[1,0]
 v_pk_mul_f32 v[118:119], v[118:119], v[10:11] op_sel_hi:[1,0]
 v_cvt_pk_bf16_f32 v80, v80, v81
 v_cvt_pk_bf16_f32 v81, v82, v83
 v_cvt_pk_bf16_f32 v82, v84, v85
 v_cvt_pk_bf16_f32 v83, v86, v87
 v_cvt_pk_bf16_f32 v112, v112, v113
 v_cvt_pk_bf16_f32 v113, v114, v115
 v_cvt_pk_bf16_f32 v114, v116, v117
 v_cvt_pk_bf16_f32 v115, v118, v119
 v_mfma_f32_16x16x32_bf16 v[92:95], a[240:243], v[68:71], v[92:95]
 ds_write_b128 v6, v[80:83] offset:0
 v_mfma_f32_16x16x32_bf16 v[124:127], a[208:211], v[72:75], v[124:127]
 v_exp_f32 v22, v22
 v_mfma_f32_16x16x32_bf16 v[124:127], a[240:243], v[76:79], v[124:127]
 s_waitcnt lgkmcnt(12)
 ds_read_b64_tr_b16 v[246:247], v2 offset:26056
 v_cvt_pk_bf16_f32 v50, v20, v21
 v_mfma_f32_16x16x32_bf16 v[96:99], a[212:215], v[64:67], v[96:99]
 v_exp_f32 v23, v23
 v_mfma_f32_16x16x32_bf16 v[96:99], a[244:247], v[68:71], v[96:99]
 ds_read_b128 a[16:19], v1 offset:512
 v_cvt_pk_bf16_f32 v51, v22, v23
 v_mfma_f32_16x16x32_bf16 v[128:131], a[212:215], v[72:75], v[128:131]
 ds_read_b128 a[32:35], v1 offset:8448
 v_mfma_f32_16x16x32_bf16 v[128:131], a[244:247], v[76:79], v[128:131]
 v_exp_f32 v32, v32
 v_mfma_f32_16x16x32_bf16 v[100:103], a[216:219], v[64:67], v[100:103]
 ds_read_b128 a[20:23], v1 offset:576
 ds_read_b128 a[36:39], v1 offset:8512
 v_mfma_f32_16x16x32_bf16 v[100:103], a[248:251], v[68:71], v[100:103]
 ds_write_b128 v6, v[112:115] offset:512
 v_pk_mul_f32 v[88:89], v[88:89], v[8:9] op_sel_hi:[1,0]
 v_pk_mul_f32 v[90:91], v[90:91], v[8:9] op_sel_hi:[1,0]
 v_pk_mul_f32 v[92:93], v[92:93], v[8:9] op_sel_hi:[1,0]
 v_pk_mul_f32 v[94:95], v[94:95], v[8:9] op_sel_hi:[1,0]
 v_pk_mul_f32 v[120:121], v[120:121], v[10:11] op_sel_hi:[1,0]
 v_pk_mul_f32 v[122:123], v[122:123], v[10:11] op_sel_hi:[1,0]
 v_pk_mul_f32 v[124:125], v[124:125], v[10:11] op_sel_hi:[1,0]
 v_pk_mul_f32 v[126:127], v[126:127], v[10:11] op_sel_hi:[1,0]
 v_cvt_pk_bf16_f32 v88, v88, v89
 v_cvt_pk_bf16_f32 v89, v90, v91
 v_cvt_pk_bf16_f32 v90, v92, v93
 v_cvt_pk_bf16_f32 v91, v94, v95
 v_cvt_pk_bf16_f32 v120, v120, v121
 v_cvt_pk_bf16_f32 v121, v122, v123
 v_cvt_pk_bf16_f32 v122, v124, v125
 v_cvt_pk_bf16_f32 v123, v126, v127
 v_mfma_f32_16x16x32_bf16 v[132:135], a[216:219], v[72:75], v[132:135]
 ds_read_b128 a[24:27], v1 offset:640
 ds_read_b128 a[40:43], v1 offset:8576
 v_mfma_f32_16x16x32_bf16 v[132:135], a[248:251], v[76:79], v[132:135]
 s_waitcnt lgkmcnt(7)
 ds_write_b128 v6, v[88:91] offset:64
 v_mfma_f32_16x16x32_bf16 v[104:107], a[220:223], v[64:67], v[104:107]
 ds_read_b128 a[28:31], v1 offset:704
 ds_read_b128 a[44:47], v1 offset:8640
 v_mfma_f32_16x16x32_bf16 v[104:107], a[252:255], v[68:71], v[104:107]
 v_exp_f32 v33, v33
 v_mfma_f32_16x16x32_bf16 v[136:139], a[220:223], v[72:75], v[136:139]
 ds_read_b128 a[48:51], v1 offset:8960
 v_cvt_pk_bf16_f32 v52, v32, v33
 v_mfma_f32_16x16x32_bf16 v[136:139], a[252:255], v[76:79], v[136:139]
 v_exp_f32_e64 v34, v34
 v_mfma_f32_16x16x32_bf16 v[108:111], a[224:227], v[64:67], v[108:111]
 ds_read_b128 a[52:55], v1 offset:9024
 ds_write_b128 v6, v[120:123] offset:576
 v_pk_mul_f32 v[96:97], v[96:97], v[8:9] op_sel_hi:[1,0]
 v_pk_mul_f32 v[98:99], v[98:99], v[8:9] op_sel_hi:[1,0]
 v_pk_mul_f32 v[100:101], v[100:101], v[8:9] op_sel_hi:[1,0]
 v_pk_mul_f32 v[102:103], v[102:103], v[8:9] op_sel_hi:[1,0]
 v_pk_mul_f32 v[128:129], v[128:129], v[10:11] op_sel_hi:[1,0]
 v_pk_mul_f32 v[130:131], v[130:131], v[10:11] op_sel_hi:[1,0]
 v_pk_mul_f32 v[132:133], v[132:133], v[10:11] op_sel_hi:[1,0]
 v_pk_mul_f32 v[134:135], v[134:135], v[10:11] op_sel_hi:[1,0]
 v_cvt_pk_bf16_f32 v96, v96, v97
 v_cvt_pk_bf16_f32 v97, v98, v99
 v_cvt_pk_bf16_f32 v98, v100, v101
 v_cvt_pk_bf16_f32 v99, v102, v103
 v_cvt_pk_bf16_f32 v128, v128, v129
 v_cvt_pk_bf16_f32 v129, v130, v131
 v_cvt_pk_bf16_f32 v130, v132, v133
 v_cvt_pk_bf16_f32 v131, v134, v135
 v_mfma_f32_16x16x32_bf16 v[108:111], v[244:247], v[68:71], v[108:111]
 ds_write_b128 v6, v[96:99] offset:128
 v_mfma_f32_16x16x32_bf16 v[140:143], a[224:227], v[72:75], v[140:143]
 ds_read_b128 a[56:59], v1 offset:9088
 v_mfma_f32_16x16x32_bf16 v[140:143], v[244:247], v[76:79], v[140:143]
 v_exp_f32 v35, v35
 v_mfma_f32_16x16x32_bf16 v[16:19], a[0:3], v[224:227], 0
 ds_read_b128 a[60:63], v1 offset:9152
 v_cvt_pk_bf16_f32 v53, v34, v35
 v_mfma_f32_16x16x32_bf16 v[16:19], a[4:7], v[228:231], v[16:19]
 v_exp_f32 v36, v36
 v_mfma_f32_16x16x32_bf16 v[16:19], a[8:11], v[232:235], v[16:19]
 s_waitcnt lgkmcnt(7)
 v_exp_f32 v37, v37
 v_mfma_f32_16x16x32_bf16 v[16:19], a[12:15], v[236:239], v[16:19]
 v_exp_f32_e64 v38, v38
 v_mfma_f32_16x16x32_bf16 v[20:23], a[16:19], v[224:227], 0
 ds_write_b128 v6, v[128:131] offset:640
 v_pk_mul_f32 v[104:105], v[104:105], v[8:9] op_sel_hi:[1,0]
 v_pk_mul_f32 v[106:107], v[106:107], v[8:9] op_sel_hi:[1,0]
 v_pk_mul_f32 v[108:109], v[108:109], v[8:9] op_sel_hi:[1,0]
 v_pk_mul_f32 v[110:111], v[110:111], v[8:9] op_sel_hi:[1,0]
 v_pk_mul_f32 v[136:137], v[136:137], v[10:11] op_sel_hi:[1,0]
 v_pk_mul_f32 v[138:139], v[138:139], v[10:11] op_sel_hi:[1,0]
 v_pk_mul_f32 v[140:141], v[140:141], v[10:11] op_sel_hi:[1,0]
 v_pk_mul_f32 v[142:143], v[142:143], v[10:11] op_sel_hi:[1,0]
 v_cvt_pk_bf16_f32 v104, v104, v105
 v_cvt_pk_bf16_f32 v105, v106, v107
 v_cvt_pk_bf16_f32 v106, v108, v109
 v_cvt_pk_bf16_f32 v107, v110, v111
 v_cvt_pk_bf16_f32 v136, v136, v137
 v_cvt_pk_bf16_f32 v137, v138, v139
 v_cvt_pk_bf16_f32 v138, v140, v141
 v_cvt_pk_bf16_f32 v139, v142, v143
 v_mfma_f32_16x16x32_bf16 v[20:23], a[20:23], v[228:231], v[20:23]
 ds_write_b128 v6, v[104:107] offset:192
 v_mfma_f32_16x16x32_bf16 v[20:23], a[24:27], v[232:235], v[20:23]
 s_waitcnt lgkmcnt(8)
 v_exp_f32 v39, v39
 v_mfma_f32_16x16x32_bf16 v[20:23], a[28:31], v[236:239], v[20:23]
 ds_write_b128 v6, v[136:139] offset:704
 v_mfma_f32_16x16x32_bf16 v[32:35], a[32:35], v[224:227], 0
 v_exp_f32 v24, v24
 v_mfma_f32_16x16x32_bf16 v[32:35], a[36:39], v[228:231], v[32:35]
 ds_read_b128 a[148:151], v7 offset:0
 v_cvt_pk_bf16_f32 v54, v36, v37
 v_mfma_f32_16x16x32_bf16 v[32:35], a[40:43], v[232:235], v[32:35]
 s_waitcnt lgkmcnt(4)
 v_exp_f32 v25, v25
 v_mfma_f32_16x16x32_bf16 v[32:35], a[44:47], v[236:239], v[32:35]
 v_cvt_pk_bf16_f32 v55, v38, v39
 v_cvt_pk_bf16_f32 v56, v24, v25
 v_mfma_f32_16x16x32_bf16 v[36:39], a[48:51], v[224:227], 0
 v_exp_f32 v26, v26
 v_mfma_f32_16x16x32_bf16 v[36:39], a[52:55], v[228:231], v[36:39]
 v_exp_f32 v27, v27
 v_mfma_f32_16x16x32_bf16 v[36:39], a[56:59], v[232:235], v[36:39]
 ds_read_b128 a[152:155], v7 offset:1056
 v_cvt_pk_bf16_f32 v57, v26, v27
 v_mfma_f32_16x16x32_bf16 v[36:39], a[60:63], v[236:239], v[36:39]
 v_exp_f32 v28, v28
 v_mfma_f32_16x16x32_bf16 v[24:27], a[0:3], a[180:183], 0
 v_exp_f32 v29, v29
 v_mfma_f32_16x16x32_bf16 v[24:27], a[4:7], a[184:187], v[24:27]
 ds_read_b128 a[156:159], v7 offset:2112
 v_cvt_pk_bf16_f32 v58, v28, v29
 v_mfma_f32_16x16x32_bf16 v[24:27], a[8:11], a[188:191], v[24:27]
 v_exp_f32 v30, v30
 v_exp_f32 v31, v31
 v_mfma_f32_16x16x32_bf16 v[24:27], a[12:15], a[192:195], v[24:27]
 v_cvt_pk_bf16_f32 v59, v30, v31
 v_mfma_f32_16x16x32_bf16 v[28:31], a[16:19], a[180:183], 0
 v_exp_f32 v40, v40
 v_mfma_f32_16x16x32_bf16 v[28:31], a[20:23], a[184:187], v[28:31]
 s_waitcnt lgkmcnt(2)
 v_exp_f32 v41, v41
 v_mfma_f32_16x16x32_bf16 v[28:31], a[24:27], a[188:191], v[28:31]
 buffer_store_dwordx4 a[148:151], v5, s[16:19], 0 offen sc0 sc1
 v_exp_f32 v42, v42
 v_exp_f32 v43, v43
 v_mfma_f32_16x16x32_bf16 v[28:31], a[28:31], a[192:195], v[28:31]
 v_cvt_pk_bf16_f32 v60, v40, v41
 v_cvt_pk_bf16_f32 v61, v42, v43
 v_mfma_f32_16x16x32_bf16 v[40:43], a[32:35], a[180:183], 0
 ds_read_b128 a[160:163], v7 offset:3168
 v_mul_f32 v24, s46, v24
 v_mfma_f32_16x16x32_bf16 v[40:43], a[36:39], a[184:187], v[40:43]
 v_exp_f32 v44, v44
 v_mfma_f32_16x16x32_bf16 v[40:43], a[40:43], a[188:191], v[40:43]
 s_waitcnt lgkmcnt(2)
 v_exp_f32 v45, v45
 v_exp_f32 v46, v46
 v_exp_f32 v47, v47
 v_mfma_f32_16x16x32_bf16 v[40:43], a[44:47], a[192:195], v[40:43]
 buffer_store_dwordx4 a[152:155], v5, s[16:19], 0 offen offset:256 sc0 sc1
 v_cvt_pk_bf16_f32 v62, v44, v45
 v_cvt_pk_bf16_f32 v63, v46, v47
 v_mul_f32 v25, s46, v25
 v_mfma_f32_16x16x32_bf16 v[44:47], a[48:51], a[180:183], 0
 ds_read_b128 a[148:151], v7 offset:4240
 v_mul_f32 v26, s46, v26
 v_mfma_f32_16x16x32_bf16 v[44:47], a[52:55], a[184:187], v[44:47]
 v_exp_f32 v16, v16
 v_mfma_f32_16x16x32_bf16 v[44:47], a[56:59], a[188:191], v[44:47]
 v_exp_f32 v17, v17
 v_mfma_f32_16x16x32_bf16 v[44:47], a[60:63], a[192:195], v[44:47]
 s_waitcnt lgkmcnt(2)
 v_exp_f32 v18, v18
 v_smfmac_f32_16x16x64_bf16 a[140:143], a[128:131], v[48:55], v242
 buffer_store_dwordx4 a[156:159], v5, s[16:19], 0 offen offset:512 sc0 sc1
 ds_read_b128 a[152:155], v7 offset:5296
 v_cvt_pk_bf16_f32 v64, v16, v17
 v_smfmac_f32_16x16x64_bf16 a[144:147], a[128:131], v[56:63], v242
 v_mul_f32 v27, s46, v27
 v_mfma_f32_16x16x32_bf16 v[144:147], a[196:199], v[48:51], v[144:147]
 v_exp_f32 v19, v19
 v_mfma_f32_16x16x32_bf16 v[144:147], a[228:231], v[52:55], v[144:147]
 v_exp_f32 v20, v20
 v_mfma_f32_16x16x32_bf16 v[176:179], a[196:199], v[56:59], v[176:179]
 s_waitcnt lgkmcnt(2)
 v_exp_f32 v21, v21
 v_mfma_f32_16x16x32_bf16 v[176:179], a[228:231], v[60:63], v[176:179]
 buffer_store_dwordx4 a[160:163], v5, s[16:19], 0 offen offset:768 sc0 sc1
 ds_read_b128 a[156:159], v7 offset:6352
 v_exp_f32 v22, v22
 v_mfma_f32_16x16x32_bf16 v[148:151], a[200:203], v[48:51], v[148:151]
 v_exp_f32 v23, v23
 v_mfma_f32_16x16x32_bf16 v[148:151], a[232:235], v[52:55], v[148:151]
 v_exp_f32 v32, v32
 v_mfma_f32_16x16x32_bf16 v[180:183], a[200:203], v[56:59], v[180:183]
 v_exp_f32 v33, v33
 v_mfma_f32_16x16x32_bf16 v[180:183], a[232:235], v[60:63], v[180:183]
 s_waitcnt lgkmcnt(2)
 v_exp_f32 v34, v34
 v_mfma_f32_16x16x32_bf16 v[152:155], a[204:207], v[48:51], v[152:155]
 buffer_store_dwordx4 a[148:151], v5, s[16:19], 0 offen offset:1024 sc0 sc1
 ds_read_b128 a[160:163], v7 offset:7408
 v_exp_f32 v35, v35
 v_mfma_f32_16x16x32_bf16 v[152:155], a[236:239], v[52:55], v[152:155]
 v_exp_f32 v36, v36
 v_mfma_f32_16x16x32_bf16 v[184:187], a[204:207], v[56:59], v[184:187]
 v_exp_f32 v37, v37
 v_mfma_f32_16x16x32_bf16 v[184:187], a[236:239], v[60:63], v[184:187]
 v_exp_f32 v38, v38
 v_mfma_f32_16x16x32_bf16 v[156:159], a[208:211], v[48:51], v[156:159]
 s_waitcnt lgkmcnt(2)
 v_exp_f32 v39, v39
 v_mfma_f32_16x16x32_bf16 v[156:159], a[240:243], v[52:55], v[156:159]
 buffer_store_dwordx4 a[152:155], v5, s[16:19], 0 offen offset:1280 sc0 sc1
 v_exp_f32 v24, v24
 v_cvt_pk_bf16_f32 v65, v18, v19
 v_mfma_f32_16x16x32_bf16 v[188:191], a[208:211], v[56:59], v[188:191]
 v_exp_f32 v25, v25
 v_mfma_f32_16x16x32_bf16 v[188:191], a[240:243], v[60:63], v[188:191]
 v_exp_f32 v26, v26
 v_mfma_f32_16x16x32_bf16 v[160:163], a[212:215], v[48:51], v[160:163]
 v_exp_f32 v27, v27
 v_mfma_f32_16x16x32_bf16 v[160:163], a[244:247], v[52:55], v[160:163]
 s_waitcnt lgkmcnt(1)
 v_cvt_pk_bf16_f32 v66, v20, v21
 v_cvt_pk_bf16_f32 v67, v22, v23
 v_mfma_f32_16x16x32_bf16 v[192:195], a[212:215], v[56:59], v[192:195]
 buffer_store_dwordx4 a[156:159], v5, s[16:19], 0 offen offset:1536 sc0 sc1
 v_cvt_pk_bf16_f32 v68, v32, v33
 v_cvt_pk_bf16_f32 v69, v34, v35
 v_cvt_pk_bf16_f32 v70, v36, v37
 v_mfma_f32_16x16x32_bf16 v[192:195], a[244:247], v[60:63], v[192:195]
 v_cvt_pk_bf16_f32 v71, v38, v39
 v_mul_f32 v28, s46, v28
 v_mfma_f32_16x16x32_bf16 v[164:167], a[216:219], v[48:51], v[164:167]
 v_exp_f32 v28, v28
 v_mfma_f32_16x16x32_bf16 v[164:167], a[248:251], v[52:55], v[164:167]
 v_mul_f32 v29, s46, v29
 v_mul_f32 v30, s46, v30
 v_mfma_f32_16x16x32_bf16 v[196:199], a[216:219], v[56:59], v[196:199]
 s_waitcnt lgkmcnt(0)
 v_exp_f32 v29, v29
 v_mfma_f32_16x16x32_bf16 v[196:199], a[248:251], v[60:63], v[196:199]
 buffer_store_dwordx4 a[160:163], v5, s[16:19], 0 offen offset:1792 sc0 sc1
 v_exp_f32 v30, v30
 v_mul_f32 v31, s46, v31
 v_mfma_f32_16x16x32_bf16 v[168:171], a[220:223], v[48:51], v[168:171]
 v_exp_f32 v31, v31
 v_mfma_f32_16x16x32_bf16 v[168:171], a[252:255], v[52:55], v[168:171]
 v_mul_f32 v40, s46, v40
 v_mul_f32 v41, s46, v41
 v_mfma_f32_16x16x32_bf16 v[200:203], a[220:223], v[56:59], v[200:203]
 v_exp_f32 v40, v40
 v_mfma_f32_16x16x32_bf16 v[200:203], a[252:255], v[60:63], v[200:203]
 v_exp_f32 v41, v41
 v_mfma_f32_16x16x32_bf16 v[172:175], a[224:227], v[48:51], v[172:175]
 v_mul_f32 v42, s46, v42
 v_mul_f32 v43, s46, v43
 v_mfma_f32_16x16x32_bf16 v[172:175], v[244:247], v[52:55], v[172:175]
 v_exp_f32 v42, v42
 v_mfma_f32_16x16x32_bf16 v[204:207], a[224:227], v[56:59], v[204:207]
 v_exp_f32 v43, v43
 v_mfma_f32_16x16x32_bf16 v[204:207], v[244:247], v[60:63], v[204:207]
 v_mul_f32 v44, s46, v44
 v_mul_f32 v45, s46, v45
 v_smfmac_f32_16x16x64_bf16 a[140:143], a[128:131], v[64:71], v242
 v_mul_f32 v46, s46, v46
 v_mfma_f32_16x16x32_bf16 v[144:147], a[64:67], v[64:67], v[144:147]
 v_exp_f32 v44, v44
 v_mfma_f32_16x16x32_bf16 v[144:147], a[96:99], v[68:71], v[144:147]
 v_exp_f32 v45, v45
 v_mfma_f32_16x16x32_bf16 v[148:151], a[68:71], v[64:67], v[148:151]
 v_exp_f32 v46, v46
 v_mfma_f32_16x16x32_bf16 v[148:151], a[100:103], v[68:71], v[148:151]
 v_mul_f32 v47, s46, v47
 v_cvt_pk_bf16_f32 v72, v24, v25
 v_mfma_f32_16x16x32_bf16 v[152:155], a[72:75], v[64:67], v[152:155]
 v_exp_f32 v47, v47
 v_mfma_f32_16x16x32_bf16 v[152:155], a[104:107], v[68:71], v[152:155]
 v_accvgpr_read_b32 v9, a140
 v_accvgpr_read_b32 v8, a141
 v_add_f32 v9, v9, v8
 v_rcp_f32 v8, v9
 v_accvgpr_write_b32 a140, 0
 v_accvgpr_write_b32 a141, 0
 v_subrev_u32 v9, s30, v9
 v_cmp_lt_u32 s[50:51], s31, v9
 s_or_b64 s[28:29], s[28:29], s[50:51]
 v_mfma_f32_16x16x32_bf16 v[156:159], a[76:79], v[64:67], v[156:159]
 v_cvt_pk_bf16_f32 v73, v26, v27
 v_cvt_pk_bf16_f32 v74, v28, v29
 v_mfma_f32_16x16x32_bf16 v[156:159], a[108:111], v[68:71], v[156:159]
 v_cvt_pk_bf16_f32 v75, v30, v31
 v_cvt_pk_bf16_f32 v76, v40, v41
 v_mfma_f32_16x16x32_bf16 v[160:163], a[80:83], v[64:67], v[160:163]
 v_cvt_pk_bf16_f32 v77, v42, v43
 v_cvt_pk_bf16_f32 v78, v44, v45
 v_mfma_f32_16x16x32_bf16 v[160:163], a[112:115], v[68:71], v[160:163]
 v_cvt_pk_bf16_f32 v79, v46, v47
 v_mul_f32 v144, v144, v8
 v_mfma_f32_16x16x32_bf16 v[164:167], a[84:87], v[64:67], v[164:167]
 v_mul_f32 v145, v145, v8
 v_mul_f32 v146, v146, v8
 v_mfma_f32_16x16x32_bf16 v[164:167], a[116:119], v[68:71], v[164:167]
 v_mul_f32 v147, v147, v8
 v_mul_f32 v148, v148, v8
 v_mfma_f32_16x16x32_bf16 v[168:171], a[88:91], v[64:67], v[168:171]
 v_mul_f32 v149, v149, v8
 v_mul_f32 v150, v150, v8
 v_mfma_f32_16x16x32_bf16 v[168:171], a[120:123], v[68:71], v[168:171]
 v_mul_f32 v151, v151, v8
 v_cvt_pk_bf16_f32 v144, v144, v145
 v_mfma_f32_16x16x32_bf16 v[172:175], a[92:95], v[64:67], v[172:175]
 v_cvt_pk_bf16_f32 v145, v146, v147
 v_cvt_pk_bf16_f32 v146, v148, v149
 v_mfma_f32_16x16x32_bf16 v[172:175], a[124:127], v[68:71], v[172:175]
 v_cvt_pk_bf16_f32 v147, v150, v151
 v_mul_f32 v152, v152, v8
 v_smfmac_f32_16x16x64_bf16 a[144:147], a[128:131], v[72:79], v242
 v_mul_f32 v153, v153, v8
 v_mfma_f32_16x16x32_bf16 v[176:179], a[64:67], v[72:75], v[176:179]
 v_mul_f32 v154, v154, v8
 v_mul_f32 v155, v155, v8
 v_mfma_f32_16x16x32_bf16 v[176:179], a[96:99], v[76:79], v[176:179]
 v_mul_f32 v156, v156, v8
 v_mul_f32 v157, v157, v8
 v_mfma_f32_16x16x32_bf16 v[180:183], a[68:71], v[72:75], v[180:183]
 v_mul_f32 v158, v158, v8
 v_mul_f32 v159, v159, v8
 v_mfma_f32_16x16x32_bf16 v[180:183], a[100:103], v[76:79], v[180:183]
 v_cvt_pk_bf16_f32 v152, v152, v153
 v_cvt_pk_bf16_f32 v153, v154, v155
 v_mfma_f32_16x16x32_bf16 v[184:187], a[72:75], v[72:75], v[184:187]
 v_cvt_pk_bf16_f32 v154, v156, v157
 v_cvt_pk_bf16_f32 v155, v158, v159
 v_mfma_f32_16x16x32_bf16 v[184:187], a[104:107], v[76:79], v[184:187]
 v_mul_f32 v160, v160, v8
 v_mul_f32 v161, v161, v8
 v_mfma_f32_16x16x32_bf16 v[188:191], a[76:79], v[72:75], v[188:191]
 v_accvgpr_read_b32 v11, a144
 v_accvgpr_read_b32 v10, a145
 v_add_f32 v11, v11, v10
 v_rcp_f32 v10, v11
 v_accvgpr_write_b32 a144, 0
 v_accvgpr_write_b32 a145, 0
 v_subrev_u32 v11, s30, v11
 v_cmp_lt_u32 s[50:51], s31, v11
 s_or_b64 s[28:29], s[28:29], s[50:51]
 v_mfma_f32_16x16x32_bf16 v[188:191], a[108:111], v[76:79], v[188:191]
 v_mul_f32 v162, v162, v8
 v_mul_f32 v163, v163, v8
 v_mfma_f32_16x16x32_bf16 v[192:195], a[80:83], v[72:75], v[192:195]
 v_mul_f32 v164, v164, v8
 v_mul_f32 v165, v165, v8
 v_mfma_f32_16x16x32_bf16 v[192:195], a[112:115], v[76:79], v[192:195]
 v_mul_f32 v166, v166, v8
 v_mul_f32 v167, v167, v8
 v_mfma_f32_16x16x32_bf16 v[196:199], a[84:87], v[72:75], v[196:199]
 v_cvt_pk_bf16_f32 v160, v160, v161
 v_cvt_pk_bf16_f32 v161, v162, v163
 v_mfma_f32_16x16x32_bf16 v[196:199], a[116:119], v[76:79], v[196:199]
 v_cvt_pk_bf16_f32 v162, v164, v165
 v_cvt_pk_bf16_f32 v163, v166, v167
 v_mfma_f32_16x16x32_bf16 v[200:203], a[88:91], v[72:75], v[200:203]
 v_mfma_f32_16x16x32_bf16 v[200:203], a[120:123], v[76:79], v[200:203]
 v_mfma_f32_16x16x32_bf16 v[204:207], a[92:95], v[72:75], v[204:207]
 v_mfma_f32_16x16x32_bf16 v[204:207], a[124:127], v[76:79], v[204:207]
 ds_write_b128 v6, v[144:147] offset:8448
 ds_write_b128 v6, v[152:155] offset:8512
 ds_write_b128 v6, v[160:163] offset:8576
  s_cmp_lg_u64 s[28:29], 0
  s_cselect_b32 s42, 1, 0
  v_mov_b32 v12, s42
  s_lshl_b32 s43, s41, 2
  s_add_u32 s43, s43, 135168
  v_mov_b32 v13, s43
  ds_write_b32 v13, v12
  v_mov_b32 v13, 135168
 v_pk_mul_f32 v[168:169], v[168:169], v[8:9] op_sel_hi:[1,0]
 v_pk_mul_f32 v[170:171], v[170:171], v[8:9] op_sel_hi:[1,0]
 v_pk_mul_f32 v[172:173], v[172:173], v[8:9] op_sel_hi:[1,0]
 v_pk_mul_f32 v[174:175], v[174:175], v[8:9] op_sel_hi:[1,0]
 v_cvt_pk_bf16_f32 v168, v168, v169
 v_cvt_pk_bf16_f32 v169, v170, v171
 v_cvt_pk_bf16_f32 v170, v172, v173
 v_cvt_pk_bf16_f32 v171, v174, v175
 ds_write_b128 v6, v[168:171] offset:8640
 ds_read_b128 a[0:3], v240 offset:8448
 ds_read_b128 a[4:7], v240 offset:10560
 ds_read_b128 a[8:11], v240 offset:12688
 ds_read_b128 a[12:15], v240 offset:14800
 v_pk_mul_f32 v[176:177], v[176:177], v[10:11] op_sel_hi:[1,0]
 v_pk_mul_f32 v[178:179], v[178:179], v[10:11] op_sel_hi:[1,0]
 v_pk_mul_f32 v[180:181], v[180:181], v[10:11] op_sel_hi:[1,0]
 v_pk_mul_f32 v[182:183], v[182:183], v[10:11] op_sel_hi:[1,0]
 v_pk_mul_f32 v[184:185], v[184:185], v[10:11] op_sel_hi:[1,0]
 v_pk_mul_f32 v[186:187], v[186:187], v[10:11] op_sel_hi:[1,0]
 v_pk_mul_f32 v[188:189], v[188:189], v[10:11] op_sel_hi:[1,0]
 v_pk_mul_f32 v[190:191], v[190:191], v[10:11] op_sel_hi:[1,0]
 v_cvt_pk_bf16_f32 v176, v176, v177
 v_cvt_pk_bf16_f32 v177, v178, v179
 v_cvt_pk_bf16_f32 v178, v180, v181
 v_cvt_pk_bf16_f32 v179, v182, v183
 v_cvt_pk_bf16_f32 v184, v184, v185
 v_cvt_pk_bf16_f32 v185, v186, v187
 v_cvt_pk_bf16_f32 v186, v188, v189
 v_cvt_pk_bf16_f32 v187, v190, v191
 s_waitcnt lgkmcnt(3)
 buffer_store_dwordx4 a[0:3], v241, s[16:19], s25 offen sc0 sc1
 s_waitcnt lgkmcnt(2)
 buffer_store_dwordx4 a[4:7], v241, s[16:19], s25 offen offset:512 sc0 sc1
 ds_write_b128 v6, v[176:179] offset:8960
 ds_write_b128 v6, v[184:187] offset:9024
 v_pk_mul_f32 v[192:193], v[192:193], v[10:11] op_sel_hi:[1,0]
 v_pk_mul_f32 v[194:195], v[194:195], v[10:11] op_sel_hi:[1,0]
 v_pk_mul_f32 v[196:197], v[196:197], v[10:11] op_sel_hi:[1,0]
 v_pk_mul_f32 v[198:199], v[198:199], v[10:11] op_sel_hi:[1,0]
 v_pk_mul_f32 v[200:201], v[200:201], v[10:11] op_sel_hi:[1,0]
 v_pk_mul_f32 v[202:203], v[202:203], v[10:11] op_sel_hi:[1,0]
 v_pk_mul_f32 v[204:205], v[204:205], v[10:11] op_sel_hi:[1,0]
 v_pk_mul_f32 v[206:207], v[206:207], v[10:11] op_sel_hi:[1,0]
 v_cvt_pk_bf16_f32 v192, v192, v193
 v_cvt_pk_bf16_f32 v193, v194, v195
 v_cvt_pk_bf16_f32 v194, v196, v197
 v_cvt_pk_bf16_f32 v195, v198, v199
 v_cvt_pk_bf16_f32 v200, v200, v201
 v_cvt_pk_bf16_f32 v201, v202, v203
 v_cvt_pk_bf16_f32 v202, v204, v205
 v_cvt_pk_bf16_f32 v203, v206, v207
 s_waitcnt lgkmcnt(3)
 buffer_store_dwordx4 a[8:11], v241, s[16:19], s25 offen offset:1024 sc0 sc1
 s_waitcnt lgkmcnt(2)
 buffer_store_dwordx4 a[12:15], v241, s[16:19], s25 offen offset:1536 sc0 sc1
 ds_write_b128 v6, v[192:195] offset:9088
 ds_write_b128 v6, v[200:203] offset:9152
 ds_read_b128 a[16:19], v240 offset:8960
 ds_read_b128 a[20:23], v240 offset:11072
 ds_read_b128 a[24:27], v240 offset:13200
 ds_read_b128 a[28:31], v240 offset:15312
  s_waitcnt lgkmcnt(4)
  s_barrier
 s_waitcnt lgkmcnt(3)
 buffer_store_dwordx4 a[16:19], v241, s[16:19], s55 offen sc0 sc1
 s_waitcnt lgkmcnt(2)
 buffer_store_dwordx4 a[20:23], v241, s[16:19], s55 offen offset:512 sc0 sc1
 s_waitcnt lgkmcnt(1)
 buffer_store_dwordx4 a[24:27], v241, s[16:19], s55 offen offset:1024 sc0 sc1
 s_waitcnt lgkmcnt(0)
 buffer_store_dwordx4 a[28:31], v241, s[16:19], s55 offen offset:1536 sc0 sc1
  ds_read_b128 v[16:19], v13
  s_waitcnt lgkmcnt(0)
  v_or_b32 v16, v16, v17
  v_or_b32 v18, v18, v19
  v_or_b32 v16, v16, v18
  s_nop 0
  v_readfirstlane_b32 s42, v16
  s_nop 3
  s_cmp_eq_u32 s42, 0
  s_cbranch_scc0 L_fallback
L_fin:
  s_endpgm
L_fallback:
  s_waitcnt vmcnt(0)
  s_mul_i32 s45, s40, 253952
  s_add_u32 s12, s32, s45
  s_addc_u32 s13, s33, 0
  s_add_u32 s16, s38, s45
  s_addc_u32 s17, s39, 0
  s_lshl_b32 s20, s40, 17
  s_mov_b32 s24, 0
  s_mov_b32 s14, 253952
L_fb_block:
 s_add_u32 m0, s48, 0
 s_nop 0
 buffer_load_dwordx4 v5, s[12:15], 0 offen nt lds
 s_add_u32 m0, s48, 800
 s_nop 0
 buffer_load_dwordx4 v5, s[12:15], 0 offen offset:256 nt lds
 s_add_u32 m0, s48, 1600
 s_nop 0
 buffer_load_dwordx4 v5, s[12:15], 0 offen offset:512 nt lds
 s_add_u32 m0, s48, 2400
 s_nop 0
 buffer_load_dwordx4 v5, s[12:15], 0 offen offset:768 nt lds
 s_add_u32 m0, s48, 3200
 s_nop 0
 buffer_load_dwordx4 v5, s[12:15], 0 offen offset:1024 nt lds
 s_add_u32 m0, s48, 4000
 s_nop 0
 buffer_load_dwordx4 v5, s[12:15], 0 offen offset:1280 nt lds
 s_add_u32 m0, s48, 4800
 s_nop 0
 buffer_load_dwordx4 v5, s[12:15], 0 offen offset:1536 nt lds
 s_add_u32 m0, s48, 5600
 s_nop 0
 buffer_load_dwordx4 v5, s[12:15], 0 offen offset:1792 nt lds
 s_add_u32 m0, s48, 8448
 s_nop 0
 buffer_load_dwordx4 v5, s[12:15], s25 offen nt lds
 s_add_u32 m0, s48, 9248
 s_nop 0
 buffer_load_dwordx4 v5, s[12:15], s25 offen offset:256 nt lds
 s_add_u32 m0, s48, 10048
 s_nop 0
 buffer_load_dwordx4 v5, s[12:15], s25 offen offset:512 nt lds
 s_add_u32 m0, s48, 10848
 s_nop 0
 buffer_load_dwordx4 v5, s[12:15], s25 offen offset:768 nt lds
 s_add_u32 m0, s48, 11648
 s_nop 0
 buffer_load_dwordx4 v5, s[12:15], s25 offen offset:1024 nt lds
 s_add_u32 m0, s48, 12448
 s_nop 0
 buffer_load_dwordx4 v5, s[12:15], s25 offen offset:1280 nt lds
 s_add_u32 m0, s48, 13248
 s_nop 0
 buffer_load_dwordx4 v5, s[12:15], s25 offen offset:1536 nt lds
 s_add_u32 m0, s48, 14048
 s_nop 0
 buffer_load_dwordx4 v5, s[12:15], s25 offen offset:1792 nt lds
  v_mov_b32 v80, 0
  v_mov_b32 v81, 0
  v_mov_b32 v82, 0
  v_mov_b32 v83, 0
  v_mov_b32 v84, 0
  v_mov_b32 v85, 0
  v_mov_b32 v86, 0
  v_mov_b32 v87, 0
  v_mov_b32 v88, 0
  v_mov_b32 v89, 0
  v_mov_b32 v90, 0
  v_mov_b32 v91, 0
  v_mov_b32 v92, 0
  v_mov_b32 v93, 0
  v_mov_b32 v94, 0
  v_mov_b32 v95, 0
  v_mov_b32 v96, 0
  v_mov_b32 v97, 0
  v_mov_b32 v98, 0
  v_mov_b32 v99, 0
  v_mov_b32 v100, 0
  v_mov_b32 v101, 0
  v_mov_b32 v102, 0
  v_mov_b32 v103, 0
  v_mov_b32 v104, 0
  v_mov_b32 v105, 0
  v_mov_b32 v106, 0
  v_mov_b32 v107, 0
  v_mov_b32 v108, 0
  v_mov_b32 v109, 0
  v_mov_b32 v110, 0
  v_mov_b32 v111, 0
  v_mov_b32 v112, 0
  v_mov_b32 v113, 0
  v_mov_b32 v114, 0
  v_mov_b32 v115, 0
  v_mov_b32 v116, 0
  v_mov_b32 v117, 0
  v_mov_b32 v118, 0
  v_mov_b32 v119, 0
  v_mov_b32 v120, 0
  v_mov_b32 v121, 0
  v_mov_b32 v122, 0
  v_mov_b32 v123, 0
  v_mov_b32 v124, 0
  v_mov_b32 v125, 0
  v_mov_b32 v126, 0
  v_mov_b32 v127, 0
  v_mov_b32 v128, 0
  v_mov_b32 v129, 0
  v_mov_b32 v130, 0
  v_mov_b32 v131, 0
  v_mov_b32 v132, 0
  v_mov_b32 v133, 0
  v_mov_b32 v134, 0
  v_mov_b32 v135, 0
  v_mov_b32 v136, 0
  v_mov_b32 v137, 0
  v_mov_b32 v138, 0
  v_mov_b32 v139, 0
  v_mov_b32 v140, 0
  v_mov_b32 v141, 0
  v_mov_b32 v142, 0
  v_mov_b32 v143, 0
  v_mov_b32 v144, 0
  v_mov_b32 v145, 0
  v_mov_b32 v146, 0
  v_mov_b32 v147, 0
  v_mov_b32 v148, 0
  v_mov_b32 v149, 0
  v_mov_b32 v150, 0
  v_mov_b32 v151, 0
  v_mov_b32 v152, 0
  v_mov_b32 v153, 0
  v_mov_b32 v154, 0
  v_mov_b32 v155, 0
  v_mov_b32 v156, 0
  v_mov_b32 v157, 0
  v_mov_b32 v158, 0
  v_mov_b32 v159, 0
  v_mov_b32 v160, 0
  v_mov_b32 v161, 0
  v_mov_b32 v162, 0
  v_mov_b32 v163, 0
  v_mov_b32 v164, 0
  v_mov_b32 v165, 0
  v_mov_b32 v166, 0
  v_mov_b32 v167, 0
  v_mov_b32 v168, 0
  v_mov_b32 v169, 0
  v_mov_b32 v170, 0
  v_mov_b32 v171, 0
  v_mov_b32 v172, 0
  v_mov_b32 v173, 0
  v_mov_b32 v174, 0
  v_mov_b32 v175, 0
  v_mov_b32 v176, 0
  v_mov_b32 v177, 0
  v_mov_b32 v178, 0
  v_mov_b32 v179, 0
  v_mov_b32 v180, 0
  v_mov_b32 v181, 0
  v_mov_b32 v182, 0
  v_mov_b32 v183, 0
  v_mov_b32 v184, 0
  v_mov_b32 v185, 0
  v_mov_b32 v186, 0
  v_mov_b32 v187, 0
  v_mov_b32 v188, 0
  v_mov_b32 v189, 0
  v_mov_b32 v190, 0
  v_mov_b32 v191, 0
  v_mov_b32 v192, 0
  v_mov_b32 v193, 0
  v_mov_b32 v194, 0
  v_mov_b32 v195, 0
  v_mov_b32 v196, 0
  v_mov_b32 v197, 0
  v_mov_b32 v198, 0
  v_mov_b32 v199, 0
  v_mov_b32 v200, 0
  v_mov_b32 v201, 0
  v_mov_b32 v202, 0
  v_mov_b32 v203, 0
  v_mov_b32 v204, 0
  v_mov_b32 v205, 0
  v_mov_b32 v206, 0
  v_mov_b32 v207, 0
  v_mov_b32 v32, 0xff800000
  v_mov_b32 v36, 0
  v_mov_b32 v33, 0xff800000
  v_mov_b32 v37, 0
  v_mov_b32 v34, 0xff800000
  v_mov_b32 v38, 0
  v_mov_b32 v35, 0xff800000
  v_mov_b32 v39, 0
  s_waitcnt vmcnt(0)
 ds_read_b128 v[208:211], v3 offset:0
 ds_read_b128 v[212:215], v3 offset:64
 ds_read_b128 v[216:219], v3 offset:128
 ds_read_b128 v[220:223], v3 offset:192
 ds_read_b128 a[164:167], v3 offset:512
 ds_read_b128 a[168:171], v3 offset:576
 ds_read_b128 a[172:175], v3 offset:640
 ds_read_b128 a[176:179], v3 offset:704
  s_waitcnt lgkmcnt(0)
 ds_read_b128 v[224:227], v3 offset:8448
 ds_read_b128 v[228:231], v3 offset:8512
 ds_read_b128 v[232:235], v3 offset:8576
 ds_read_b128 v[236:239], v3 offset:8640
 ds_read_b128 a[180:183], v3 offset:8960
 ds_read_b128 a[184:187], v3 offset:9024
 ds_read_b128 a[188:191], v3 offset:9088
 ds_read_b128 a[192:195], v3 offset:9152
  s_waitcnt lgkmcnt(0)
  s_mov_b32 s44, 0
L_fb_step:
  s_barrier
  s_mov_b32 s21, s20
 s_add_u32 m0, s22, 0
 s_nop 0
 buffer_load_dwordx4 v4, s[4:7], s20 offen nt lds
 s_add_u32 m0, s22, 32
 s_nop 0
 buffer_load_dwordx4 v4, s[4:7], s20 offen offset:1024 nt lds
 s_add_u32 m0, s23, 0
 s_nop 0
 buffer_load_dwordx4 v4, s[8:11], s21 offen nt lds
 s_add_u32 m0, s23, 8
 s_nop 0
 buffer_load_dwordx4 v4, s[8:11], s21 offen offset:1024 nt lds
 s_add_u32 s20, s20, 8192
  s_waitcnt vmcnt(0)
  s_barrier
 ds_read_b128 a[0:3], v1 offset:0
 ds_read_b128 a[4:7], v1 offset:64
 ds_read_b128 a[8:11], v1 offset:128
 ds_read_b128 a[12:15], v1 offset:192
 ds_read_b128 a[16:19], v1 offset:512
 ds_read_b128 a[20:23], v1 offset:576
 ds_read_b128 a[24:27], v1 offset:640
 ds_read_b128 a[28:31], v1 offset:704
  s_waitcnt lgkmcnt(0)
  ds_read_b64_tr_b16 a[64:65], v2 offset:0
  ds_read_b64_tr_b16 a[66:67], v2 offset:512
  ds_read_b64_tr_b16 a[68:69], v2 offset:8
  ds_read_b64_tr_b16 a[70:71], v2 offset:520
  ds_read_b64_tr_b16 a[72:73], v2 offset:64
  ds_read_b64_tr_b16 a[74:75], v2 offset:576
  ds_read_b64_tr_b16 a[76:77], v2 offset:72
  ds_read_b64_tr_b16 a[78:79], v2 offset:584
  s_waitcnt lgkmcnt(0)
  ds_read_b64_tr_b16 a[80:81], v2 offset:128
  ds_read_b64_tr_b16 a[82:83], v2 offset:640
  ds_read_b64_tr_b16 a[84:85], v2 offset:136
  ds_read_b64_tr_b16 a[86:87], v2 offset:648
  ds_read_b64_tr_b16 a[88:89], v2 offset:192
  ds_read_b64_tr_b16 a[90:91], v2 offset:704
  ds_read_b64_tr_b16 a[92:93], v2 offset:200
  ds_read_b64_tr_b16 a[94:95], v2 offset:712
  s_waitcnt lgkmcnt(0)
 v_mfma_f32_16x16x32_bf16 v[16:19], a[0:3], v[208:211], 0
 v_mfma_f32_16x16x32_bf16 v[16:19], a[4:7], v[212:215], v[16:19]
 v_mfma_f32_16x16x32_bf16 v[16:19], a[8:11], v[216:219], v[16:19]
 v_mfma_f32_16x16x32_bf16 v[16:19], a[12:15], v[220:223], v[16:19]
 v_mfma_f32_16x16x32_bf16 v[20:23], a[16:19], v[208:211], 0
 v_mfma_f32_16x16x32_bf16 v[20:23], a[20:23], v[212:215], v[20:23]
 v_mfma_f32_16x16x32_bf16 v[20:23], a[24:27], v[216:219], v[20:23]
 v_mfma_f32_16x16x32_bf16 v[20:23], a[28:31], v[220:223], v[20:23]
 v_mfma_f32_16x16x32_bf16 v[24:27], a[0:3], a[164:167], 0
 v_mfma_f32_16x16x32_bf16 v[24:27], a[4:7], a[168:171], v[24:27]
 v_mfma_f32_16x16x32_bf16 v[24:27], a[8:11], a[172:175], v[24:27]
 v_mfma_f32_16x16x32_bf16 v[24:27], a[12:15], a[176:179], v[24:27]
 v_mfma_f32_16x16x32_bf16 v[28:31], a[16:19], a[164:167], 0
 v_mfma_f32_16x16x32_bf16 v[28:31], a[20:23], a[168:171], v[28:31]
 v_mfma_f32_16x16x32_bf16 v[28:31], a[24:27], a[172:175], v[28:31]
 v_mfma_f32_16x16x32_bf16 v[28:31], a[28:31], a[176:179], v[28:31]
  s_nop 15
 v_mul_f32 v16, s46, v16
 v_mul_f32 v17, s46, v17
 v_mul_f32 v18, s46, v18
 v_mul_f32 v19, s46, v19
 v_mul_f32 v20, s46, v20
 v_mul_f32 v21, s46, v21
 v_mul_f32 v22, s46, v22
 v_mul_f32 v23, s46, v23
  v_max3_f32 v12, v16, v17, v18
  v_max3_f32 v12, v12, v19, v20
  v_max3_f32 v12, v12, v21, v22
  v_max3_f32 v12, v12, v23, v32
  v_mov_b32 v13, v12
  s_nop 1
  v_permlane32_swap_b32 v13, v12
  v_max_f32 v12, v12, v13
  v_mov_b32 v13, v12
  s_nop 1
  v_permlane16_swap_b32 v13, v12
  v_max_f32 v12, v12, v13
  v_sub_f32 v13, v32, v12
  v_exp_f32 v13, v13
  v_mov_b32 v32, v12
  v_sub_f32 v16, v16, v12
  v_sub_f32 v17, v17, v12
  v_sub_f32 v18, v18, v12
  v_sub_f32 v19, v19, v12
  v_sub_f32 v20, v20, v12
  v_sub_f32 v21, v21, v12
  v_sub_f32 v22, v22, v12
  v_sub_f32 v23, v23, v12
  v_exp_f32 v16, v16
  v_exp_f32 v17, v17
  v_exp_f32 v18, v18
  v_exp_f32 v19, v19
  v_exp_f32 v20, v20
  v_exp_f32 v21, v21
  v_exp_f32 v22, v22
  v_exp_f32 v23, v23
  v_mul_f32 v36, v36, v13
  v_add_f32 v36, v36, v16
  v_add_f32 v36, v36, v17
  v_add_f32 v36, v36, v18
  v_add_f32 v36, v36, v19
  v_add_f32 v36, v36, v20
  v_add_f32 v36, v36, v21
  v_add_f32 v36, v36, v22
  v_add_f32 v36, v36, v23
 v_cvt_pk_bf16_f32 v48, v16, v17
 v_cvt_pk_bf16_f32 v49, v18, v19
 v_cvt_pk_bf16_f32 v50, v20, v21
 v_cvt_pk_bf16_f32 v51, v22, v23
  v_mul_f32 v80, v80, v13
  v_mul_f32 v81, v81, v13
  v_mul_f32 v82, v82, v13
  v_mul_f32 v83, v83, v13
  v_mul_f32 v84, v84, v13
  v_mul_f32 v85, v85, v13
  v_mul_f32 v86, v86, v13
  v_mul_f32 v87, v87, v13
  v_mul_f32 v88, v88, v13
  v_mul_f32 v89, v89, v13
  v_mul_f32 v90, v90, v13
  v_mul_f32 v91, v91, v13
  v_mul_f32 v92, v92, v13
  v_mul_f32 v93, v93, v13
  v_mul_f32 v94, v94, v13
  v_mul_f32 v95, v95, v13
  v_mul_f32 v96, v96, v13
  v_mul_f32 v97, v97, v13
  v_mul_f32 v98, v98, v13
  v_mul_f32 v99, v99, v13
  v_mul_f32 v100, v100, v13
  v_mul_f32 v101, v101, v13
  v_mul_f32 v102, v102, v13
  v_mul_f32 v103, v103, v13
  v_mul_f32 v104, v104, v13
  v_mul_f32 v105, v105, v13
  v_mul_f32 v106, v106, v13
  v_mul_f32 v107, v107, v13
  v_mul_f32 v108, v108, v13
  v_mul_f32 v109, v109, v13
  v_mul_f32 v110, v110, v13
  v_mul_f32 v111, v111, v13
 v_mul_f32 v24, s46, v24
 v_mul_f32 v25, s46, v25
 v_mul_f32 v26, s46, v26
 v_mul_f32 v27, s46, v27
 v_mul_f32 v28, s46, v28
 v_mul_f32 v29, s46, v29
 v_mul_f32 v30, s46, v30
 v_mul_f32 v31, s46, v31
  v_max3_f32 v12, v24, v25, v26
  v_max3_f32 v12, v12, v27, v28
  v_max3_f32 v12, v12, v29, v30
  v_max3_f32 v12, v12, v31, v33
  v_mov_b32 v13, v12
  s_nop 1
  v_permlane32_swap_b32 v13, v12
  v_max_f32 v12, v12, v13
  v_mov_b32 v13, v12
  s_nop 1
  v_permlane16_swap_b32 v13, v12
  v_max_f32 v12, v12, v13
  v_sub_f32 v13, v33, v12
  v_exp_f32 v13, v13
  v_mov_b32 v33, v12
  v_sub_f32 v24, v24, v12
  v_sub_f32 v25, v25, v12
  v_sub_f32 v26, v26, v12
  v_sub_f32 v27, v27, v12
  v_sub_f32 v28, v28, v12
  v_sub_f32 v29, v29, v12
  v_sub_f32 v30, v30, v12
  v_sub_f32 v31, v31, v12
  v_exp_f32 v24, v24
  v_exp_f32 v25, v25
  v_exp_f32 v26, v26
  v_exp_f32 v27, v27
  v_exp_f32 v28, v28
  v_exp_f32 v29, v29
  v_exp_f32 v30, v30
  v_exp_f32 v31, v31
  v_mul_f32 v37, v37, v13
  v_add_f32 v37, v37, v24
  v_add_f32 v37, v37, v25
  v_add_f32 v37, v37, v26
  v_add_f32 v37, v37, v27
  v_add_f32 v37, v37, v28
  v_add_f32 v37, v37, v29
  v_add_f32 v37, v37, v30
  v_add_f32 v37, v37, v31
 v_cvt_pk_bf16_f32 v56, v24, v25
 v_cvt_pk_bf16_f32 v57, v26, v27
 v_cvt_pk_bf16_f32 v58, v28, v29
 v_cvt_pk_bf16_f32 v59, v30, v31
  v_mul_f32 v112, v112, v13
  v_mul_f32 v113, v113, v13
  v_mul_f32 v114, v114, v13
  v_mul_f32 v115, v115, v13
  v_mul_f32 v116, v116, v13
  v_mul_f32 v117, v117, v13
  v_mul_f32 v118, v118, v13
  v_mul_f32 v119, v119, v13
  v_mul_f32 v120, v120, v13
  v_mul_f32 v121, v121, v13
  v_mul_f32 v122, v122, v13
  v_mul_f32 v123, v123, v13
  v_mul_f32 v124, v124, v13
  v_mul_f32 v125, v125, v13
  v_mul_f32 v126, v126, v13
  v_mul_f32 v127, v127, v13
  v_mul_f32 v128, v128, v13
  v_mul_f32 v129, v129, v13
  v_mul_f32 v130, v130, v13
  v_mul_f32 v131, v131, v13
  v_mul_f32 v132, v132, v13
  v_mul_f32 v133, v133, v13
  v_mul_f32 v134, v134, v13
  v_mul_f32 v135, v135, v13
  v_mul_f32 v136, v136, v13
  v_mul_f32 v137, v137, v13
  v_mul_f32 v138, v138, v13
  v_mul_f32 v139, v139, v13
  v_mul_f32 v140, v140, v13
  v_mul_f32 v141, v141, v13
  v_mul_f32 v142, v142, v13
  v_mul_f32 v143, v143, v13
  s_nop 1
 v_mfma_f32_16x16x32_bf16 v[80:83], a[64:67], v[48:51], v[80:83]
 v_mfma_f32_16x16x32_bf16 v[112:115], a[64:67], v[56:59], v[112:115]
 v_mfma_f32_16x16x32_bf16 v[84:87], a[68:71], v[48:51], v[84:87]
 v_mfma_f32_16x16x32_bf16 v[116:119], a[68:71], v[56:59], v[116:119]
 v_mfma_f32_16x16x32_bf16 v[88:91], a[72:75], v[48:51], v[88:91]
 v_mfma_f32_16x16x32_bf16 v[120:123], a[72:75], v[56:59], v[120:123]
 v_mfma_f32_16x16x32_bf16 v[92:95], a[76:79], v[48:51], v[92:95]
 v_mfma_f32_16x16x32_bf16 v[124:127], a[76:79], v[56:59], v[124:127]
 v_mfma_f32_16x16x32_bf16 v[96:99], a[80:83], v[48:51], v[96:99]
 v_mfma_f32_16x16x32_bf16 v[128:131], a[80:83], v[56:59], v[128:131]
 v_mfma_f32_16x16x32_bf16 v[100:103], a[84:87], v[48:51], v[100:103]
 v_mfma_f32_16x16x32_bf16 v[132:135], a[84:87], v[56:59], v[132:135]
 v_mfma_f32_16x16x32_bf16 v[104:107], a[88:91], v[48:51], v[104:107]
 v_mfma_f32_16x16x32_bf16 v[136:139], a[88:91], v[56:59], v[136:139]
 v_mfma_f32_16x16x32_bf16 v[108:111], a[92:95], v[48:51], v[108:111]
 v_mfma_f32_16x16x32_bf16 v[140:143], a[92:95], v[56:59], v[140:143]
 v_mfma_f32_16x16x32_bf16 v[16:19], a[0:3], v[224:227], 0
 v_mfma_f32_16x16x32_bf16 v[16:19], a[4:7], v[228:231], v[16:19]
 v_mfma_f32_16x16x32_bf16 v[16:19], a[8:11], v[232:235], v[16:19]
 v_mfma_f32_16x16x32_bf16 v[16:19], a[12:15], v[236:239], v[16:19]
 v_mfma_f32_16x16x32_bf16 v[20:23], a[16:19], v[224:227], 0
 v_mfma_f32_16x16x32_bf16 v[20:23], a[20:23], v[228:231], v[20:23]
 v_mfma_f32_16x16x32_bf16 v[20:23], a[24:27], v[232:235], v[20:23]
 v_mfma_f32_16x16x32_bf16 v[20:23], a[28:31], v[236:239], v[20:23]
 v_mfma_f32_16x16x32_bf16 v[24:27], a[0:3], a[180:183], 0
 v_mfma_f32_16x16x32_bf16 v[24:27], a[4:7], a[184:187], v[24:27]
 v_mfma_f32_16x16x32_bf16 v[24:27], a[8:11], a[188:191], v[24:27]
 v_mfma_f32_16x16x32_bf16 v[24:27], a[12:15], a[192:195], v[24:27]
 v_mfma_f32_16x16x32_bf16 v[28:31], a[16:19], a[180:183], 0
 v_mfma_f32_16x16x32_bf16 v[28:31], a[20:23], a[184:187], v[28:31]
 v_mfma_f32_16x16x32_bf16 v[28:31], a[24:27], a[188:191], v[28:31]
 v_mfma_f32_16x16x32_bf16 v[28:31], a[28:31], a[192:195], v[28:31]
  s_nop 15
 v_mul_f32 v16, s46, v16
 v_mul_f32 v17, s46, v17
 v_mul_f32 v18, s46, v18
 v_mul_f32 v19, s46, v19
 v_mul_f32 v20, s46, v20
 v_mul_f32 v21, s46, v21
 v_mul_f32 v22, s46, v22
 v_mul_f32 v23, s46, v23
  v_max3_f32 v12, v16, v17, v18
  v_max3_f32 v12, v12, v19, v20
  v_max3_f32 v12, v12, v21, v22
  v_max3_f32 v12, v12, v23, v34
  v_mov_b32 v13, v12
  s_nop 1
  v_permlane32_swap_b32 v13, v12
  v_max_f32 v12, v12, v13
  v_mov_b32 v13, v12
  s_nop 1
  v_permlane16_swap_b32 v13, v12
  v_max_f32 v12, v12, v13
  v_sub_f32 v13, v34, v12
  v_exp_f32 v13, v13
  v_mov_b32 v34, v12
  v_sub_f32 v16, v16, v12
  v_sub_f32 v17, v17, v12
  v_sub_f32 v18, v18, v12
  v_sub_f32 v19, v19, v12
  v_sub_f32 v20, v20, v12
  v_sub_f32 v21, v21, v12
  v_sub_f32 v22, v22, v12
  v_sub_f32 v23, v23, v12
  v_exp_f32 v16, v16
  v_exp_f32 v17, v17
  v_exp_f32 v18, v18
  v_exp_f32 v19, v19
  v_exp_f32 v20, v20
  v_exp_f32 v21, v21
  v_exp_f32 v22, v22
  v_exp_f32 v23, v23
  v_mul_f32 v38, v38, v13
  v_add_f32 v38, v38, v16
  v_add_f32 v38, v38, v17
  v_add_f32 v38, v38, v18
  v_add_f32 v38, v38, v19
  v_add_f32 v38, v38, v20
  v_add_f32 v38, v38, v21
  v_add_f32 v38, v38, v22
  v_add_f32 v38, v38, v23
 v_cvt_pk_bf16_f32 v48, v16, v17
 v_cvt_pk_bf16_f32 v49, v18, v19
 v_cvt_pk_bf16_f32 v50, v20, v21
 v_cvt_pk_bf16_f32 v51, v22, v23
  v_mul_f32 v144, v144, v13
  v_mul_f32 v145, v145, v13
  v_mul_f32 v146, v146, v13
  v_mul_f32 v147, v147, v13
  v_mul_f32 v148, v148, v13
  v_mul_f32 v149, v149, v13
  v_mul_f32 v150, v150, v13
  v_mul_f32 v151, v151, v13
  v_mul_f32 v152, v152, v13
  v_mul_f32 v153, v153, v13
  v_mul_f32 v154, v154, v13
  v_mul_f32 v155, v155, v13
  v_mul_f32 v156, v156, v13
  v_mul_f32 v157, v157, v13
  v_mul_f32 v158, v158, v13
  v_mul_f32 v159, v159, v13
  v_mul_f32 v160, v160, v13
  v_mul_f32 v161, v161, v13
  v_mul_f32 v162, v162, v13
  v_mul_f32 v163, v163, v13
  v_mul_f32 v164, v164, v13
  v_mul_f32 v165, v165, v13
  v_mul_f32 v166, v166, v13
  v_mul_f32 v167, v167, v13
  v_mul_f32 v168, v168, v13
  v_mul_f32 v169, v169, v13
  v_mul_f32 v170, v170, v13
  v_mul_f32 v171, v171, v13
  v_mul_f32 v172, v172, v13
  v_mul_f32 v173, v173, v13
  v_mul_f32 v174, v174, v13
  v_mul_f32 v175, v175, v13
 v_mul_f32 v24, s46, v24
 v_mul_f32 v25, s46, v25
 v_mul_f32 v26, s46, v26
 v_mul_f32 v27, s46, v27
 v_mul_f32 v28, s46, v28
 v_mul_f32 v29, s46, v29
 v_mul_f32 v30, s46, v30
 v_mul_f32 v31, s46, v31
  v_max3_f32 v12, v24, v25, v26
  v_max3_f32 v12, v12, v27, v28
  v_max3_f32 v12, v12, v29, v30
  v_max3_f32 v12, v12, v31, v35
  v_mov_b32 v13, v12
  s_nop 1
  v_permlane32_swap_b32 v13, v12
  v_max_f32 v12, v12, v13
  v_mov_b32 v13, v12
  s_nop 1
  v_permlane16_swap_b32 v13, v12
  v_max_f32 v12, v12, v13
  v_sub_f32 v13, v35, v12
  v_exp_f32 v13, v13
  v_mov_b32 v35, v12
  v_sub_f32 v24, v24, v12
  v_sub_f32 v25, v25, v12
  v_sub_f32 v26, v26, v12
  v_sub_f32 v27, v27, v12
  v_sub_f32 v28, v28, v12
  v_sub_f32 v29, v29, v12
  v_sub_f32 v30, v30, v12
  v_sub_f32 v31, v31, v12
  v_exp_f32 v24, v24
  v_exp_f32 v25, v25
  v_exp_f32 v26, v26
  v_exp_f32 v27, v27
  v_exp_f32 v28, v28
  v_exp_f32 v29, v29
  v_exp_f32 v30, v30
  v_exp_f32 v31, v31
  v_mul_f32 v39, v39, v13
  v_add_f32 v39, v39, v24
  v_add_f32 v39, v39, v25
  v_add_f32 v39, v39, v26
  v_add_f32 v39, v39, v27
  v_add_f32 v39, v39, v28
  v_add_f32 v39, v39, v29
  v_add_f32 v39, v39, v30
  v_add_f32 v39, v39, v31
 v_cvt_pk_bf16_f32 v56, v24, v25
 v_cvt_pk_bf16_f32 v57, v26, v27
 v_cvt_pk_bf16_f32 v58, v28, v29
 v_cvt_pk_bf16_f32 v59, v30, v31
  v_mul_f32 v176, v176, v13
  v_mul_f32 v177, v177, v13
  v_mul_f32 v178, v178, v13
  v_mul_f32 v179, v179, v13
  v_mul_f32 v180, v180, v13
  v_mul_f32 v181, v181, v13
  v_mul_f32 v182, v182, v13
  v_mul_f32 v183, v183, v13
  v_mul_f32 v184, v184, v13
  v_mul_f32 v185, v185, v13
  v_mul_f32 v186, v186, v13
  v_mul_f32 v187, v187, v13
  v_mul_f32 v188, v188, v13
  v_mul_f32 v189, v189, v13
  v_mul_f32 v190, v190, v13
  v_mul_f32 v191, v191, v13
  v_mul_f32 v192, v192, v13
  v_mul_f32 v193, v193, v13
  v_mul_f32 v194, v194, v13
  v_mul_f32 v195, v195, v13
  v_mul_f32 v196, v196, v13
  v_mul_f32 v197, v197, v13
  v_mul_f32 v198, v198, v13
  v_mul_f32 v199, v199, v13
  v_mul_f32 v200, v200, v13
  v_mul_f32 v201, v201, v13
  v_mul_f32 v202, v202, v13
  v_mul_f32 v203, v203, v13
  v_mul_f32 v204, v204, v13
  v_mul_f32 v205, v205, v13
  v_mul_f32 v206, v206, v13
  v_mul_f32 v207, v207, v13
  s_nop 1
 v_mfma_f32_16x16x32_bf16 v[144:147], a[64:67], v[48:51], v[144:147]
 v_mfma_f32_16x16x32_bf16 v[176:179], a[64:67], v[56:59], v[176:179]
 v_mfma_f32_16x16x32_bf16 v[148:151], a[68:71], v[48:51], v[148:151]
 v_mfma_f32_16x16x32_bf16 v[180:183], a[68:71], v[56:59], v[180:183]
 v_mfma_f32_16x16x32_bf16 v[152:155], a[72:75], v[48:51], v[152:155]
 v_mfma_f32_16x16x32_bf16 v[184:187], a[72:75], v[56:59], v[184:187]
 v_mfma_f32_16x16x32_bf16 v[156:159], a[76:79], v[48:51], v[156:159]
 v_mfma_f32_16x16x32_bf16 v[188:191], a[76:79], v[56:59], v[188:191]
 v_mfma_f32_16x16x32_bf16 v[160:163], a[80:83], v[48:51], v[160:163]
 v_mfma_f32_16x16x32_bf16 v[192:195], a[80:83], v[56:59], v[192:195]
 v_mfma_f32_16x16x32_bf16 v[164:167], a[84:87], v[48:51], v[164:167]
 v_mfma_f32_16x16x32_bf16 v[196:199], a[84:87], v[56:59], v[196:199]
 v_mfma_f32_16x16x32_bf16 v[168:171], a[88:91], v[48:51], v[168:171]
 v_mfma_f32_16x16x32_bf16 v[200:203], a[88:91], v[56:59], v[200:203]
 v_mfma_f32_16x16x32_bf16 v[172:175], a[92:95], v[48:51], v[172:175]
 v_mfma_f32_16x16x32_bf16 v[204:207], a[92:95], v[56:59], v[204:207]
  s_nop 15
  s_add_u32 s44, s44, 1
  s_cmp_lt_u32 s44, 16
  s_cbranch_scc1 L_fb_step
  v_mov_b32 v13, v36
  s_nop 1
  v_permlane32_swap_b32 v13, v36
  v_add_f32 v36, v36, v13
  v_mov_b32 v13, v36
  s_nop 1
  v_permlane16_swap_b32 v13, v36
  v_add_f32 v36, v36, v13
  v_rcp_f32 v8, v36
  v_mov_b32 v13, v37
  s_nop 1
  v_permlane32_swap_b32 v13, v37
  v_add_f32 v37, v37, v13
  v_mov_b32 v13, v37
  s_nop 1
  v_permlane16_swap_b32 v13, v37
  v_add_f32 v37, v37, v13
  v_rcp_f32 v10, v37
  s_nop 0
 v_pk_mul_f32 v[80:81], v[80:81], v[8:9] op_sel_hi:[1,0]
 v_pk_mul_f32 v[82:83], v[82:83], v[8:9] op_sel_hi:[1,0]
 v_pk_mul_f32 v[84:85], v[84:85], v[8:9] op_sel_hi:[1,0]
 v_pk_mul_f32 v[86:87], v[86:87], v[8:9] op_sel_hi:[1,0]
 v_pk_mul_f32 v[88:89], v[88:89], v[8:9] op_sel_hi:[1,0]
 v_pk_mul_f32 v[90:91], v[90:91], v[8:9] op_sel_hi:[1,0]
 v_pk_mul_f32 v[92:93], v[92:93], v[8:9] op_sel_hi:[1,0]
 v_pk_mul_f32 v[94:95], v[94:95], v[8:9] op_sel_hi:[1,0]
 v_pk_mul_f32 v[96:97], v[96:97], v[8:9] op_sel_hi:[1,0]
 v_pk_mul_f32 v[98:99], v[98:99], v[8:9] op_sel_hi:[1,0]
 v_pk_mul_f32 v[100:101], v[100:101], v[8:9] op_sel_hi:[1,0]
 v_pk_mul_f32 v[102:103], v[102:103], v[8:9] op_sel_hi:[1,0]
 v_pk_mul_f32 v[104:105], v[104:105], v[8:9] op_sel_hi:[1,0]
 v_pk_mul_f32 v[106:107], v[106:107], v[8:9] op_sel_hi:[1,0]
 v_pk_mul_f32 v[108:109], v[108:109], v[8:9] op_sel_hi:[1,0]
 v_pk_mul_f32 v[110:111], v[110:111], v[8:9] op_sel_hi:[1,0]
 v_pk_mul_f32 v[112:113], v[112:113], v[10:11] op_sel_hi:[1,0]
 v_pk_mul_f32 v[114:115], v[114:115], v[10:11] op_sel_hi:[1,0]
 v_pk_mul_f32 v[116:117], v[116:117], v[10:11] op_sel_hi:[1,0]
 v_pk_mul_f32 v[118:119], v[118:119], v[10:11] op_sel_hi:[1,0]
 v_pk_mul_f32 v[120:121], v[120:121], v[10:11] op_sel_hi:[1,0]
 v_pk_mul_f32 v[122:123], v[122:123], v[10:11] op_sel_hi:[1,0]
 v_pk_mul_f32 v[124:125], v[124:125], v[10:11] op_sel_hi:[1,0]
 v_pk_mul_f32 v[126:127], v[126:127], v[10:11] op_sel_hi:[1,0]
 v_pk_mul_f32 v[128:129], v[128:129], v[10:11] op_sel_hi:[1,0]
 v_pk_mul_f32 v[130:131], v[130:131], v[10:11] op_sel_hi:[1,0]
 v_pk_mul_f32 v[132:133], v[132:133], v[10:11] op_sel_hi:[1,0]
 v_pk_mul_f32 v[134:135], v[134:135], v[10:11] op_sel_hi:[1,0]
 v_pk_mul_f32 v[136:137], v[136:137], v[10:11] op_sel_hi:[1,0]
 v_pk_mul_f32 v[138:139], v[138:139], v[10:11] op_sel_hi:[1,0]
 v_pk_mul_f32 v[140:141], v[140:141], v[10:11] op_sel_hi:[1,0]
 v_pk_mul_f32 v[142:143], v[142:143], v[10:11] op_sel_hi:[1,0]
 v_cvt_pk_bf16_f32 v80, v80, v81
 v_cvt_pk_bf16_f32 v81, v82, v83
 v_cvt_pk_bf16_f32 v82, v84, v85
 v_cvt_pk_bf16_f32 v83, v86, v87
 v_cvt_pk_bf16_f32 v88, v88, v89
 v_cvt_pk_bf16_f32 v89, v90, v91
 v_cvt_pk_bf16_f32 v90, v92, v93
 v_cvt_pk_bf16_f32 v91, v94, v95
 v_cvt_pk_bf16_f32 v96, v96, v97
 v_cvt_pk_bf16_f32 v97, v98, v99
 v_cvt_pk_bf16_f32 v98, v100, v101
 v_cvt_pk_bf16_f32 v99, v102, v103
 v_cvt_pk_bf16_f32 v104, v104, v105
 v_cvt_pk_bf16_f32 v105, v106, v107
 v_cvt_pk_bf16_f32 v106, v108, v109
 v_cvt_pk_bf16_f32 v107, v110, v111
 v_cvt_pk_bf16_f32 v112, v112, v113
 v_cvt_pk_bf16_f32 v113, v114, v115
 v_cvt_pk_bf16_f32 v114, v116, v117
 v_cvt_pk_bf16_f32 v115, v118, v119
 v_cvt_pk_bf16_f32 v120, v120, v121
 v_cvt_pk_bf16_f32 v121, v122, v123
 v_cvt_pk_bf16_f32 v122, v124, v125
 v_cvt_pk_bf16_f32 v123, v126, v127
 v_cvt_pk_bf16_f32 v128, v128, v129
 v_cvt_pk_bf16_f32 v129, v130, v131
 v_cvt_pk_bf16_f32 v130, v132, v133
 v_cvt_pk_bf16_f32 v131, v134, v135
 v_cvt_pk_bf16_f32 v136, v136, v137
 v_cvt_pk_bf16_f32 v137, v138, v139
 v_cvt_pk_bf16_f32 v138, v140, v141
 v_cvt_pk_bf16_f32 v139, v142, v143
 ds_write_b128 v6, v[80:83] offset:0
 ds_write_b128 v6, v[88:91] offset:64
 ds_write_b128 v6, v[96:99] offset:128
 ds_write_b128 v6, v[104:107] offset:192
 ds_write_b128 v6, v[112:115] offset:512
 ds_write_b128 v6, v[120:123] offset:576
 ds_write_b128 v6, v[128:131] offset:640
 ds_write_b128 v6, v[136:139] offset:704
 ds_read_b128 a[0:3], v7 offset:0
 ds_read_b128 a[4:7], v7 offset:1056
 ds_read_b128 a[8:11], v7 offset:2112
 ds_read_b128 a[12:15], v7 offset:3168
 ds_read_b128 a[16:19], v7 offset:4240
 ds_read_b128 a[20:23], v7 offset:5296
 ds_read_b128 a[24:27], v7 offset:6352
 ds_read_b128 a[28:31], v7 offset:7408
  s_waitcnt lgkmcnt(0)
 buffer_store_dwordx4 a[0:3], v5, s[16:19], 0 offen sc0 sc1
 buffer_store_dwordx4 a[4:7], v5, s[16:19], 0 offen offset:256 sc0 sc1
 buffer_store_dwordx4 a[8:11], v5, s[16:19], 0 offen offset:512 sc0 sc1
 buffer_store_dwordx4 a[12:15], v5, s[16:19], 0 offen offset:768 sc0 sc1
 buffer_store_dwordx4 a[16:19], v5, s[16:19], 0 offen offset:1024 sc0 sc1
 buffer_store_dwordx4 a[20:23], v5, s[16:19], 0 offen offset:1280 sc0 sc1
 buffer_store_dwordx4 a[24:27], v5, s[16:19], 0 offen offset:1536 sc0 sc1
 buffer_store_dwordx4 a[28:31], v5, s[16:19], 0 offen offset:1792 sc0 sc1
  s_waitcnt vmcnt(0)
  v_mov_b32 v13, v38
  s_nop 1
  v_permlane32_swap_b32 v13, v38
  v_add_f32 v38, v38, v13
  v_mov_b32 v13, v38
  s_nop 1
  v_permlane16_swap_b32 v13, v38
  v_add_f32 v38, v38, v13
  v_rcp_f32 v8, v38
  v_mov_b32 v13, v39
  s_nop 1
  v_permlane32_swap_b32 v13, v39
  v_add_f32 v39, v39, v13
  v_mov_b32 v13, v39
  s_nop 1
  v_permlane16_swap_b32 v13, v39
  v_add_f32 v39, v39, v13
  v_rcp_f32 v10, v39
  s_nop 0
 v_pk_mul_f32 v[144:145], v[144:145], v[8:9] op_sel_hi:[1,0]
 v_pk_mul_f32 v[146:147], v[146:147], v[8:9] op_sel_hi:[1,0]
 v_pk_mul_f32 v[148:149], v[148:149], v[8:9] op_sel_hi:[1,0]
 v_pk_mul_f32 v[150:151], v[150:151], v[8:9] op_sel_hi:[1,0]
 v_pk_mul_f32 v[152:153], v[152:153], v[8:9] op_sel_hi:[1,0]
 v_pk_mul_f32 v[154:155], v[154:155], v[8:9] op_sel_hi:[1,0]
 v_pk_mul_f32 v[156:157], v[156:157], v[8:9] op_sel_hi:[1,0]
 v_pk_mul_f32 v[158:159], v[158:159], v[8:9] op_sel_hi:[1,0]
 v_pk_mul_f32 v[160:161], v[160:161], v[8:9] op_sel_hi:[1,0]
 v_pk_mul_f32 v[162:163], v[162:163], v[8:9] op_sel_hi:[1,0]
 v_pk_mul_f32 v[164:165], v[164:165], v[8:9] op_sel_hi:[1,0]
 v_pk_mul_f32 v[166:167], v[166:167], v[8:9] op_sel_hi:[1,0]
 v_pk_mul_f32 v[168:169], v[168:169], v[8:9] op_sel_hi:[1,0]
 v_pk_mul_f32 v[170:171], v[170:171], v[8:9] op_sel_hi:[1,0]
 v_pk_mul_f32 v[172:173], v[172:173], v[8:9] op_sel_hi:[1,0]
 v_pk_mul_f32 v[174:175], v[174:175], v[8:9] op_sel_hi:[1,0]
 v_pk_mul_f32 v[176:177], v[176:177], v[10:11] op_sel_hi:[1,0]
 v_pk_mul_f32 v[178:179], v[178:179], v[10:11] op_sel_hi:[1,0]
 v_pk_mul_f32 v[180:181], v[180:181], v[10:11] op_sel_hi:[1,0]
 v_pk_mul_f32 v[182:183], v[182:183], v[10:11] op_sel_hi:[1,0]
 v_pk_mul_f32 v[184:185], v[184:185], v[10:11] op_sel_hi:[1,0]
 v_pk_mul_f32 v[186:187], v[186:187], v[10:11] op_sel_hi:[1,0]
 v_pk_mul_f32 v[188:189], v[188:189], v[10:11] op_sel_hi:[1,0]
 v_pk_mul_f32 v[190:191], v[190:191], v[10:11] op_sel_hi:[1,0]
 v_pk_mul_f32 v[192:193], v[192:193], v[10:11] op_sel_hi:[1,0]
 v_pk_mul_f32 v[194:195], v[194:195], v[10:11] op_sel_hi:[1,0]
 v_pk_mul_f32 v[196:197], v[196:197], v[10:11] op_sel_hi:[1,0]
 v_pk_mul_f32 v[198:199], v[198:199], v[10:11] op_sel_hi:[1,0]
 v_pk_mul_f32 v[200:201], v[200:201], v[10:11] op_sel_hi:[1,0]
 v_pk_mul_f32 v[202:203], v[202:203], v[10:11] op_sel_hi:[1,0]
 v_pk_mul_f32 v[204:205], v[204:205], v[10:11] op_sel_hi:[1,0]
 v_pk_mul_f32 v[206:207], v[206:207], v[10:11] op_sel_hi:[1,0]
 v_cvt_pk_bf16_f32 v144, v144, v145
 v_cvt_pk_bf16_f32 v145, v146, v147
 v_cvt_pk_bf16_f32 v146, v148, v149
 v_cvt_pk_bf16_f32 v147, v150, v151
 v_cvt_pk_bf16_f32 v152, v152, v153
 v_cvt_pk_bf16_f32 v153, v154, v155
 v_cvt_pk_bf16_f32 v154, v156, v157
 v_cvt_pk_bf16_f32 v155, v158, v159
 v_cvt_pk_bf16_f32 v160, v160, v161
 v_cvt_pk_bf16_f32 v161, v162, v163
 v_cvt_pk_bf16_f32 v162, v164, v165
 v_cvt_pk_bf16_f32 v163, v166, v167
 v_cvt_pk_bf16_f32 v168, v168, v169
 v_cvt_pk_bf16_f32 v169, v170, v171
 v_cvt_pk_bf16_f32 v170, v172, v173
 v_cvt_pk_bf16_f32 v171, v174, v175
 v_cvt_pk_bf16_f32 v176, v176, v177
 v_cvt_pk_bf16_f32 v177, v178, v179
 v_cvt_pk_bf16_f32 v178, v180, v181
 v_cvt_pk_bf16_f32 v179, v182, v183
 v_cvt_pk_bf16_f32 v184, v184, v185
 v_cvt_pk_bf16_f32 v185, v186, v187
 v_cvt_pk_bf16_f32 v186, v188, v189
 v_cvt_pk_bf16_f32 v187, v190, v191
 v_cvt_pk_bf16_f32 v192, v192, v193
 v_cvt_pk_bf16_f32 v193, v194, v195
 v_cvt_pk_bf16_f32 v194, v196, v197
 v_cvt_pk_bf16_f32 v195, v198, v199
 v_cvt_pk_bf16_f32 v200, v200, v201
 v_cvt_pk_bf16_f32 v201, v202, v203
 v_cvt_pk_bf16_f32 v202, v204, v205
 v_cvt_pk_bf16_f32 v203, v206, v207
 ds_write_b128 v6, v[144:147] offset:8448
 ds_write_b128 v6, v[152:155] offset:8512
 ds_write_b128 v6, v[160:163] offset:8576
 ds_write_b128 v6, v[168:171] offset:8640
 ds_write_b128 v6, v[176:179] offset:8960
 ds_write_b128 v6, v[184:187] offset:9024
 ds_write_b128 v6, v[192:195] offset:9088
 ds_write_b128 v6, v[200:203] offset:9152
 ds_read_b128 a[0:3], v7 offset:8448
 ds_read_b128 a[4:7], v7 offset:9504
 ds_read_b128 a[8:11], v7 offset:10560
 ds_read_b128 a[12:15], v7 offset:11616
 ds_read_b128 a[16:19], v7 offset:12688
 ds_read_b128 a[20:23], v7 offset:13744
 ds_read_b128 a[24:27], v7 offset:14800
 ds_read_b128 a[28:31], v7 offset:15856
  s_waitcnt lgkmcnt(0)
 buffer_store_dwordx4 a[0:3], v5, s[16:19], s25 offen sc0 sc1
 buffer_store_dwordx4 a[4:7], v5, s[16:19], s25 offen offset:256 sc0 sc1
 buffer_store_dwordx4 a[8:11], v5, s[16:19], s25 offen offset:512 sc0 sc1
 buffer_store_dwordx4 a[12:15], v5, s[16:19], s25 offen offset:768 sc0 sc1
 buffer_store_dwordx4 a[16:19], v5, s[16:19], s25 offen offset:1024 sc0 sc1
 buffer_store_dwordx4 a[20:23], v5, s[16:19], s25 offen offset:1280 sc0 sc1
 buffer_store_dwordx4 a[24:27], v5, s[16:19], s25 offen offset:1536 sc0 sc1
 buffer_store_dwordx4 a[28:31], v5, s[16:19], s25 offen offset:1792 sc0 sc1
  s_waitcnt vmcnt(0)
  s_add_u32 s12, s12, 253952
  s_addc_u32 s13, s13, 0
  s_add_u32 s16, s16, 253952
  s_addc_u32 s17, s17, 0
  s_add_u32 s20, s20, 0
  s_add_u32 s24, s24, 1
  s_cmp_lt_u32 s24, 4
  s_cbranch_scc1 L_fb_block
  s_branch L_fin
.section .rodata,"a"
.p2align 6
.amdhsa_kernel standalone__gqa_softmax__near_ridge_kernel
  .amdhsa_next_free_vgpr 512
  .amdhsa_next_free_sgpr 100
  .amdhsa_accum_offset 256
  .amdhsa_group_segment_fixed_size 0
  .amdhsa_kernarg_size 48
  .amdhsa_user_sgpr_count 2
  .amdhsa_user_sgpr_kernarg_segment_ptr 1
  .amdhsa_system_sgpr_workgroup_id_x 1
.end_amdhsa_kernel
```
